```python
import torch

def _softmax(x, axis=-1):
    return torch.softmax(x, dim=axis)
def _gelu(x):
    return torch.nn.functional.gelu(x, approximate="tanh")
def _silu(x):
    return torch.nn.functional.silu(x)
def _sigmoid(x):
    return torch.sigmoid(x)
def _layernorm(x, axis=-1, eps=1e-5):
    m = x.mean(dim=axis, keepdim=True)
    v = x.var(dim=axis, keepdim=True, unbiased=False)
    return (x - m) / torch.sqrt(v + eps)
def _scatter_add(tgt, idx, src, axis=0):
    return tgt.clone().index_add_(axis, idx, src)
def _segment_sum(src, seg, n):
    out = torch.zeros((n,) + src.shape[1:], dtype=src.dtype)
    return out.index_add_(0, seg, src)
def _pad(x, pw):
    flat = tuple(v for pair in reversed(pw) for v in pair)
    return torch.nn.functional.pad(x, flat)

kernel_name = 'standalone__glu_gated_geglu__prompt'

def setup_inputs():

    _w = (lambda a: (lambda t: t.to(torch.bfloat16) if t.is_floating_point() else t)(torch.as_tensor(a)))
    B, S, Dm, Df = 1, 2048, 640, 1728
    return {
        "x": _w((lambda *s: torch.randn(*s, dtype=torch.bfloat16) * 0.05)(B, S, Dm)),
        "w_gate": _w((lambda *s: torch.randn(*s, dtype=torch.bfloat16) * 0.05)(Dm, Df) * (Dm ** -0.5)),
        "w_up": _w((lambda *s: torch.randn(*s, dtype=torch.bfloat16) * 0.05)(Dm, Df) * (Dm ** -0.5)),
        "w_down": _w((lambda *s: torch.randn(*s, dtype=torch.bfloat16) * 0.05)(Df, Dm) * (Df ** -0.5)),
    }

def reference(x, w_gate, w_up, w_down):
    g = torch.einsum("bsd,df->bsf", x, w_gate)
    u = torch.einsum("bsd,df->bsf", x, w_up)
    h = _gelu(g) * u
    return torch.einsum("bsf,fd->bsd", h, w_down)
```

```asm
; @launch grid=(256,1,1) block=(256,1,1) lds=163840
.amdgcn_target "amdgcn-amd-amdhsa--gfx950"
.text
.globl standalone__glu_gated_geglu__prompt_kernel
.p2align 8
.type standalone__glu_gated_geglu__prompt_kernel,@function
standalone__glu_gated_geglu__prompt_kernel:
    s_cmp_ge_u32 s2, 256
    s_cbranch_scc1 L_end
    s_load_dwordx8 s[4:11], s[0:1], 0
    s_load_dwordx4 s[12:15], s[0:1], 32
    s_load_dwordx2 s[16:17], s[0:1], 48
    s_getpc_b64 s[18:19]
L_pc:
    s_add_u32 s100, s18, jobtab-L_pc
    s_addc_u32 s101, s19, 0
    s_lshl_b32 s3, s2, 6
    s_mov_b64 s[92:93], s[18:19]
    s_mov_b32 s95, 0x20000
    s_mov_b32 s94, 2048
    v_lshlrev_b32 v252, 7, v0
    buffer_load_dword v254, v252, s[92:95], 0 offen
    s_mov_b32 s94, L_spec-L_pc
    s_bfe_u32 s52, s2, 0x40003
    s_lshl_b32 s52, s52, 7
    v_lshlrev_b32 v252, 11, v0
    buffer_load_dword v254, v252, s[92:95], s52 offen
    s_mov_b32 s94, jobtab+16384-L_pc
    s_add_u32 s52, s3, jobtab-L_pc
    v_lshlrev_b32 v252, 20, v0
    buffer_load_dword v254, v252, s[92:95], s52 offen
    s_and_b32 s80, s2, 7
    s_lshr_b32 s81, s2, 3
    s_lshl_b32 s85, s80, 2
    s_lshr_b32 s85, 0x55100101, s85
    s_and_b32 s85, s85, 15
    s_cmp_lt_u32 s81, s85
    s_cselect_b32 s88, 99, 0
    s_mov_b32 s86, 0x27072707
    s_mov_b32 s87, 0x1e032708
    s_lshl_b32 s85, s80, 3
    s_lshr_b64 s[86:87], s[86:87], s85
    s_and_b32 s85, s86, 0xff
    s_add_u32 s82, s81, s85
    s_sub_u32 s82, s82, 8
    s_cmp_ge_u32 s80, 6
    s_cselect_b32 s86, 43, 37
    s_cselect_b32 s87, 6, 7
    s_mul_i32 s83, s82, s86
    s_lshr_b32 s83, s83, 8
    s_mul_i32 s85, s83, s87
    s_sub_u32 s84, s82, s85
    s_lshr_b32 s85, s80, 1
    s_mul_i32 s85, s85, 7
    s_add_u32 s84, s84, s85
    s_mul_i32 s89, s83, 286720
    s_lshl_b32 s96, s84, 7
    s_add_u32 s82, s84, s83
    s_mul_i32 s85, s82, 86
    s_lshr_b32 s85, s85, 8
    s_mul_i32 s85, s85, 3
    s_sub_u32 s82, s82, s85
    s_max_u32 s88, s88, s82
    s_mul_i32 s97, s84, 86
    v_lshrrev_b32 v1, 6, v0
    v_lshlrev_b32 v49, 7, v0
    v_and_b32 v0, 63, v0
    v_readfirstlane_b32 s48, v1
    s_mov_b32 s23, 0x20000
    s_mov_b32 s27, 0x20000
    s_mov_b32 s31, 0x20000
    s_lshl_b32 s49, s48, 10
    s_lshl_b32 s50, s48, 12
    v_lshrrev_b32 v2, 3, v0
    v_and_b32 v3, 7, v0
    v_and_b32 v4, 15, v0
    v_lshrrev_b32 v5, 4, v0
    v_bfe_u32 v6, v0, 2, 2
    v_and_b32 v7, 3, v0
    v_mov_b32 v9, 0
    s_lshl_b32 s52, s48, 3
    v_add_u32 v100, s52, v2
    v_bfe_u32 v101, v100, 1, 3
    v_xor_b32 v101, v101, v3
    v_mul_u32_u24 v10, 1280, v100
    v_lshl_add_u32 v10, v101, 4, v10
    v_mul_u32_u24 v100, 3456, v100
    s_and_b32 s52, s48, 1
    s_lshl_b32 s52, s52, 2
    v_and_b32 v101, 2, v2
    v_xor_b32 v101, v101, v3
    v_xor_b32 v17, s52, v101
    v_lshl_add_u32 v17, v17, 4, v100
    v_add_u32 v18, 110592, v17
    s_cmp_ge_u32 s88, 3
    s_cbranch_scc1 L_spec
    s_sub_u32 s22, 2621440, s89
    s_sub_u32 s26, 2211840, s96
    s_sub_u32 s30, 2211840, s96
    s_bitcmp1_b32 s97, 8
    s_cselect_b32 s52, 245760, 0
    s_mov_b32 s53, 40960
    s_cselect_b32 s53, -40960, s53
    s_cselect_b32 s54, 663552, 0
    s_mov_b32 s60, 110592
    s_cselect_b32 s60, -110592, s60
    v_add_u32 v10, s52, v10
    v_add_u32 v11, s53, v10
    v_add_u32 v12, s53, v11
    v_add_u32 v13, s53, v12
    v_add_u32 v14, s53, v13
    v_add_u32 v15, s53, v14
    v_add_u32 v16, s53, v15
    s_movk_i32 s80, 0
    s_movk_i32 s81, 256
    s_cmp_eq_u32 s88, 1
    s_cmovk_i32 s81, 128
    s_cmp_eq_u32 s88, 2
    s_cmovk_i32 s80, 128
    s_cmovk_i32 s81, 0
    s_mul_i32 s51, s80, 1728
    s_waitcnt lgkmcnt(0)
    s_add_u32 s24, s6, s96
    s_addc_u32 s25, s7, 0
    s_add_u32 s28, s8, s96
    s_addc_u32 s29, s9, 0
    s_add_u32 s20, s4, s89
    s_addc_u32 s21, s5, 0
    s_add_u32 m0, s49, 0
    s_nop 0
    buffer_load_dwordx4 v17, s[24:27], s51 offen lds
    s_add_u32 m0, s49, 4096
    s_nop 0
    buffer_load_dwordx4 v17, s[28:31], s51 offen lds
    s_add_u32 m0, s49, 8192
    s_nop 0
    buffer_load_dwordx4 v18, s[24:27], s51 offen lds
    s_add_u32 m0, s49, 12288
    s_nop 0
    buffer_load_dwordx4 v18, s[28:31], s51 offen lds
    s_load_dwordx16 s[64:79], s[100:101], s3
    s_add_u32 m0, s49, 16384
    s_nop 0
    buffer_load_dwordx4 v10, s[20:23], s80 offen lds
    s_add_u32 m0, s49, 20480
    s_nop 0
    buffer_load_dwordx4 v11, s[20:23], s80 offen lds
    s_add_u32 m0, s49, 24576
    s_nop 0
    buffer_load_dwordx4 v12, s[20:23], s80 offen lds
    s_add_u32 m0, s49, 28672
    s_nop 0
    buffer_load_dwordx4 v13, s[20:23], s80 offen lds
    s_mov_b64 s[32:33], s[10:11]
    s_mov_b64 s[36:37], s[12:13]
    s_mov_b64 s[44:45], s[14:15]
    s_mov_b64 s[40:41], s[16:17]
    s_mov_b32 s34, 2211840
    s_mov_b32 s35, 0x20000
    s_mov_b32 s38, 2621440
    s_mov_b32 s39, 0x20000
    s_mov_b32 s42, 8423168
    s_mov_b32 s43, 0x20000
    s_mov_b32 s46, 256
    s_mov_b32 s47, 0x20000
    s_mov_b32 s62, 0xbdd2d3e8
    s_mov_b32 s63, 0xc0135761
    s_mul_i32 s52, s48, 448
    v_add_u32 v100, s52, v2
    v_mul_u32_u24 v100, 1280, v100
    v_and_b32 v101, 6, v2
    v_xor_b32 v101, v101, v3
    v_lshl_add_u32 v19, v101, 4, v100
    v_add_u32 v20, 10240, v19
    v_lshrrev_b32 v100, 1, v4
    v_xor_b32 v100, v100, v5
    v_lshlrev_b32 v100, 4, v100
    v_lshl_add_u32 v23, v4, 7, v100
    s_lshr_b32 s52, s48, 1
    s_lshl_b32 s52, s52, 11
    v_add_u32 v23, s52, v23
    v_xor_b32 v24, 64, v23
    v_lshrrev_b32 v100, 1, v6
    v_and_b32 v101, 1, v5
    v_lshl_or_b32 v100, v101, 1, v100
    v_lshlrev_b32 v100, 5, v100
    v_lshl_add_u32 v100, v7, 3, v100
    v_lshl_add_u32 v101, v5, 3, v6
    v_lshl_add_u32 v29, v101, 7, v100
    s_and_b32 s52, s48, 1
    s_lshl_b32 s52, s52, 6
    v_xor_b32 v29, s52, v29
    v_lshl_add_u32 v101, v5, 2, v6
    v_lshl_add_u32 v32, v101, 7, v100
    s_lshl_b32 s52, s48, 5
    v_xor_b32 v32, s52, v32
    v_add_u32 v32, s50, v32
    v_add_u32 v25, 65536, v23
    v_add_u32 v26, 65536, v24
    v_add_u32 v30, 65536, v29
    v_add_u32 v27, 131072, v23
    v_add_u32 v28, 131072, v24
    v_add_u32 v31, 131072, v29
    v_xor_b32 v104, 32, v29
    v_xor_b32 v105, 32, v30
    v_xor_b32 v106, 32, v31
    s_add_u32 m0, s49, 32768
    s_nop 0
    buffer_load_dwordx4 v14, s[20:23], s80 offen lds
    s_add_u32 m0, s49, 36864
    s_nop 0
    buffer_load_dwordx4 v15, s[20:23], s80 offen lds
    s_add_u32 m0, s49, 40960
    s_nop 0
    buffer_load_dwordx4 v16, s[20:23], s80 offen lds
    s_mul_i32 s51, s81, 1728
    s_add_u32 m0, s49, 45056
    s_nop 0
    buffer_load_dwordx4 v17, s[24:27], s51 offen lds
    s_waitcnt lgkmcnt(0)
    v_xor_b32 v33, 32, v32
    v_xor_b32 v34, 64, v32
    v_xor_b32 v35, 96, v32
    v_add_u32 v36, 65536, v32
    v_add_u32 v37, 65536, v33
    v_add_u32 v38, 65536, v34
    v_add_u32 v39, 65536, v35
    v_add_u32 v40, 131072, v32
    v_add_u32 v41, 131072, v33
    v_add_u32 v42, 131072, v34
    v_add_u32 v43, 131072, v35
    v_add_u32 v19, s70, v19
    v_add_u32 v20, s70, v20
    v_add_u32 v21, 20480, v19
    v_add_u32 v22, 20480, v20
    s_lshr_b32 s52, s48, 1
    s_mul_i32 s52, s52, 53248
    s_add_u32 s52, s52, s49
    s_add_u32 s52, s52, s68
    v_lshlrev_b32 v100, 4, v0
    v_add_u32 v44, s52, v100
    s_mul_i32 s52, s48, 14336
    v_add_u32 v45, s52, v100
    s_cmp_eq_u32 s48, 3
    s_cselect_b32 s53, 5, 6
    s_movk_i32 s56, 14336
    s_cselect_b32 s56, 12288, s56
    s_lshl_b32 s52, s48, 2
    v_add_u32 v100, s52, v5
    v_xor_b32 v100, v100, v4
    v_lshlrev_b32 v100, 4, v100
    v_lshl_add_u32 v100, v4, 8, v100
    v_add_u32 v50, s50, v100
    s_and_b32 s52, s48, 1
    s_lshl_b32 s52, s52, 3
    v_add_u32 v100, s52, v2
    v_lshlrev_b32 v102, 1, v3
    v_xor_b32 v102, v102, v100
    v_lshlrev_b32 v102, 4, v102
    v_lshl_add_u32 v102, v100, 8, v102
    s_lshr_b32 s52, s48, 1
    s_lshl_b32 s52, s52, 14
    v_add_u32 v253, s52, v102
    v_mul_u32_u24 v100, 1280, v100
    v_lshl_add_u32 v100, v3, 4, v100
    v_add_u32 v51, s70, v100
    v_lshl_add_u32 v102, v2, 3, 8
    v_lshrrev_b32 v100, v102, s71
    v_and_b32 v100, 0x7f, v100
    v_lshrrev_b32 v100, 1, v100
    v_mul_u32_u24 v102, 37, v100
    v_lshrrev_b32 v102, 8, v102
    v_mul_u32_u24 v48, 7, v102
    v_sub_u32 v48, v100, v48
    v_mul_u32_u24 v102, 27, v102
    v_min_u32 v100, s53, v3
    s_mul_i32 s52, s48, 7
    v_add3_u32 v100, v100, v102, s52
    v_lshlrev_b32 v100, 7, v100
    v_add_u32 v47, 8388608, v100
    s_add_u32 s69, s69, 8388608
    s_lshl_b32 s52, s48, 2
    s_add_u32 s69, s69, s52
L_code_c0:
    s_add_u32 m0, s49, 49152
    s_nop 0
    buffer_load_dwordx4 v17, s[28:31], s51 offen lds
    s_add_u32 m0, s49, 53248
    s_nop 0
    buffer_load_dwordx4 v18, s[24:27], s51 offen lds
    s_add_u32 m0, s49, 57344
    s_nop 0
    buffer_load_dwordx4 v18, s[28:31], s51 offen lds
    s_add_u32 m0, s49, 61440
    s_nop 0
    buffer_load_dwordx4 v10, s[20:23], s81 offen lds
    s_add_u32 m0, s49, 65536
    s_nop 0
    buffer_load_dwordx4 v11, s[20:23], s81 offen lds
    s_branch L_pg0
    .p2align 12
L_pg0:
    s_waitcnt vmcnt(9)
    s_barrier
    ds_read_b64_tr_b16 a[0:1], v29 offset:0
    ds_read_b64_tr_b16 a[2:3], v29 offset:512
    ds_read_b128 v[52:55], v23 offset:16384
    ds_read_b64_tr_b16 a[16:17], v29 offset:8192
    ds_read_b64_tr_b16 a[18:19], v29 offset:8704
    ds_read_b128 v[56:59], v24 offset:16384
    ds_read_b64_tr_b16 a[20:21], v29 offset:12288
    ds_read_b64_tr_b16 a[22:23], v29 offset:12800
    ds_read_b64_tr_b16 a[4:5], v29 offset:4096
    ds_read_b64_tr_b16 a[6:7], v29 offset:4608
    ds_read_b64_tr_b16 a[8:9], v104 offset:0
    ds_read_b64_tr_b16 a[10:11], v104 offset:512
    ds_read_b64_tr_b16 a[24:25], v104 offset:8192
    ds_read_b64_tr_b16 a[26:27], v104 offset:8704
    ds_read_b64_tr_b16 a[28:29], v104 offset:12288
    s_waitcnt lgkmcnt(12)
    v_mfma_f32_16x16x32_bf16 v[204:207], a[0:3], v[52:55], 0
    ds_read_b64_tr_b16 a[30:31], v104 offset:12800
    ds_read_b64_tr_b16 a[12:13], v104 offset:4096
    s_waitcnt lgkmcnt(11)
    v_mfma_f32_16x16x32_bf16 v[204:207], a[16:19], v[56:59], v[204:207]
    ds_read_b64_tr_b16 a[14:15], v104 offset:4608
    ds_read_b128 v[60:63], v23 offset:20480
    s_waitcnt lgkmcnt(11)
    v_mfma_f32_16x16x32_bf16 v[208:211], a[20:23], v[56:59], 0
    ds_read_b128 v[64:67], v24 offset:20480
    s_add_u32 m0, s49, 69632
    s_waitcnt lgkmcnt(10)
    v_mfma_f32_16x16x32_bf16 v[208:211], a[4:7], v[52:55], v[208:211]
    buffer_load_dwordx4 v12, s[20:23], s81 offen lds
    s_waitcnt lgkmcnt(8)
    v_mfma_f32_16x16x32_bf16 v[212:215], a[8:11], v[52:55], 0
    ds_read_b128 v[68:71], v23 offset:24576
    s_waitcnt lgkmcnt(7)
    v_mfma_f32_16x16x32_bf16 v[212:215], a[24:27], v[56:59], v[212:215]
    ds_read_b128 v[72:75], v24 offset:24576
    s_waitcnt lgkmcnt(6)
    v_mfma_f32_16x16x32_bf16 v[216:219], a[28:31], v[56:59], 0
    s_add_u32 m0, s49, 73728
    s_waitcnt lgkmcnt(4)
    v_mfma_f32_16x16x32_bf16 v[216:219], a[12:15], v[52:55], v[216:219]
    buffer_load_dwordx4 v13, s[20:23], s81 offen lds
    s_waitcnt lgkmcnt(2)
    v_mfma_f32_16x16x32_bf16 v[188:191], a[0:3], v[60:63], 0
    ds_read_b128 v[76:79], v23 offset:28672
    v_mfma_f32_16x16x32_bf16 v[188:191], a[16:19], v[64:67], v[188:191]
    ds_read_b128 v[80:83], v24 offset:28672
    v_mfma_f32_16x16x32_bf16 v[192:195], a[20:23], v[64:67], 0
    s_add_u32 m0, s49, 77824
    v_mfma_f32_16x16x32_bf16 v[192:195], a[4:7], v[60:63], v[192:195]
    buffer_load_dwordx4 v14, s[20:23], s81 offen lds
    v_mfma_f32_16x16x32_bf16 v[196:199], a[8:11], v[60:63], 0
    v_mfma_f32_16x16x32_bf16 v[196:199], a[24:27], v[64:67], v[196:199]
    v_mfma_f32_16x16x32_bf16 v[200:203], a[28:31], v[64:67], 0
    s_add_u32 m0, s49, 81920
    v_mfma_f32_16x16x32_bf16 v[200:203], a[12:15], v[60:63], v[200:203]
    buffer_load_dwordx4 v15, s[20:23], s81 offen lds
    s_waitcnt lgkmcnt(2)
    v_mfma_f32_16x16x32_bf16 v[172:175], a[0:3], v[68:71], 0
    s_waitcnt vmcnt(10) lgkmcnt(0)
    s_barrier
    v_mfma_f32_16x16x32_bf16 v[172:175], a[16:19], v[72:75], v[172:175]
    ds_read_b128 v[84:87], v23 offset:32768
    v_mfma_f32_16x16x32_bf16 v[176:179], a[20:23], v[72:75], 0
    ds_read_b128 v[88:91], v24 offset:32768
    s_add_u32 m0, s49, 86016
    v_mfma_f32_16x16x32_bf16 v[176:179], a[4:7], v[68:71], v[176:179]
    buffer_load_dwordx4 v16, s[20:23], s81 offen lds
    v_mfma_f32_16x16x32_bf16 v[180:183], a[8:11], v[68:71], 0
    v_mfma_f32_16x16x32_bf16 v[180:183], a[24:27], v[72:75], v[180:183]
    v_mfma_f32_16x16x32_bf16 v[184:187], a[28:31], v[72:75], 0
    s_bfe_u32 s82, s67, 0x40008
    s_lshl_b32 s82, s82, 7
    s_mul_i32 s51, s82, 1728
    s_add_u32 m0, s49, 90112
    v_mfma_f32_16x16x32_bf16 v[184:187], a[12:15], v[68:71], v[184:187]
    buffer_load_dwordx4 v17, s[24:27], s51 offen lds
    v_mfma_f32_16x16x32_bf16 v[156:159], a[0:3], v[76:79], 0
    ds_read_b128 v[92:95], v23 offset:36864
    v_mfma_f32_16x16x32_bf16 v[156:159], a[16:19], v[80:83], v[156:159]
    ds_read_b128 v[96:99], v24 offset:36864
    v_mfma_f32_16x16x32_bf16 v[160:163], a[20:23], v[80:83], 0
    s_add_u32 m0, s49, 94208
    v_mfma_f32_16x16x32_bf16 v[160:163], a[4:7], v[76:79], v[160:163]
    buffer_load_dwordx4 v17, s[28:31], s51 offen lds
    v_mfma_f32_16x16x32_bf16 v[164:167], a[8:11], v[76:79], 0
    v_mfma_f32_16x16x32_bf16 v[164:167], a[24:27], v[80:83], v[164:167]
    v_mfma_f32_16x16x32_bf16 v[168:171], a[28:31], v[80:83], 0
    s_add_u32 m0, s49, 98304
    v_mfma_f32_16x16x32_bf16 v[168:171], a[12:15], v[76:79], v[168:171]
    buffer_load_dwordx4 v18, s[24:27], s51 offen lds
    s_waitcnt lgkmcnt(2)
    v_mfma_f32_16x16x32_bf16 v[140:143], a[0:3], v[84:87], 0
    ds_read_b128 v[52:55], v23 offset:40960
    v_mfma_f32_16x16x32_bf16 v[140:143], a[16:19], v[88:91], v[140:143]
    ds_read_b128 v[56:59], v24 offset:40960
    v_mfma_f32_16x16x32_bf16 v[144:147], a[20:23], v[88:91], 0
    s_add_u32 m0, s49, 102400
    v_mfma_f32_16x16x32_bf16 v[144:147], a[4:7], v[84:87], v[144:147]
    buffer_load_dwordx4 v18, s[28:31], s51 offen lds
    v_mfma_f32_16x16x32_bf16 v[148:151], a[8:11], v[84:87], 0
    v_mfma_f32_16x16x32_bf16 v[148:151], a[24:27], v[88:91], v[148:151]
    v_mfma_f32_16x16x32_bf16 v[152:155], a[28:31], v[88:91], 0
    s_add_u32 m0, s49, 106496
    v_mfma_f32_16x16x32_bf16 v[152:155], a[12:15], v[84:87], v[152:155]
    buffer_load_dwordx4 v10, s[20:23], s82 offen lds
    s_waitcnt lgkmcnt(2)
    v_mfma_f32_16x16x32_bf16 v[124:127], a[0:3], v[92:95], 0
    s_waitcnt vmcnt(8) lgkmcnt(0)
    s_barrier
    ds_read_b64_tr_b16 a[32:33], v29 offset:45056
    v_mfma_f32_16x16x32_bf16 v[124:127], a[16:19], v[96:99], v[124:127]
    ds_read_b64_tr_b16 a[34:35], v29 offset:45568
    ds_read_b128 v[60:63], v23 offset:61440
    v_mfma_f32_16x16x32_bf16 v[128:131], a[20:23], v[96:99], 0
    ds_read_b64_tr_b16 a[48:49], v29 offset:53248
    ds_read_b64_tr_b16 a[50:51], v29 offset:53760
    v_mfma_f32_16x16x32_bf16 v[128:131], a[4:7], v[92:95], v[128:131]
    ds_read_b128 v[64:67], v24 offset:61440
    ds_read_b64_tr_b16 a[52:53], v29 offset:57344
    v_mfma_f32_16x16x32_bf16 v[132:135], a[8:11], v[92:95], 0
    ds_read_b64_tr_b16 a[54:55], v29 offset:57856
    ds_read_b64_tr_b16 a[36:37], v29 offset:49152
    v_mfma_f32_16x16x32_bf16 v[132:135], a[24:27], v[96:99], v[132:135]
    ds_read_b64_tr_b16 a[38:39], v29 offset:49664
    ds_read_b64_tr_b16 a[40:41], v104 offset:45056
    v_mfma_f32_16x16x32_bf16 v[136:139], a[28:31], v[96:99], 0
    ds_read_b64_tr_b16 a[42:43], v104 offset:45568
    ds_read_b64_tr_b16 a[56:57], v104 offset:53248
    v_mfma_f32_16x16x32_bf16 v[136:139], a[12:15], v[92:95], v[136:139]
    ds_read_b64_tr_b16 a[58:59], v104 offset:53760
    ds_read_b64_tr_b16 a[60:61], v104 offset:57344
    v_mfma_f32_16x16x32_bf16 v[108:111], a[0:3], v[52:55], 0
    ds_read_b64_tr_b16 a[62:63], v104 offset:57856
    ds_read_b64_tr_b16 a[44:45], v104 offset:49152
    v_mfma_f32_16x16x32_bf16 v[108:111], a[16:19], v[56:59], v[108:111]
    ds_read_b64_tr_b16 a[46:47], v104 offset:49664
    s_add_u32 m0, s49, 110592
    v_mfma_f32_16x16x32_bf16 v[112:115], a[20:23], v[56:59], 0
    buffer_load_dwordx4 v11, s[20:23], s82 offen lds
    v_mfma_f32_16x16x32_bf16 v[112:115], a[4:7], v[52:55], v[112:115]
    ds_read_b128 v[68:71], v25 offset:0
    v_mfma_f32_16x16x32_bf16 v[116:119], a[8:11], v[52:55], 0
    ds_read_b128 v[72:75], v26 offset:0
    v_mfma_f32_16x16x32_bf16 v[116:119], a[24:27], v[56:59], v[116:119]
    s_add_u32 m0, s49, 114688
    v_mfma_f32_16x16x32_bf16 v[120:123], a[28:31], v[56:59], 0
    buffer_load_dwordx4 v12, s[20:23], s82 offen lds
    v_mfma_f32_16x16x32_bf16 v[120:123], a[12:15], v[52:55], v[120:123]
    s_and_b32 s91, s71, 0xff
    s_lshl_b32 s91, s91, 10
    s_waitcnt lgkmcnt(15)
    v_mfma_f32_16x16x32_bf16 v[204:207], a[32:35], v[60:63], v[204:207]
    ds_read_b128 v[76:79], v25 offset:4096
    s_waitcnt lgkmcnt(15)
    v_mfma_f32_16x16x32_bf16 v[204:207], a[48:51], v[64:67], v[204:207]
    ds_read_b128 v[80:83], v26 offset:4096
    s_add_u32 m0, s49, 118784
    s_waitcnt lgkmcnt(14)
    v_mfma_f32_16x16x32_bf16 v[208:211], a[52:55], v[64:67], v[208:211]
    buffer_load_dwordx4 v13, s[20:23], s82 offen lds
    s_waitcnt lgkmcnt(12)
    v_mfma_f32_16x16x32_bf16 v[208:211], a[36:39], v[60:63], v[208:211]
    s_cmp_ge_u32 s91, s56
    s_cselect_b32 s4, 0x2000000, s91
    s_waitcnt lgkmcnt(10)
    v_mfma_f32_16x16x32_bf16 v[212:215], a[40:43], v[60:63], v[212:215]
    s_add_u32 s91, s91, 1024
    s_cmp_eq_u32 s91, 14336
    s_cselect_b32 s91, 0, s91
    s_waitcnt lgkmcnt(8)
    v_mfma_f32_16x16x32_bf16 v[212:215], a[56:59], v[64:67], v[212:215]
    s_add_u32 m0, s49, 122880
    s_waitcnt lgkmcnt(6)
    v_mfma_f32_16x16x32_bf16 v[216:219], a[60:63], v[64:67], v[216:219]
    buffer_load_dwordx4 v14, s[20:23], s82 offen lds
    s_waitcnt lgkmcnt(4)
    v_mfma_f32_16x16x32_bf16 v[216:219], a[44:47], v[60:63], v[216:219]
    s_cmp_ge_u32 s91, s56
    s_cselect_b32 s5, 0x2000000, s91
    s_waitcnt lgkmcnt(2)
    v_mfma_f32_16x16x32_bf16 v[188:191], a[32:35], v[68:71], v[188:191]
    ds_read_b128 v[84:87], v25 offset:8192
    v_mfma_f32_16x16x32_bf16 v[188:191], a[48:51], v[72:75], v[188:191]
    ds_read_b128 v[88:91], v26 offset:8192
    s_add_u32 m0, s49, 126976
    v_mfma_f32_16x16x32_bf16 v[192:195], a[52:55], v[72:75], v[192:195]
    buffer_load_dwordx4 v15, s[20:23], s82 offen lds
    v_mfma_f32_16x16x32_bf16 v[192:195], a[36:39], v[68:71], v[192:195]
    s_add_u32 s91, s91, 1024
    s_cmp_eq_u32 s91, 14336
    s_cselect_b32 s91, 0, s91
    v_mfma_f32_16x16x32_bf16 v[196:199], a[40:43], v[68:71], v[196:199]
    s_cmp_ge_u32 s91, s56
    s_cselect_b32 s6, 0x2000000, s91
    v_mfma_f32_16x16x32_bf16 v[196:199], a[56:59], v[72:75], v[196:199]
    s_add_u32 m0, s49, 131072
    v_mfma_f32_16x16x32_bf16 v[200:203], a[60:63], v[72:75], v[200:203]
    buffer_load_dwordx4 v16, s[20:23], s82 offen lds
    v_mfma_f32_16x16x32_bf16 v[200:203], a[44:47], v[68:71], v[200:203]
    s_add_u32 s91, s91, 1024
    s_cmp_eq_u32 s91, 14336
    s_cselect_b32 s91, 0, s91
    s_waitcnt lgkmcnt(2)
    v_mfma_f32_16x16x32_bf16 v[172:175], a[32:35], v[76:79], v[172:175]
    s_waitcnt vmcnt(11) lgkmcnt(0)
    s_barrier
    s_bfe_u32 s83, s67, 0x4000c
    s_lshl_b32 s83, s83, 7
    s_mul_i32 s51, s83, 1728
    s_add_u32 m0, s49, 135168
    v_mfma_f32_16x16x32_bf16 v[172:175], a[48:51], v[80:83], v[172:175]
    buffer_load_dwordx4 v17, s[24:27], s51 offen lds
    v_mfma_f32_16x16x32_bf16 v[176:179], a[52:55], v[80:83], v[176:179]
    ds_read_b128 v[92:95], v25 offset:12288
    v_mfma_f32_16x16x32_bf16 v[176:179], a[36:39], v[76:79], v[176:179]
    ds_read_b128 v[96:99], v26 offset:12288
    v_mfma_f32_16x16x32_bf16 v[180:183], a[40:43], v[76:79], v[180:183]
    s_add_u32 m0, s49, 139264
    v_mfma_f32_16x16x32_bf16 v[180:183], a[56:59], v[80:83], v[180:183]
    buffer_load_dwordx4 v17, s[28:31], s51 offen lds
    v_mfma_f32_16x16x32_bf16 v[184:187], a[60:63], v[80:83], v[184:187]
    s_cmp_ge_u32 s91, s56
    s_cselect_b32 s7, 0x2000000, s91
    v_mfma_f32_16x16x32_bf16 v[184:187], a[44:47], v[76:79], v[184:187]
    s_add_u32 s91, s91, 1024
    s_cmp_eq_u32 s91, 14336
    s_cselect_b32 s91, 0, s91
    v_mfma_f32_16x16x32_bf16 v[156:159], a[32:35], v[84:87], v[156:159]
    ds_read_b128 v[52:55], v25 offset:16384
    s_add_u32 m0, s49, 143360
    v_mfma_f32_16x16x32_bf16 v[156:159], a[48:51], v[88:91], v[156:159]
    buffer_load_dwordx4 v18, s[24:27], s51 offen lds
    v_mfma_f32_16x16x32_bf16 v[160:163], a[52:55], v[88:91], v[160:163]
    ds_read_b128 v[56:59], v26 offset:16384
    v_mfma_f32_16x16x32_bf16 v[160:163], a[36:39], v[84:87], v[160:163]
    s_cmp_ge_u32 s91, s56
    s_cselect_b32 s8, 0x2000000, s91
    v_mfma_f32_16x16x32_bf16 v[164:167], a[40:43], v[84:87], v[164:167]
    s_add_u32 m0, s49, 147456
    v_mfma_f32_16x16x32_bf16 v[164:167], a[56:59], v[88:91], v[164:167]
    buffer_load_dwordx4 v18, s[28:31], s51 offen lds
    v_mfma_f32_16x16x32_bf16 v[168:171], a[60:63], v[88:91], v[168:171]
    s_add_u32 s91, s91, 1024
    s_cmp_eq_u32 s91, 14336
    s_cselect_b32 s91, 0, s91
    v_mfma_f32_16x16x32_bf16 v[168:171], a[44:47], v[84:87], v[168:171]
    s_cmp_ge_u32 s91, s56
    s_cselect_b32 s9, 0x2000000, s91
    s_waitcnt lgkmcnt(2)
    v_mfma_f32_16x16x32_bf16 v[140:143], a[32:35], v[92:95], v[140:143]
    ds_read_b128 v[60:63], v25 offset:20480
    s_add_u32 m0, s49, 151552
    v_mfma_f32_16x16x32_bf16 v[140:143], a[48:51], v[96:99], v[140:143]
    buffer_load_dwordx4 v10, s[20:23], s83 offen lds
    v_mfma_f32_16x16x32_bf16 v[144:147], a[52:55], v[96:99], v[144:147]
    ds_read_b128 v[64:67], v26 offset:20480
    v_mfma_f32_16x16x32_bf16 v[144:147], a[36:39], v[92:95], v[144:147]
    s_add_u32 s91, s91, 1024
    s_cmp_eq_u32 s91, 14336
    s_cselect_b32 s91, 0, s91
    v_mfma_f32_16x16x32_bf16 v[148:151], a[40:43], v[92:95], v[148:151]
    s_add_u32 m0, s49, 155648
    v_mfma_f32_16x16x32_bf16 v[148:151], a[56:59], v[96:99], v[148:151]
    buffer_load_dwordx4 v11, s[20:23], s83 offen lds
    v_mfma_f32_16x16x32_bf16 v[152:155], a[60:63], v[96:99], v[152:155]
    s_cmp_ge_u32 s91, s56
    s_cselect_b32 s10, 0x2000000, s91
    v_mfma_f32_16x16x32_bf16 v[152:155], a[44:47], v[92:95], v[152:155]
    s_add_u32 s91, s91, 1024
    s_cmp_eq_u32 s91, 14336
    s_cselect_b32 s91, 0, s91
    s_waitcnt lgkmcnt(2)
    v_mfma_f32_16x16x32_bf16 v[124:127], a[32:35], v[52:55], v[124:127]
    s_add_u32 m0, s49, 159744
    s_nop 0
    buffer_load_dwordx4 v12, s[20:23], s83 offen lds
    s_add_u32 m0, s49, 0
    s_nop 0
    buffer_load_dwordx4 v13, s[20:23], s83 offen lds
    s_add_u32 m0, s49, 4096
    s_nop 0
    buffer_load_dwordx4 v14, s[20:23], s83 offen lds
    s_add_u32 m0, s49, 8192
    s_nop 0
    buffer_load_dwordx4 v15, s[20:23], s83 offen lds
    s_waitcnt vmcnt(10) lgkmcnt(0)
    s_barrier
    ds_read_b64_tr_b16 a[64:65], v30 offset:24576
    v_mfma_f32_16x16x32_bf16 v[124:127], a[48:51], v[56:59], v[124:127]
    ds_read_b64_tr_b16 a[66:67], v30 offset:25088
    ds_read_b128 v[68:71], v25 offset:40960
    v_mfma_f32_16x16x32_bf16 v[128:131], a[52:55], v[56:59], v[128:131]
    ds_read_b64_tr_b16 a[80:81], v30 offset:32768
    ds_read_b64_tr_b16 a[82:83], v30 offset:33280
    v_mfma_f32_16x16x32_bf16 v[128:131], a[36:39], v[52:55], v[128:131]
    ds_read_b128 v[72:75], v26 offset:40960
    ds_read_b64_tr_b16 a[84:85], v30 offset:36864
    v_mfma_f32_16x16x32_bf16 v[132:135], a[40:43], v[52:55], v[132:135]
    ds_read_b64_tr_b16 a[86:87], v30 offset:37376
    ds_read_b64_tr_b16 a[68:69], v30 offset:28672
    v_mfma_f32_16x16x32_bf16 v[132:135], a[56:59], v[56:59], v[132:135]
    ds_read_b64_tr_b16 a[70:71], v30 offset:29184
    ds_read_b64_tr_b16 a[72:73], v105 offset:24576
    v_mfma_f32_16x16x32_bf16 v[136:139], a[60:63], v[56:59], v[136:139]
    ds_read_b64_tr_b16 a[74:75], v105 offset:25088
    ds_read_b64_tr_b16 a[88:89], v105 offset:32768
    v_mfma_f32_16x16x32_bf16 v[136:139], a[44:47], v[52:55], v[136:139]
    ds_read_b64_tr_b16 a[90:91], v105 offset:33280
    ds_read_b64_tr_b16 a[92:93], v105 offset:36864
    v_mfma_f32_16x16x32_bf16 v[108:111], a[32:35], v[60:63], v[108:111]
    ds_read_b64_tr_b16 a[94:95], v105 offset:37376
    ds_read_b64_tr_b16 a[76:77], v105 offset:28672
    v_mfma_f32_16x16x32_bf16 v[108:111], a[48:51], v[64:67], v[108:111]
    ds_read_b64_tr_b16 a[78:79], v105 offset:29184
    s_add_u32 m0, s49, 12288
    v_mfma_f32_16x16x32_bf16 v[112:115], a[52:55], v[64:67], v[112:115]
    buffer_load_dwordx4 v16, s[20:23], s83 offen lds
    v_mfma_f32_16x16x32_bf16 v[112:115], a[36:39], v[60:63], v[112:115]
    ds_read_b128 v[76:79], v25 offset:45056
    v_mfma_f32_16x16x32_bf16 v[116:119], a[40:43], v[60:63], v[116:119]
    ds_read_b128 v[80:83], v26 offset:45056
    v_mfma_f32_16x16x32_bf16 v[116:119], a[56:59], v[64:67], v[116:119]
    s_bfe_u32 s84, s67, 0x40010
    s_lshl_b32 s84, s84, 7
    s_mul_i32 s51, s84, 1728
    s_add_u32 m0, s49, 16384
    v_mfma_f32_16x16x32_bf16 v[120:123], a[60:63], v[64:67], v[120:123]
    buffer_load_dwordx4 v17, s[24:27], s51 offen lds
    v_mfma_f32_16x16x32_bf16 v[120:123], a[44:47], v[60:63], v[120:123]
    s_cmp_ge_u32 s91, s56
    s_cselect_b32 s11, 0x2000000, s91
    s_waitcnt lgkmcnt(15)
    v_mfma_f32_16x16x32_bf16 v[204:207], a[64:67], v[68:71], v[204:207]
    ds_read_b128 v[84:87], v25 offset:49152
    s_waitcnt lgkmcnt(15)
    v_mfma_f32_16x16x32_bf16 v[204:207], a[80:83], v[72:75], v[204:207]
    ds_read_b128 v[88:91], v26 offset:49152
    s_add_u32 m0, s49, 20480
    s_waitcnt lgkmcnt(14)
    v_mfma_f32_16x16x32_bf16 v[208:211], a[84:87], v[72:75], v[208:211]
    buffer_load_dwordx4 v17, s[28:31], s51 offen lds
    s_waitcnt lgkmcnt(12)
    v_mfma_f32_16x16x32_bf16 v[208:211], a[68:71], v[68:71], v[208:211]
    s_add_u32 s91, s91, 1024
    s_cmp_eq_u32 s91, 14336
    s_cselect_b32 s91, 0, s91
    s_waitcnt lgkmcnt(10)
    v_mfma_f32_16x16x32_bf16 v[212:215], a[72:75], v[68:71], v[212:215]
    s_cmp_ge_u32 s91, s56
    s_cselect_b32 s12, 0x2000000, s91
    s_waitcnt lgkmcnt(8)
    v_mfma_f32_16x16x32_bf16 v[212:215], a[88:91], v[72:75], v[212:215]
    s_add_u32 m0, s49, 24576
    s_waitcnt lgkmcnt(6)
    v_mfma_f32_16x16x32_bf16 v[216:219], a[92:95], v[72:75], v[216:219]
    buffer_load_dwordx4 v18, s[24:27], s51 offen lds
    s_waitcnt lgkmcnt(4)
    v_mfma_f32_16x16x32_bf16 v[216:219], a[76:79], v[68:71], v[216:219]
    s_add_u32 s91, s91, 1024
    s_cmp_eq_u32 s91, 14336
    s_cselect_b32 s91, 0, s91
    s_waitcnt lgkmcnt(2)
    v_mfma_f32_16x16x32_bf16 v[188:191], a[64:67], v[76:79], v[188:191]
    ds_read_b128 v[92:95], v25 offset:53248
    s_add_u32 m0, s49, 28672
    v_mfma_f32_16x16x32_bf16 v[188:191], a[80:83], v[80:83], v[188:191]
    buffer_load_dwordx4 v18, s[28:31], s51 offen lds
    v_mfma_f32_16x16x32_bf16 v[192:195], a[84:87], v[80:83], v[192:195]
    ds_read_b128 v[96:99], v26 offset:53248
    v_mfma_f32_16x16x32_bf16 v[192:195], a[68:71], v[76:79], v[192:195]
    s_cmp_ge_u32 s91, s56
    s_cselect_b32 s13, 0x2000000, s91
    v_mfma_f32_16x16x32_bf16 v[196:199], a[72:75], v[76:79], v[196:199]
    s_add_u32 m0, s49, 32768
    v_mfma_f32_16x16x32_bf16 v[196:199], a[88:91], v[80:83], v[196:199]
    buffer_load_dwordx4 v10, s[20:23], s84 offen lds
    v_mfma_f32_16x16x32_bf16 v[200:203], a[92:95], v[80:83], v[200:203]
    s_add_u32 s91, s91, 1024
    s_cmp_eq_u32 s91, 14336
    s_cselect_b32 s91, 0, s91
    v_mfma_f32_16x16x32_bf16 v[200:203], a[76:79], v[76:79], v[200:203]
    s_cmp_ge_u32 s91, s56
    s_cselect_b32 s14, 0x2000000, s91
    s_waitcnt lgkmcnt(2)
    v_mfma_f32_16x16x32_bf16 v[172:175], a[64:67], v[84:87], v[172:175]
    ds_read_b128 v[52:55], v25 offset:57344
    s_add_u32 m0, s49, 36864
    v_mfma_f32_16x16x32_bf16 v[172:175], a[80:83], v[88:91], v[172:175]
    buffer_load_dwordx4 v11, s[20:23], s84 offen lds
    v_mfma_f32_16x16x32_bf16 v[176:179], a[84:87], v[88:91], v[176:179]
    ds_read_b128 v[56:59], v26 offset:57344
    v_mfma_f32_16x16x32_bf16 v[176:179], a[68:71], v[84:87], v[176:179]
    s_add_u32 s91, s91, 1024
    s_cmp_eq_u32 s91, 14336
    s_cselect_b32 s91, 0, s91
    v_mfma_f32_16x16x32_bf16 v[180:183], a[72:75], v[84:87], v[180:183]
    s_add_u32 m0, s49, 40960
    v_mfma_f32_16x16x32_bf16 v[180:183], a[88:91], v[88:91], v[180:183]
    buffer_load_dwordx4 v12, s[20:23], s84 offen lds
    v_mfma_f32_16x16x32_bf16 v[184:187], a[92:95], v[88:91], v[184:187]
    s_cmp_ge_u32 s91, s56
    s_cselect_b32 s15, 0x2000000, s91
    v_mfma_f32_16x16x32_bf16 v[184:187], a[76:79], v[84:87], v[184:187]
    s_add_u32 s91, s91, 1024
    s_cmp_eq_u32 s91, 14336
    s_cselect_b32 s91, 0, s91
    s_waitcnt lgkmcnt(2)
    v_mfma_f32_16x16x32_bf16 v[156:159], a[64:67], v[92:95], v[156:159]
    ds_read_b128 v[60:63], v25 offset:61440
    s_add_u32 m0, s49, 45056
    v_mfma_f32_16x16x32_bf16 v[156:159], a[80:83], v[96:99], v[156:159]
    buffer_load_dwordx4 v13, s[20:23], s84 offen lds
    v_mfma_f32_16x16x32_bf16 v[160:163], a[84:87], v[96:99], v[160:163]
    ds_read_b128 v[64:67], v26 offset:61440
    v_mfma_f32_16x16x32_bf16 v[160:163], a[68:71], v[92:95], v[160:163]
    s_cmp_ge_u32 s91, s56
    s_cselect_b32 s16, 0x2000000, s91
    v_mfma_f32_16x16x32_bf16 v[164:167], a[72:75], v[92:95], v[164:167]
    s_add_u32 m0, s49, 49152
    v_mfma_f32_16x16x32_bf16 v[164:167], a[88:91], v[96:99], v[164:167]
    buffer_load_dwordx4 v14, s[20:23], s84 offen lds
    v_mfma_f32_16x16x32_bf16 v[168:171], a[92:95], v[96:99], v[168:171]
    s_add_u32 s91, s91, 1024
    s_cmp_eq_u32 s91, 14336
    s_cselect_b32 s91, 0, s91
    v_mfma_f32_16x16x32_bf16 v[168:171], a[76:79], v[92:95], v[168:171]
    s_cmp_ge_u32 s91, s56
    s_cselect_b32 s17, 0x2000000, s91
    s_waitcnt lgkmcnt(2)
    v_mfma_f32_16x16x32_bf16 v[140:143], a[64:67], v[52:55], v[140:143]
    ds_read_b128 v[68:71], v27 offset:0
    s_add_u32 m0, s49, 53248
    v_mfma_f32_16x16x32_bf16 v[140:143], a[80:83], v[56:59], v[140:143]
    buffer_load_dwordx4 v15, s[20:23], s84 offen lds
    v_mfma_f32_16x16x32_bf16 v[144:147], a[84:87], v[56:59], v[144:147]
    ds_read_b128 v[72:75], v28 offset:0
    v_mfma_f32_16x16x32_bf16 v[144:147], a[68:71], v[52:55], v[144:147]
    v_mfma_f32_16x16x32_bf16 v[148:151], a[72:75], v[52:55], v[148:151]
    s_add_u32 m0, s49, 57344
    v_mfma_f32_16x16x32_bf16 v[148:151], a[88:91], v[56:59], v[148:151]
    buffer_load_dwordx4 v16, s[20:23], s84 offen lds
    v_mfma_f32_16x16x32_bf16 v[152:155], a[92:95], v[56:59], v[152:155]
    v_mfma_f32_16x16x32_bf16 v[152:155], a[76:79], v[52:55], v[152:155]
    s_waitcnt lgkmcnt(2)
    v_mfma_f32_16x16x32_bf16 v[124:127], a[64:67], v[60:63], v[124:127]
    s_waitcnt vmcnt(11) lgkmcnt(0)
    s_barrier
    ds_read_b64_tr_b16 a[96:97], v31 offset:4096
    v_mfma_f32_16x16x32_bf16 v[124:127], a[80:83], v[64:67], v[124:127]
    ds_read_b64_tr_b16 a[98:99], v31 offset:4608
    ds_read_b128 v[76:79], v27 offset:20480
    v_mfma_f32_16x16x32_bf16 v[128:131], a[84:87], v[64:67], v[128:131]
    ds_read_b64_tr_b16 a[112:113], v31 offset:12288
    ds_read_b64_tr_b16 a[114:115], v31 offset:12800
    v_mfma_f32_16x16x32_bf16 v[128:131], a[68:71], v[60:63], v[128:131]
    ds_read_b128 v[80:83], v28 offset:20480
    ds_read_b64_tr_b16 a[116:117], v31 offset:16384
    v_mfma_f32_16x16x32_bf16 v[132:135], a[72:75], v[60:63], v[132:135]
    ds_read_b64_tr_b16 a[118:119], v31 offset:16896
    ds_read_b64_tr_b16 a[100:101], v31 offset:8192
    v_mfma_f32_16x16x32_bf16 v[132:135], a[88:91], v[64:67], v[132:135]
    ds_read_b64_tr_b16 a[102:103], v31 offset:8704
    ds_read_b64_tr_b16 a[104:105], v106 offset:4096
    v_mfma_f32_16x16x32_bf16 v[136:139], a[92:95], v[64:67], v[136:139]
    ds_read_b64_tr_b16 a[106:107], v106 offset:4608
    ds_read_b64_tr_b16 a[120:121], v106 offset:12288
    v_mfma_f32_16x16x32_bf16 v[136:139], a[76:79], v[60:63], v[136:139]
    ds_read_b64_tr_b16 a[122:123], v106 offset:12800
    ds_read_b64_tr_b16 a[124:125], v106 offset:16384
    v_mfma_f32_16x16x32_bf16 v[108:111], a[64:67], v[68:71], v[108:111]
    ds_read_b64_tr_b16 a[126:127], v106 offset:16896
    ds_read_b64_tr_b16 a[108:109], v106 offset:8192
    v_mfma_f32_16x16x32_bf16 v[108:111], a[80:83], v[72:75], v[108:111]
    ds_read_b64_tr_b16 a[110:111], v106 offset:8704
    s_bfe_u32 s85, s67, 0x40014
    s_lshl_b32 s85, s85, 7
    s_mul_i32 s51, s85, 1728
    s_add_u32 m0, s49, 61440
    v_mfma_f32_16x16x32_bf16 v[112:115], a[84:87], v[72:75], v[112:115]
    buffer_load_dwordx4 v17, s[24:27], s51 offen lds
    v_mfma_f32_16x16x32_bf16 v[112:115], a[68:71], v[68:71], v[112:115]
    ds_read_b128 v[84:87], v27 offset:24576
    v_mfma_f32_16x16x32_bf16 v[116:119], a[72:75], v[68:71], v[116:119]
    ds_read_b128 v[88:91], v28 offset:24576
    v_mfma_f32_16x16x32_bf16 v[116:119], a[88:91], v[72:75], v[116:119]
    s_add_u32 m0, s49, 65536
    v_mfma_f32_16x16x32_bf16 v[120:123], a[92:95], v[72:75], v[120:123]
    buffer_load_dwordx4 v17, s[28:31], s51 offen lds
    v_mfma_f32_16x16x32_bf16 v[120:123], a[76:79], v[68:71], v[120:123]
    s_waitcnt lgkmcnt(15)
    v_mfma_f32_16x16x32_bf16 v[204:207], a[96:99], v[76:79], v[204:207]
    ds_read_b128 v[92:95], v27 offset:28672
    s_waitcnt lgkmcnt(15)
    v_mfma_f32_16x16x32_bf16 v[204:207], a[112:115], v[80:83], v[204:207]
    ds_read_b128 v[96:99], v28 offset:28672
    s_add_u32 m0, s49, 69632
    s_waitcnt lgkmcnt(14)
    v_mfma_f32_16x16x32_bf16 v[208:211], a[116:119], v[80:83], v[208:211]
    buffer_load_dwordx4 v18, s[24:27], s51 offen lds
    s_waitcnt lgkmcnt(12)
    v_mfma_f32_16x16x32_bf16 v[208:211], a[100:103], v[76:79], v[208:211]
    s_waitcnt lgkmcnt(10)
    v_mfma_f32_16x16x32_bf16 v[212:215], a[104:107], v[76:79], v[212:215]
    s_waitcnt lgkmcnt(8)
    v_mfma_f32_16x16x32_bf16 v[212:215], a[120:123], v[80:83], v[212:215]
    s_add_u32 m0, s49, 73728
    s_waitcnt lgkmcnt(6)
    v_mfma_f32_16x16x32_bf16 v[216:219], a[124:127], v[80:83], v[216:219]
    buffer_load_dwordx4 v18, s[28:31], s51 offen lds
    s_waitcnt lgkmcnt(4)
    v_mfma_f32_16x16x32_bf16 v[216:219], a[108:111], v[76:79], v[216:219]
    s_waitcnt lgkmcnt(2)
    v_mfma_f32_16x16x32_bf16 v[188:191], a[96:99], v[84:87], v[188:191]
    ds_read_b128 v[52:55], v23 offset:0
    v_mfma_f32_16x16x32_bf16 v[188:191], a[112:115], v[88:91], v[188:191]
    ds_read_b128 v[56:59], v24 offset:0
    s_add_u32 m0, s49, 77824
    v_mfma_f32_16x16x32_bf16 v[192:195], a[116:119], v[88:91], v[192:195]
    buffer_load_dwordx4 v10, s[20:23], s85 offen lds
    v_mfma_f32_16x16x32_bf16 v[192:195], a[100:103], v[84:87], v[192:195]
    v_mfma_f32_16x16x32_bf16 v[196:199], a[104:107], v[84:87], v[196:199]
    v_mfma_f32_16x16x32_bf16 v[196:199], a[120:123], v[88:91], v[196:199]
    s_add_u32 m0, s49, 81920
    v_mfma_f32_16x16x32_bf16 v[200:203], a[124:127], v[88:91], v[200:203]
    buffer_load_dwordx4 v11, s[20:23], s85 offen lds
    v_mfma_f32_16x16x32_bf16 v[200:203], a[108:111], v[84:87], v[200:203]
    s_waitcnt lgkmcnt(2)
    v_mfma_f32_16x16x32_bf16 v[172:175], a[96:99], v[92:95], v[172:175]
    ds_read_b128 v[60:63], v23 offset:4096
    v_mfma_f32_16x16x32_bf16 v[172:175], a[112:115], v[96:99], v[172:175]
    ds_read_b128 v[64:67], v24 offset:4096
    s_add_u32 m0, s49, 86016
    v_mfma_f32_16x16x32_bf16 v[176:179], a[116:119], v[96:99], v[176:179]
    buffer_load_dwordx4 v12, s[20:23], s85 offen lds
    v_mfma_f32_16x16x32_bf16 v[176:179], a[100:103], v[92:95], v[176:179]
    v_mfma_f32_16x16x32_bf16 v[180:183], a[104:107], v[92:95], v[180:183]
    v_mfma_f32_16x16x32_bf16 v[180:183], a[120:123], v[96:99], v[180:183]
    s_add_u32 m0, s49, 90112
    v_mfma_f32_16x16x32_bf16 v[184:187], a[124:127], v[96:99], v[184:187]
    buffer_load_dwordx4 v13, s[20:23], s85 offen lds
    v_mfma_f32_16x16x32_bf16 v[184:187], a[108:111], v[92:95], v[184:187]
    s_waitcnt lgkmcnt(2)
    v_mfma_f32_16x16x32_bf16 v[156:159], a[96:99], v[52:55], v[156:159]
    ds_read_b128 v[68:71], v23 offset:8192
    v_mfma_f32_16x16x32_bf16 v[156:159], a[112:115], v[56:59], v[156:159]
    ds_read_b128 v[72:75], v24 offset:8192
    s_add_u32 m0, s49, 94208
    v_mfma_f32_16x16x32_bf16 v[160:163], a[116:119], v[56:59], v[160:163]
    buffer_load_dwordx4 v14, s[20:23], s85 offen lds
    v_mfma_f32_16x16x32_bf16 v[160:163], a[100:103], v[52:55], v[160:163]
    v_mfma_f32_16x16x32_bf16 v[164:167], a[104:107], v[52:55], v[164:167]
    v_mfma_f32_16x16x32_bf16 v[164:167], a[120:123], v[56:59], v[164:167]
    s_add_u32 m0, s49, 98304
    v_mfma_f32_16x16x32_bf16 v[168:171], a[124:127], v[56:59], v[168:171]
    buffer_load_dwordx4 v15, s[20:23], s85 offen lds
    v_mfma_f32_16x16x32_bf16 v[168:171], a[108:111], v[52:55], v[168:171]
    s_waitcnt lgkmcnt(2)
    v_mfma_f32_16x16x32_bf16 v[140:143], a[96:99], v[60:63], v[140:143]
    ds_read_b128 v[76:79], v23 offset:12288
    v_mfma_f32_16x16x32_bf16 v[140:143], a[112:115], v[64:67], v[140:143]
    ds_read_b128 v[80:83], v24 offset:12288
    s_add_u32 m0, s49, 102400
    v_mfma_f32_16x16x32_bf16 v[144:147], a[116:119], v[64:67], v[144:147]
    buffer_load_dwordx4 v16, s[20:23], s85 offen lds
    v_mfma_f32_16x16x32_bf16 v[144:147], a[100:103], v[60:63], v[144:147]
    v_mfma_f32_16x16x32_bf16 v[148:151], a[104:107], v[60:63], v[148:151]
    v_mfma_f32_16x16x32_bf16 v[148:151], a[120:123], v[64:67], v[148:151]
    s_bfe_u32 s86, s67, 0x40018
    s_lshl_b32 s86, s86, 7
    s_mul_i32 s51, s86, 1728
    s_add_u32 m0, s49, 106496
    v_mfma_f32_16x16x32_bf16 v[152:155], a[124:127], v[64:67], v[152:155]
    buffer_load_dwordx4 v17, s[24:27], s51 offen lds
    v_mfma_f32_16x16x32_bf16 v[152:155], a[108:111], v[60:63], v[152:155]
    s_waitcnt lgkmcnt(2)
    v_mfma_f32_16x16x32_bf16 v[124:127], a[96:99], v[68:71], v[124:127]
    s_waitcnt vmcnt(12) lgkmcnt(0)
    s_barrier
    ds_read_b64_tr_b16 a[0:1], v29 offset:16384
    v_mfma_f32_16x16x32_bf16 v[124:127], a[112:115], v[72:75], v[124:127]
    ds_read_b64_tr_b16 a[2:3], v29 offset:16896
    ds_read_b128 v[84:87], v23 offset:32768
    v_mfma_f32_16x16x32_bf16 v[128:131], a[116:119], v[72:75], v[128:131]
    ds_read_b64_tr_b16 a[16:17], v29 offset:24576
    ds_read_b64_tr_b16 a[18:19], v29 offset:25088
    v_mfma_f32_16x16x32_bf16 v[128:131], a[100:103], v[68:71], v[128:131]
    ds_read_b128 v[88:91], v24 offset:32768
    ds_read_b64_tr_b16 a[20:21], v29 offset:28672
    v_mfma_f32_16x16x32_bf16 v[132:135], a[104:107], v[68:71], v[132:135]
    ds_read_b64_tr_b16 a[22:23], v29 offset:29184
    ds_read_b64_tr_b16 a[4:5], v29 offset:20480
    v_mfma_f32_16x16x32_bf16 v[132:135], a[120:123], v[72:75], v[132:135]
    ds_read_b64_tr_b16 a[6:7], v29 offset:20992
    ds_read_b64_tr_b16 a[8:9], v104 offset:16384
    v_mfma_f32_16x16x32_bf16 v[136:139], a[124:127], v[72:75], v[136:139]
    ds_read_b64_tr_b16 a[10:11], v104 offset:16896
    ds_read_b64_tr_b16 a[24:25], v104 offset:24576
    v_mfma_f32_16x16x32_bf16 v[136:139], a[108:111], v[68:71], v[136:139]
    ds_read_b64_tr_b16 a[26:27], v104 offset:25088
    ds_read_b64_tr_b16 a[28:29], v104 offset:28672
    v_mfma_f32_16x16x32_bf16 v[108:111], a[96:99], v[76:79], v[108:111]
    ds_read_b64_tr_b16 a[30:31], v104 offset:29184
    ds_read_b64_tr_b16 a[12:13], v104 offset:20480
    v_mfma_f32_16x16x32_bf16 v[108:111], a[112:115], v[80:83], v[108:111]
    ds_read_b64_tr_b16 a[14:15], v104 offset:20992
    s_add_u32 m0, s49, 110592
    v_mfma_f32_16x16x32_bf16 v[112:115], a[116:119], v[80:83], v[112:115]
    buffer_load_dwordx4 v17, s[28:31], s51 offen lds
    v_mfma_f32_16x16x32_bf16 v[112:115], a[100:103], v[76:79], v[112:115]
    ds_read_b128 v[92:95], v23 offset:36864
    v_mfma_f32_16x16x32_bf16 v[116:119], a[104:107], v[76:79], v[116:119]
    ds_read_b128 v[96:99], v24 offset:36864
    v_mfma_f32_16x16x32_bf16 v[116:119], a[120:123], v[80:83], v[116:119]
    s_add_u32 m0, s49, 114688
    v_mfma_f32_16x16x32_bf16 v[120:123], a[124:127], v[80:83], v[120:123]
    buffer_load_dwordx4 v18, s[24:27], s51 offen lds
    v_mfma_f32_16x16x32_bf16 v[120:123], a[108:111], v[76:79], v[120:123]
    s_waitcnt lgkmcnt(15)
    v_mfma_f32_16x16x32_bf16 v[204:207], a[0:3], v[84:87], v[204:207]
    ds_read_b128 v[52:55], v23 offset:40960
    s_waitcnt lgkmcnt(15)
    v_mfma_f32_16x16x32_bf16 v[204:207], a[16:19], v[88:91], v[204:207]
    ds_read_b128 v[56:59], v24 offset:40960
    s_add_u32 m0, s49, 118784
    s_waitcnt lgkmcnt(14)
    v_mfma_f32_16x16x32_bf16 v[208:211], a[20:23], v[88:91], v[208:211]
    buffer_load_dwordx4 v18, s[28:31], s51 offen lds
    s_waitcnt lgkmcnt(12)
    v_mfma_f32_16x16x32_bf16 v[208:211], a[4:7], v[84:87], v[208:211]
    s_waitcnt lgkmcnt(10)
    v_mfma_f32_16x16x32_bf16 v[212:215], a[8:11], v[84:87], v[212:215]
    s_waitcnt lgkmcnt(8)
    v_mfma_f32_16x16x32_bf16 v[212:215], a[24:27], v[88:91], v[212:215]
    s_add_u32 m0, s49, 122880
    s_waitcnt lgkmcnt(6)
    v_mfma_f32_16x16x32_bf16 v[216:219], a[28:31], v[88:91], v[216:219]
    buffer_load_dwordx4 v10, s[20:23], s86 offen lds
    s_waitcnt lgkmcnt(4)
    v_mfma_f32_16x16x32_bf16 v[216:219], a[12:15], v[84:87], v[216:219]
    s_waitcnt lgkmcnt(2)
    v_mfma_f32_16x16x32_bf16 v[188:191], a[0:3], v[92:95], v[188:191]
    ds_read_b128 v[60:63], v23 offset:45056
    v_mfma_f32_16x16x32_bf16 v[188:191], a[16:19], v[96:99], v[188:191]
    ds_read_b128 v[64:67], v24 offset:45056
    s_add_u32 m0, s49, 126976
    v_mfma_f32_16x16x32_bf16 v[192:195], a[20:23], v[96:99], v[192:195]
    buffer_load_dwordx4 v11, s[20:23], s86 offen lds
    v_mfma_f32_16x16x32_bf16 v[192:195], a[4:7], v[92:95], v[192:195]
    v_mfma_f32_16x16x32_bf16 v[196:199], a[8:11], v[92:95], v[196:199]
    v_mfma_f32_16x16x32_bf16 v[196:199], a[24:27], v[96:99], v[196:199]
    s_add_u32 m0, s49, 131072
    v_mfma_f32_16x16x32_bf16 v[200:203], a[28:31], v[96:99], v[200:203]
    buffer_load_dwordx4 v12, s[20:23], s86 offen lds
    v_mfma_f32_16x16x32_bf16 v[200:203], a[12:15], v[92:95], v[200:203]
    s_waitcnt lgkmcnt(2)
    v_mfma_f32_16x16x32_bf16 v[172:175], a[0:3], v[52:55], v[172:175]
    ds_read_b128 v[68:71], v23 offset:49152
    v_mfma_f32_16x16x32_bf16 v[172:175], a[16:19], v[56:59], v[172:175]
    ds_read_b128 v[72:75], v24 offset:49152
    s_add_u32 m0, s49, 135168
    v_mfma_f32_16x16x32_bf16 v[176:179], a[20:23], v[56:59], v[176:179]
    buffer_load_dwordx4 v13, s[20:23], s86 offen lds
    v_mfma_f32_16x16x32_bf16 v[176:179], a[4:7], v[52:55], v[176:179]
    v_mfma_f32_16x16x32_bf16 v[180:183], a[8:11], v[52:55], v[180:183]
    v_mfma_f32_16x16x32_bf16 v[180:183], a[24:27], v[56:59], v[180:183]
    s_add_u32 m0, s49, 139264
    v_mfma_f32_16x16x32_bf16 v[184:187], a[28:31], v[56:59], v[184:187]
    buffer_load_dwordx4 v14, s[20:23], s86 offen lds
    v_mfma_f32_16x16x32_bf16 v[184:187], a[12:15], v[52:55], v[184:187]
    s_waitcnt lgkmcnt(2)
    v_mfma_f32_16x16x32_bf16 v[156:159], a[0:3], v[60:63], v[156:159]
    ds_read_b128 v[76:79], v23 offset:53248
    v_mfma_f32_16x16x32_bf16 v[156:159], a[16:19], v[64:67], v[156:159]
    ds_read_b128 v[80:83], v24 offset:53248
    s_add_u32 m0, s49, 143360
    v_mfma_f32_16x16x32_bf16 v[160:163], a[20:23], v[64:67], v[160:163]
    buffer_load_dwordx4 v15, s[20:23], s86 offen lds
    v_mfma_f32_16x16x32_bf16 v[160:163], a[4:7], v[60:63], v[160:163]
    v_mfma_f32_16x16x32_bf16 v[164:167], a[8:11], v[60:63], v[164:167]
    v_mfma_f32_16x16x32_bf16 v[164:167], a[24:27], v[64:67], v[164:167]
    s_add_u32 m0, s49, 147456
    v_mfma_f32_16x16x32_bf16 v[168:171], a[28:31], v[64:67], v[168:171]
    buffer_load_dwordx4 v16, s[20:23], s86 offen lds
    v_mfma_f32_16x16x32_bf16 v[168:171], a[12:15], v[60:63], v[168:171]
    s_waitcnt lgkmcnt(2)
    v_mfma_f32_16x16x32_bf16 v[140:143], a[0:3], v[68:71], v[140:143]
    ds_read_b128 v[84:87], v23 offset:57344
    v_mfma_f32_16x16x32_bf16 v[140:143], a[16:19], v[72:75], v[140:143]
    ds_read_b128 v[88:91], v24 offset:57344
    s_bfe_u32 s87, s67, 0x4001c
    s_lshl_b32 s87, s87, 7
    s_mul_i32 s51, s87, 1728
    s_add_u32 m0, s49, 151552
    v_mfma_f32_16x16x32_bf16 v[144:147], a[20:23], v[72:75], v[144:147]
    buffer_load_dwordx4 v17, s[24:27], s51 offen lds
    v_mfma_f32_16x16x32_bf16 v[144:147], a[4:7], v[68:71], v[144:147]
    v_mfma_f32_16x16x32_bf16 v[148:151], a[8:11], v[68:71], v[148:151]
    v_mfma_f32_16x16x32_bf16 v[148:151], a[24:27], v[72:75], v[148:151]
    s_add_u32 m0, s49, 155648
    v_mfma_f32_16x16x32_bf16 v[152:155], a[28:31], v[72:75], v[152:155]
    buffer_load_dwordx4 v17, s[28:31], s51 offen lds
    v_mfma_f32_16x16x32_bf16 v[152:155], a[12:15], v[68:71], v[152:155]
    s_waitcnt lgkmcnt(2)
    v_mfma_f32_16x16x32_bf16 v[124:127], a[0:3], v[76:79], v[124:127]
    s_waitcnt vmcnt(13) lgkmcnt(0)
    s_barrier
    ds_read_b64_tr_b16 a[32:33], v29 offset:61440
    v_mfma_f32_16x16x32_bf16 v[124:127], a[16:19], v[80:83], v[124:127]
    ds_read_b64_tr_b16 a[34:35], v29 offset:61952
    ds_read_b128 v[92:95], v25 offset:12288
    v_mfma_f32_16x16x32_bf16 v[128:131], a[20:23], v[80:83], v[128:131]
    ds_read_b64_tr_b16 a[48:49], v30 offset:4096
    ds_read_b64_tr_b16 a[50:51], v30 offset:4608
    v_mfma_f32_16x16x32_bf16 v[128:131], a[4:7], v[76:79], v[128:131]
    ds_read_b128 v[96:99], v26 offset:12288
    ds_read_b64_tr_b16 a[52:53], v30 offset:8192
    v_mfma_f32_16x16x32_bf16 v[132:135], a[8:11], v[76:79], v[132:135]
    ds_read_b64_tr_b16 a[54:55], v30 offset:8704
    ds_read_b64_tr_b16 a[36:37], v30 offset:0
    v_mfma_f32_16x16x32_bf16 v[132:135], a[24:27], v[80:83], v[132:135]
    ds_read_b64_tr_b16 a[38:39], v30 offset:512
    ds_read_b64_tr_b16 a[40:41], v104 offset:61440
    v_mfma_f32_16x16x32_bf16 v[136:139], a[28:31], v[80:83], v[136:139]
    ds_read_b64_tr_b16 a[42:43], v104 offset:61952
    ds_read_b64_tr_b16 a[56:57], v105 offset:4096
    v_mfma_f32_16x16x32_bf16 v[136:139], a[12:15], v[76:79], v[136:139]
    ds_read_b64_tr_b16 a[58:59], v105 offset:4608
    ds_read_b64_tr_b16 a[60:61], v105 offset:8192
    v_mfma_f32_16x16x32_bf16 v[108:111], a[0:3], v[84:87], v[108:111]
    ds_read_b64_tr_b16 a[62:63], v105 offset:8704
    ds_read_b64_tr_b16 a[44:45], v105 offset:0
    v_mfma_f32_16x16x32_bf16 v[108:111], a[16:19], v[88:91], v[108:111]
    ds_read_b64_tr_b16 a[46:47], v105 offset:512
    s_add_u32 m0, s49, 159744
    v_mfma_f32_16x16x32_bf16 v[112:115], a[20:23], v[88:91], v[112:115]
    buffer_load_dwordx4 v18, s[24:27], s51 offen lds
    v_mfma_f32_16x16x32_bf16 v[112:115], a[4:7], v[84:87], v[112:115]
    ds_read_b128 v[52:55], v25 offset:16384
    v_mfma_f32_16x16x32_bf16 v[116:119], a[8:11], v[84:87], v[116:119]
    ds_read_b128 v[56:59], v26 offset:16384
    v_mfma_f32_16x16x32_bf16 v[116:119], a[24:27], v[88:91], v[116:119]
    s_add_u32 m0, s49, 0
    v_mfma_f32_16x16x32_bf16 v[120:123], a[28:31], v[88:91], v[120:123]
    buffer_load_dwordx4 v18, s[28:31], s51 offen lds
    v_mfma_f32_16x16x32_bf16 v[120:123], a[12:15], v[84:87], v[120:123]
    s_waitcnt lgkmcnt(15)
    v_mfma_f32_16x16x32_bf16 v[204:207], a[32:35], v[92:95], v[204:207]
    ds_read_b128 v[60:63], v25 offset:20480
    s_waitcnt lgkmcnt(15)
    v_mfma_f32_16x16x32_bf16 v[204:207], a[48:51], v[96:99], v[204:207]
    ds_read_b128 v[64:67], v26 offset:20480
    s_add_u32 m0, s49, 4096
    s_waitcnt lgkmcnt(14)
    v_mfma_f32_16x16x32_bf16 v[208:211], a[52:55], v[96:99], v[208:211]
    buffer_load_dwordx4 v10, s[20:23], s87 offen lds
    s_waitcnt lgkmcnt(12)
    v_mfma_f32_16x16x32_bf16 v[208:211], a[36:39], v[92:95], v[208:211]
    s_waitcnt lgkmcnt(10)
    v_mfma_f32_16x16x32_bf16 v[212:215], a[40:43], v[92:95], v[212:215]
    s_waitcnt lgkmcnt(8)
    v_mfma_f32_16x16x32_bf16 v[212:215], a[56:59], v[96:99], v[212:215]
    s_add_u32 m0, s49, 8192
    s_waitcnt lgkmcnt(6)
    v_mfma_f32_16x16x32_bf16 v[216:219], a[60:63], v[96:99], v[216:219]
    buffer_load_dwordx4 v11, s[20:23], s87 offen lds
    s_waitcnt lgkmcnt(4)
    v_mfma_f32_16x16x32_bf16 v[216:219], a[44:47], v[92:95], v[216:219]
    s_waitcnt lgkmcnt(2)
    v_mfma_f32_16x16x32_bf16 v[188:191], a[32:35], v[52:55], v[188:191]
    ds_read_b128 v[68:71], v25 offset:24576
    v_mfma_f32_16x16x32_bf16 v[188:191], a[48:51], v[56:59], v[188:191]
    ds_read_b128 v[72:75], v26 offset:24576
    s_add_u32 m0, s49, 12288
    v_mfma_f32_16x16x32_bf16 v[192:195], a[52:55], v[56:59], v[192:195]
    buffer_load_dwordx4 v12, s[20:23], s87 offen lds
    v_mfma_f32_16x16x32_bf16 v[192:195], a[36:39], v[52:55], v[192:195]
    v_mfma_f32_16x16x32_bf16 v[196:199], a[40:43], v[52:55], v[196:199]
    v_mfma_f32_16x16x32_bf16 v[196:199], a[56:59], v[56:59], v[196:199]
    s_add_u32 m0, s49, 16384
    v_mfma_f32_16x16x32_bf16 v[200:203], a[60:63], v[56:59], v[200:203]
    buffer_load_dwordx4 v13, s[20:23], s87 offen lds
    v_mfma_f32_16x16x32_bf16 v[200:203], a[44:47], v[52:55], v[200:203]
    s_waitcnt lgkmcnt(2)
    v_mfma_f32_16x16x32_bf16 v[172:175], a[32:35], v[60:63], v[172:175]
    ds_read_b128 v[76:79], v25 offset:28672
    v_mfma_f32_16x16x32_bf16 v[172:175], a[48:51], v[64:67], v[172:175]
    ds_read_b128 v[80:83], v26 offset:28672
    s_add_u32 m0, s49, 20480
    v_mfma_f32_16x16x32_bf16 v[176:179], a[52:55], v[64:67], v[176:179]
    buffer_load_dwordx4 v14, s[20:23], s87 offen lds
    v_mfma_f32_16x16x32_bf16 v[176:179], a[36:39], v[60:63], v[176:179]
    v_mfma_f32_16x16x32_bf16 v[180:183], a[40:43], v[60:63], v[180:183]
    v_mfma_f32_16x16x32_bf16 v[180:183], a[56:59], v[64:67], v[180:183]
    s_add_u32 m0, s49, 24576
    v_mfma_f32_16x16x32_bf16 v[184:187], a[60:63], v[64:67], v[184:187]
    buffer_load_dwordx4 v15, s[20:23], s87 offen lds
    v_mfma_f32_16x16x32_bf16 v[184:187], a[44:47], v[60:63], v[184:187]
    s_waitcnt lgkmcnt(2)
    v_mfma_f32_16x16x32_bf16 v[156:159], a[32:35], v[68:71], v[156:159]
    ds_read_b128 v[84:87], v25 offset:32768
    v_mfma_f32_16x16x32_bf16 v[156:159], a[48:51], v[72:75], v[156:159]
    ds_read_b128 v[88:91], v26 offset:32768
    s_add_u32 m0, s49, 28672
    v_mfma_f32_16x16x32_bf16 v[160:163], a[52:55], v[72:75], v[160:163]
    buffer_load_dwordx4 v16, s[20:23], s87 offen lds
    v_mfma_f32_16x16x32_bf16 v[160:163], a[36:39], v[68:71], v[160:163]
    v_mfma_f32_16x16x32_bf16 v[164:167], a[40:43], v[68:71], v[164:167]
    v_mfma_f32_16x16x32_bf16 v[164:167], a[56:59], v[72:75], v[164:167]
    s_bfe_u32 s88, s79, 0x40000
    s_lshl_b32 s88, s88, 7
    s_mul_i32 s51, s88, 1728
    s_add_u32 m0, s49, 32768
    v_mfma_f32_16x16x32_bf16 v[168:171], a[60:63], v[72:75], v[168:171]
    buffer_load_dwordx4 v17, s[24:27], s51 offen lds
    v_mfma_f32_16x16x32_bf16 v[168:171], a[44:47], v[68:71], v[168:171]
    s_waitcnt lgkmcnt(2)
    v_mfma_f32_16x16x32_bf16 v[140:143], a[32:35], v[76:79], v[140:143]
    ds_read_b128 v[92:95], v25 offset:36864
    v_mfma_f32_16x16x32_bf16 v[140:143], a[48:51], v[80:83], v[140:143]
    ds_read_b128 v[96:99], v26 offset:36864
    s_add_u32 m0, s49, 36864
    v_mfma_f32_16x16x32_bf16 v[144:147], a[52:55], v[80:83], v[144:147]
    buffer_load_dwordx4 v17, s[28:31], s51 offen lds
    v_mfma_f32_16x16x32_bf16 v[144:147], a[36:39], v[76:79], v[144:147]
    v_mfma_f32_16x16x32_bf16 v[148:151], a[40:43], v[76:79], v[148:151]
    v_mfma_f32_16x16x32_bf16 v[148:151], a[56:59], v[80:83], v[148:151]
    s_add_u32 m0, s49, 40960
    v_mfma_f32_16x16x32_bf16 v[152:155], a[60:63], v[80:83], v[152:155]
    buffer_load_dwordx4 v18, s[24:27], s51 offen lds
    v_mfma_f32_16x16x32_bf16 v[152:155], a[44:47], v[76:79], v[152:155]
    s_waitcnt lgkmcnt(2)
    v_mfma_f32_16x16x32_bf16 v[124:127], a[32:35], v[84:87], v[124:127]
    s_waitcnt vmcnt(14) lgkmcnt(0)
    s_barrier
    ds_read_b64_tr_b16 a[64:65], v30 offset:40960
    v_mfma_f32_16x16x32_bf16 v[124:127], a[48:51], v[88:91], v[124:127]
    ds_read_b64_tr_b16 a[66:67], v30 offset:41472
    ds_read_b128 v[52:55], v25 offset:57344
    v_mfma_f32_16x16x32_bf16 v[128:131], a[52:55], v[88:91], v[128:131]
    ds_read_b64_tr_b16 a[80:81], v30 offset:49152
    ds_read_b64_tr_b16 a[82:83], v30 offset:49664
    v_mfma_f32_16x16x32_bf16 v[128:131], a[36:39], v[84:87], v[128:131]
    ds_read_b128 v[56:59], v26 offset:57344
    ds_read_b64_tr_b16 a[84:85], v30 offset:53248
    v_mfma_f32_16x16x32_bf16 v[132:135], a[40:43], v[84:87], v[132:135]
    ds_read_b64_tr_b16 a[86:87], v30 offset:53760
    ds_read_b64_tr_b16 a[68:69], v30 offset:45056
    v_mfma_f32_16x16x32_bf16 v[132:135], a[56:59], v[88:91], v[132:135]
    ds_read_b64_tr_b16 a[70:71], v30 offset:45568
    ds_read_b64_tr_b16 a[72:73], v105 offset:40960
    v_mfma_f32_16x16x32_bf16 v[136:139], a[60:63], v[88:91], v[136:139]
    ds_read_b64_tr_b16 a[74:75], v105 offset:41472
    ds_read_b64_tr_b16 a[88:89], v105 offset:49152
    v_mfma_f32_16x16x32_bf16 v[136:139], a[44:47], v[84:87], v[136:139]
    ds_read_b64_tr_b16 a[90:91], v105 offset:49664
    ds_read_b64_tr_b16 a[92:93], v105 offset:53248
    v_mfma_f32_16x16x32_bf16 v[108:111], a[32:35], v[92:95], v[108:111]
    ds_read_b64_tr_b16 a[94:95], v105 offset:53760
    ds_read_b64_tr_b16 a[76:77], v105 offset:45056
    v_mfma_f32_16x16x32_bf16 v[108:111], a[48:51], v[96:99], v[108:111]
    ds_read_b64_tr_b16 a[78:79], v105 offset:45568
    s_add_u32 m0, s49, 45056
    v_mfma_f32_16x16x32_bf16 v[112:115], a[52:55], v[96:99], v[112:115]
    buffer_load_dwordx4 v18, s[28:31], s51 offen lds
    v_mfma_f32_16x16x32_bf16 v[112:115], a[36:39], v[92:95], v[112:115]
    ds_read_b128 v[60:63], v25 offset:61440
    v_mfma_f32_16x16x32_bf16 v[116:119], a[40:43], v[92:95], v[116:119]
    ds_read_b128 v[64:67], v26 offset:61440
    v_mfma_f32_16x16x32_bf16 v[116:119], a[56:59], v[96:99], v[116:119]
    s_add_u32 m0, s49, 49152
    v_mfma_f32_16x16x32_bf16 v[120:123], a[60:63], v[96:99], v[120:123]
    buffer_load_dwordx4 v10, s[20:23], s88 offen lds
    v_mfma_f32_16x16x32_bf16 v[120:123], a[44:47], v[92:95], v[120:123]
    s_waitcnt lgkmcnt(15)
    v_mfma_f32_16x16x32_bf16 v[204:207], a[64:67], v[52:55], v[204:207]
    ds_read_b128 v[68:71], v27 offset:0
    s_waitcnt lgkmcnt(15)
    v_mfma_f32_16x16x32_bf16 v[204:207], a[80:83], v[56:59], v[204:207]
    ds_read_b128 v[72:75], v28 offset:0
    s_add_u32 m0, s49, 53248
    s_waitcnt lgkmcnt(14)
    v_mfma_f32_16x16x32_bf16 v[208:211], a[84:87], v[56:59], v[208:211]
    buffer_load_dwordx4 v11, s[20:23], s88 offen lds
    s_waitcnt lgkmcnt(12)
    v_mfma_f32_16x16x32_bf16 v[208:211], a[68:71], v[52:55], v[208:211]
    s_waitcnt lgkmcnt(10)
    v_mfma_f32_16x16x32_bf16 v[212:215], a[72:75], v[52:55], v[212:215]
    s_waitcnt lgkmcnt(8)
    v_mfma_f32_16x16x32_bf16 v[212:215], a[88:91], v[56:59], v[212:215]
    s_add_u32 m0, s49, 57344
    s_waitcnt lgkmcnt(6)
    v_mfma_f32_16x16x32_bf16 v[216:219], a[92:95], v[56:59], v[216:219]
    buffer_load_dwordx4 v12, s[20:23], s88 offen lds
    s_waitcnt lgkmcnt(4)
    v_mfma_f32_16x16x32_bf16 v[216:219], a[76:79], v[52:55], v[216:219]
    s_waitcnt lgkmcnt(2)
    v_mfma_f32_16x16x32_bf16 v[188:191], a[64:67], v[60:63], v[188:191]
    ds_read_b128 v[76:79], v27 offset:4096
    v_mfma_f32_16x16x32_bf16 v[188:191], a[80:83], v[64:67], v[188:191]
    ds_read_b128 v[80:83], v28 offset:4096
    s_add_u32 m0, s49, 61440
    v_mfma_f32_16x16x32_bf16 v[192:195], a[84:87], v[64:67], v[192:195]
    buffer_load_dwordx4 v13, s[20:23], s88 offen lds
    v_mfma_f32_16x16x32_bf16 v[192:195], a[68:71], v[60:63], v[192:195]
    v_mfma_f32_16x16x32_bf16 v[196:199], a[72:75], v[60:63], v[196:199]
    v_mfma_f32_16x16x32_bf16 v[196:199], a[88:91], v[64:67], v[196:199]
    s_add_u32 m0, s49, 65536
    v_mfma_f32_16x16x32_bf16 v[200:203], a[92:95], v[64:67], v[200:203]
    buffer_load_dwordx4 v14, s[20:23], s88 offen lds
    v_mfma_f32_16x16x32_bf16 v[200:203], a[76:79], v[60:63], v[200:203]
    s_waitcnt lgkmcnt(2)
    v_mfma_f32_16x16x32_bf16 v[172:175], a[64:67], v[68:71], v[172:175]
    ds_read_b128 v[84:87], v27 offset:8192
    v_mfma_f32_16x16x32_bf16 v[172:175], a[80:83], v[72:75], v[172:175]
    ds_read_b128 v[88:91], v28 offset:8192
    s_add_u32 m0, s49, 69632
    v_mfma_f32_16x16x32_bf16 v[176:179], a[84:87], v[72:75], v[176:179]
    buffer_load_dwordx4 v15, s[20:23], s88 offen lds
    v_mfma_f32_16x16x32_bf16 v[176:179], a[68:71], v[68:71], v[176:179]
    v_mfma_f32_16x16x32_bf16 v[180:183], a[72:75], v[68:71], v[180:183]
    v_mfma_f32_16x16x32_bf16 v[180:183], a[88:91], v[72:75], v[180:183]
    s_add_u32 m0, s49, 73728
    v_mfma_f32_16x16x32_bf16 v[184:187], a[92:95], v[72:75], v[184:187]
    buffer_load_dwordx4 v16, s[20:23], s88 offen lds
    v_mfma_f32_16x16x32_bf16 v[184:187], a[76:79], v[68:71], v[184:187]
    s_waitcnt lgkmcnt(2)
    v_mfma_f32_16x16x32_bf16 v[156:159], a[64:67], v[76:79], v[156:159]
    ds_read_b128 v[92:95], v27 offset:12288
    v_mfma_f32_16x16x32_bf16 v[156:159], a[80:83], v[80:83], v[156:159]
    ds_read_b128 v[96:99], v28 offset:12288
    s_bfe_u32 s89, s79, 0x40004
    s_lshl_b32 s89, s89, 7
    s_mul_i32 s51, s89, 1728
    s_add_u32 m0, s49, 77824
    v_mfma_f32_16x16x32_bf16 v[160:163], a[84:87], v[80:83], v[160:163]
    buffer_load_dwordx4 v17, s[24:27], s51 offen lds
    v_mfma_f32_16x16x32_bf16 v[160:163], a[68:71], v[76:79], v[160:163]
    v_mfma_f32_16x16x32_bf16 v[164:167], a[72:75], v[76:79], v[164:167]
    v_mfma_f32_16x16x32_bf16 v[164:167], a[88:91], v[80:83], v[164:167]
    s_add_u32 m0, s49, 81920
    v_mfma_f32_16x16x32_bf16 v[168:171], a[92:95], v[80:83], v[168:171]
    buffer_load_dwordx4 v17, s[28:31], s51 offen lds
    v_mfma_f32_16x16x32_bf16 v[168:171], a[76:79], v[76:79], v[168:171]
    s_waitcnt lgkmcnt(2)
    v_mfma_f32_16x16x32_bf16 v[140:143], a[64:67], v[84:87], v[140:143]
    ds_read_b128 v[52:55], v27 offset:16384
    v_mfma_f32_16x16x32_bf16 v[140:143], a[80:83], v[88:91], v[140:143]
    ds_read_b128 v[56:59], v28 offset:16384
    s_add_u32 m0, s49, 86016
    v_mfma_f32_16x16x32_bf16 v[144:147], a[84:87], v[88:91], v[144:147]
    buffer_load_dwordx4 v18, s[24:27], s51 offen lds
    v_mfma_f32_16x16x32_bf16 v[144:147], a[68:71], v[84:87], v[144:147]
    v_mfma_f32_16x16x32_bf16 v[148:151], a[72:75], v[84:87], v[148:151]
    v_mfma_f32_16x16x32_bf16 v[148:151], a[88:91], v[88:91], v[148:151]
    s_add_u32 m0, s49, 90112
    v_mfma_f32_16x16x32_bf16 v[152:155], a[92:95], v[88:91], v[152:155]
    buffer_load_dwordx4 v18, s[28:31], s51 offen lds
    v_mfma_f32_16x16x32_bf16 v[152:155], a[76:79], v[84:87], v[152:155]
    s_waitcnt lgkmcnt(2)
    v_mfma_f32_16x16x32_bf16 v[124:127], a[64:67], v[92:95], v[124:127]
    s_waitcnt vmcnt(15) lgkmcnt(0)
    s_barrier
    buffer_load_dword v8, v9, s[44:47], s49 offen sc1
    ds_read_b64_tr_b16 a[96:97], v31 offset:20480
    v_mfma_f32_16x16x32_bf16 v[124:127], a[80:83], v[96:99], v[124:127]
    ds_read_b64_tr_b16 a[98:99], v31 offset:20992
    ds_read_b128 v[60:63], v23 offset:4096
    v_mfma_f32_16x16x32_bf16 v[128:131], a[84:87], v[96:99], v[128:131]
    ds_read_b64_tr_b16 a[112:113], v31 offset:28672
    ds_read_b64_tr_b16 a[114:115], v31 offset:29184
    v_mfma_f32_16x16x32_bf16 v[128:131], a[68:71], v[92:95], v[128:131]
    ds_read_b128 v[64:67], v24 offset:4096
    ds_read_b64_tr_b16 a[116:117], v29 offset:0
    v_mfma_f32_16x16x32_bf16 v[132:135], a[72:75], v[92:95], v[132:135]
    ds_read_b64_tr_b16 a[118:119], v29 offset:512
    ds_read_b64_tr_b16 a[100:101], v31 offset:24576
    v_mfma_f32_16x16x32_bf16 v[132:135], a[88:91], v[96:99], v[132:135]
    ds_read_b64_tr_b16 a[102:103], v31 offset:25088
    ds_read_b64_tr_b16 a[104:105], v106 offset:20480
    v_mfma_f32_16x16x32_bf16 v[136:139], a[92:95], v[96:99], v[136:139]
    ds_read_b64_tr_b16 a[106:107], v106 offset:20992
    ds_read_b64_tr_b16 a[120:121], v106 offset:28672
    v_mfma_f32_16x16x32_bf16 v[136:139], a[76:79], v[92:95], v[136:139]
    ds_read_b64_tr_b16 a[122:123], v106 offset:29184
    ds_read_b64_tr_b16 a[124:125], v104 offset:0
    v_mfma_f32_16x16x32_bf16 v[108:111], a[64:67], v[52:55], v[108:111]
    ds_read_b64_tr_b16 a[126:127], v104 offset:512
    ds_read_b64_tr_b16 a[108:109], v106 offset:24576
    v_mfma_f32_16x16x32_bf16 v[108:111], a[80:83], v[56:59], v[108:111]
    ds_read_b64_tr_b16 a[110:111], v106 offset:25088
    s_add_u32 m0, s49, 94208
    v_mfma_f32_16x16x32_bf16 v[112:115], a[84:87], v[56:59], v[112:115]
    buffer_load_dwordx4 v10, s[20:23], s89 offen lds
    v_mfma_f32_16x16x32_bf16 v[112:115], a[68:71], v[52:55], v[112:115]
    ds_read_b128 v[68:71], v23 offset:8192
    v_mfma_f32_16x16x32_bf16 v[116:119], a[72:75], v[52:55], v[116:119]
    ds_read_b128 v[72:75], v24 offset:8192
    v_mfma_f32_16x16x32_bf16 v[116:119], a[88:91], v[56:59], v[116:119]
    s_add_u32 m0, s49, 98304
    v_mfma_f32_16x16x32_bf16 v[120:123], a[92:95], v[56:59], v[120:123]
    buffer_load_dwordx4 v11, s[20:23], s89 offen lds
    v_mfma_f32_16x16x32_bf16 v[120:123], a[76:79], v[52:55], v[120:123]
    s_waitcnt lgkmcnt(15)
    v_mfma_f32_16x16x32_bf16 v[204:207], a[96:99], v[60:63], v[204:207]
    ds_read_b128 v[76:79], v23 offset:12288
    s_waitcnt lgkmcnt(15)
    v_mfma_f32_16x16x32_bf16 v[204:207], a[112:115], v[64:67], v[204:207]
    ds_read_b128 v[80:83], v24 offset:12288
    s_add_u32 m0, s49, 102400
    s_waitcnt lgkmcnt(14)
    v_mfma_f32_16x16x32_bf16 v[208:211], a[116:119], v[64:67], v[208:211]
    buffer_load_dwordx4 v12, s[20:23], s89 offen lds
    s_waitcnt lgkmcnt(12)
    v_mfma_f32_16x16x32_bf16 v[208:211], a[100:103], v[60:63], v[208:211]
    s_waitcnt lgkmcnt(10)
    v_mfma_f32_16x16x32_bf16 v[212:215], a[104:107], v[60:63], v[212:215]
    s_waitcnt lgkmcnt(8)
    v_mfma_f32_16x16x32_bf16 v[212:215], a[120:123], v[64:67], v[212:215]
    s_add_u32 m0, s49, 106496
    s_waitcnt lgkmcnt(6)
    v_mfma_f32_16x16x32_bf16 v[216:219], a[124:127], v[64:67], v[216:219]
    buffer_load_dwordx4 v13, s[20:23], s89 offen lds
    s_waitcnt lgkmcnt(4)
    v_mfma_f32_16x16x32_bf16 v[216:219], a[108:111], v[60:63], v[216:219]
    s_waitcnt lgkmcnt(2)
    v_mfma_f32_16x16x32_bf16 v[188:191], a[96:99], v[68:71], v[188:191]
    ds_read_b128 v[84:87], v23 offset:16384
    v_mfma_f32_16x16x32_bf16 v[188:191], a[112:115], v[72:75], v[188:191]
    ds_read_b128 v[88:91], v24 offset:16384
    s_add_u32 m0, s49, 110592
    v_mfma_f32_16x16x32_bf16 v[192:195], a[116:119], v[72:75], v[192:195]
    buffer_load_dwordx4 v14, s[20:23], s89 offen lds
    v_mfma_f32_16x16x32_bf16 v[192:195], a[100:103], v[68:71], v[192:195]
    v_mfma_f32_16x16x32_bf16 v[196:199], a[104:107], v[68:71], v[196:199]
    v_mfma_f32_16x16x32_bf16 v[196:199], a[120:123], v[72:75], v[196:199]
    s_add_u32 m0, s49, 114688
    v_mfma_f32_16x16x32_bf16 v[200:203], a[124:127], v[72:75], v[200:203]
    buffer_load_dwordx4 v15, s[20:23], s89 offen lds
    v_mfma_f32_16x16x32_bf16 v[200:203], a[108:111], v[68:71], v[200:203]
    s_waitcnt lgkmcnt(2)
    v_mfma_f32_16x16x32_bf16 v[172:175], a[96:99], v[76:79], v[172:175]
    ds_read_b128 v[92:95], v23 offset:20480
    v_mfma_f32_16x16x32_bf16 v[172:175], a[112:115], v[80:83], v[172:175]
    ds_read_b128 v[96:99], v24 offset:20480
    s_add_u32 m0, s49, 118784
    v_mfma_f32_16x16x32_bf16 v[176:179], a[116:119], v[80:83], v[176:179]
    buffer_load_dwordx4 v16, s[20:23], s89 offen lds
    v_mfma_f32_16x16x32_bf16 v[176:179], a[100:103], v[76:79], v[176:179]
    v_mfma_f32_16x16x32_bf16 v[180:183], a[104:107], v[76:79], v[180:183]
    v_mfma_f32_16x16x32_bf16 v[180:183], a[120:123], v[80:83], v[180:183]
    s_mul_i32 s55, s4, 40
    s_add_u32 m0, s50, 131072
    v_mfma_f32_16x16x32_bf16 v[184:187], a[124:127], v[80:83], v[184:187]
    buffer_load_dwordx4 v19, s[32:35], s55 offen lds
    v_mfma_f32_16x16x32_bf16 v[184:187], a[108:111], v[76:79], v[184:187]
    s_waitcnt lgkmcnt(2)
    v_mfma_f32_16x16x32_bf16 v[156:159], a[96:99], v[84:87], v[156:159]
    ds_read_b128 v[52:55], v23 offset:24576
    v_mfma_f32_16x16x32_bf16 v[156:159], a[112:115], v[88:91], v[156:159]
    ds_read_b128 v[56:59], v24 offset:24576
    s_add_u32 m0, s50, 132096
    v_mfma_f32_16x16x32_bf16 v[160:163], a[116:119], v[88:91], v[160:163]
    buffer_load_dwordx4 v20, s[32:35], s55 offen lds
    v_mfma_f32_16x16x32_bf16 v[160:163], a[100:103], v[84:87], v[160:163]
    v_mfma_f32_16x16x32_bf16 v[164:167], a[104:107], v[84:87], v[164:167]
    v_mfma_f32_16x16x32_bf16 v[164:167], a[120:123], v[88:91], v[164:167]
    s_add_u32 m0, s50, 133120
    v_mfma_f32_16x16x32_bf16 v[168:171], a[124:127], v[88:91], v[168:171]
    buffer_load_dwordx4 v21, s[32:35], s55 offen lds
    v_mfma_f32_16x16x32_bf16 v[168:171], a[108:111], v[84:87], v[168:171]
    s_waitcnt lgkmcnt(2)
    v_mfma_f32_16x16x32_bf16 v[140:143], a[96:99], v[92:95], v[140:143]
    ds_read_b128 v[60:63], v23 offset:28672
    v_mfma_f32_16x16x32_bf16 v[140:143], a[112:115], v[96:99], v[140:143]
    ds_read_b128 v[64:67], v24 offset:28672
    s_add_u32 m0, s50, 134144
    v_mfma_f32_16x16x32_bf16 v[144:147], a[116:119], v[96:99], v[144:147]
    buffer_load_dwordx4 v22, s[32:35], s55 offen lds
    v_mfma_f32_16x16x32_bf16 v[144:147], a[100:103], v[92:95], v[144:147]
    v_mfma_f32_16x16x32_bf16 v[148:151], a[104:107], v[92:95], v[148:151]
    v_mfma_f32_16x16x32_bf16 v[148:151], a[120:123], v[96:99], v[148:151]
    v_mfma_f32_16x16x32_bf16 v[152:155], a[124:127], v[96:99], v[152:155]
    v_mfma_f32_16x16x32_bf16 v[152:155], a[108:111], v[92:95], v[152:155]
    s_waitcnt lgkmcnt(2)
    v_mfma_f32_16x16x32_bf16 v[124:127], a[96:99], v[52:55], v[124:127]
    s_waitcnt vmcnt(16) lgkmcnt(0)
    s_barrier
    ds_read_b64_tr_b16 a[0:1], v29 offset:32768
    v_mfma_f32_16x16x32_bf16 v[124:127], a[112:115], v[56:59], v[124:127]
    ds_read_b64_tr_b16 a[2:3], v29 offset:33280
    ds_read_b128 v[68:71], v23 offset:49152
    v_mfma_f32_16x16x32_bf16 v[128:131], a[116:119], v[56:59], v[128:131]
    ds_read_b64_tr_b16 a[16:17], v29 offset:40960
    ds_read_b64_tr_b16 a[18:19], v29 offset:41472
    v_mfma_f32_16x16x32_bf16 v[128:131], a[100:103], v[52:55], v[128:131]
    ds_read_b128 v[72:75], v24 offset:49152
    ds_read_b64_tr_b16 a[20:21], v29 offset:45056
    v_mfma_f32_16x16x32_bf16 v[132:135], a[104:107], v[52:55], v[132:135]
    ds_read_b64_tr_b16 a[22:23], v29 offset:45568
    ds_read_b64_tr_b16 a[4:5], v29 offset:36864
    v_mfma_f32_16x16x32_bf16 v[132:135], a[120:123], v[56:59], v[132:135]
    ds_read_b64_tr_b16 a[6:7], v29 offset:37376
    ds_read_b64_tr_b16 a[8:9], v104 offset:32768
    v_mfma_f32_16x16x32_bf16 v[136:139], a[124:127], v[56:59], v[136:139]
    ds_read_b64_tr_b16 a[10:11], v104 offset:33280
    ds_read_b64_tr_b16 a[24:25], v104 offset:40960
    v_mfma_f32_16x16x32_bf16 v[136:139], a[108:111], v[52:55], v[136:139]
    ds_read_b64_tr_b16 a[26:27], v104 offset:41472
    ds_read_b64_tr_b16 a[28:29], v104 offset:45056
    v_mfma_f32_16x16x32_bf16 v[108:111], a[96:99], v[60:63], v[108:111]
    ds_read_b64_tr_b16 a[30:31], v104 offset:45568
    ds_read_b64_tr_b16 a[12:13], v104 offset:36864
    v_mfma_f32_16x16x32_bf16 v[108:111], a[112:115], v[64:67], v[108:111]
    ds_read_b64_tr_b16 a[14:15], v104 offset:37376
    s_mul_i32 s55, s5, 40
    s_add_u32 m0, s50, 147456
    v_mfma_f32_16x16x32_bf16 v[112:115], a[116:119], v[64:67], v[112:115]
    buffer_load_dwordx4 v19, s[32:35], s55 offen lds
    v_mfma_f32_16x16x32_bf16 v[112:115], a[100:103], v[60:63], v[112:115]
    ds_read_b128 v[76:79], v23 offset:53248
    v_mfma_f32_16x16x32_bf16 v[116:119], a[104:107], v[60:63], v[116:119]
    ds_read_b128 v[80:83], v24 offset:53248
    v_mfma_f32_16x16x32_bf16 v[116:119], a[120:123], v[64:67], v[116:119]
    s_add_u32 m0, s50, 148480
    v_mfma_f32_16x16x32_bf16 v[120:123], a[124:127], v[64:67], v[120:123]
    buffer_load_dwordx4 v20, s[32:35], s55 offen lds
    v_mfma_f32_16x16x32_bf16 v[120:123], a[108:111], v[60:63], v[120:123]
    s_waitcnt lgkmcnt(15)
    v_mfma_f32_16x16x32_bf16 v[204:207], a[0:3], v[68:71], v[204:207]
    ds_read_b128 v[84:87], v23 offset:57344
    s_waitcnt lgkmcnt(15)
    v_mfma_f32_16x16x32_bf16 v[204:207], a[16:19], v[72:75], v[204:207]
    ds_read_b128 v[88:91], v24 offset:57344
    s_add_u32 m0, s50, 149504
    s_waitcnt lgkmcnt(14)
    v_mfma_f32_16x16x32_bf16 v[208:211], a[20:23], v[72:75], v[208:211]
    buffer_load_dwordx4 v21, s[32:35], s55 offen lds
    s_waitcnt lgkmcnt(12)
    v_mfma_f32_16x16x32_bf16 v[208:211], a[4:7], v[68:71], v[208:211]
    s_waitcnt lgkmcnt(10)
    v_mfma_f32_16x16x32_bf16 v[212:215], a[8:11], v[68:71], v[212:215]
    s_waitcnt lgkmcnt(8)
    v_mfma_f32_16x16x32_bf16 v[212:215], a[24:27], v[72:75], v[212:215]
    s_add_u32 m0, s50, 150528
    s_waitcnt lgkmcnt(6)
    v_mfma_f32_16x16x32_bf16 v[216:219], a[28:31], v[72:75], v[216:219]
    buffer_load_dwordx4 v22, s[32:35], s55 offen lds
    s_waitcnt lgkmcnt(4)
    v_mfma_f32_16x16x32_bf16 v[216:219], a[12:15], v[68:71], v[216:219]
    s_waitcnt lgkmcnt(2)
    v_mfma_f32_16x16x32_bf16 v[188:191], a[0:3], v[76:79], v[188:191]
    ds_read_b128 v[92:95], v23 offset:61440
    v_mfma_f32_16x16x32_bf16 v[188:191], a[16:19], v[80:83], v[188:191]
    ds_read_b128 v[96:99], v24 offset:61440
    v_mfma_f32_16x16x32_bf16 v[192:195], a[20:23], v[80:83], v[192:195]
    v_mfma_f32_16x16x32_bf16 v[192:195], a[4:7], v[76:79], v[192:195]
    v_mfma_f32_16x16x32_bf16 v[196:199], a[8:11], v[76:79], v[196:199]
    v_mfma_f32_16x16x32_bf16 v[196:199], a[24:27], v[80:83], v[196:199]
    v_mfma_f32_16x16x32_bf16 v[200:203], a[28:31], v[80:83], v[200:203]
    v_mfma_f32_16x16x32_bf16 v[200:203], a[12:15], v[76:79], v[200:203]
    s_waitcnt lgkmcnt(2)
    v_mfma_f32_16x16x32_bf16 v[172:175], a[0:3], v[84:87], v[172:175]
    ds_read_b128 v[52:55], v25 offset:0
    v_mfma_f32_16x16x32_bf16 v[172:175], a[16:19], v[88:91], v[172:175]
    ds_read_b128 v[56:59], v26 offset:0
    v_mfma_f32_16x16x32_bf16 v[176:179], a[20:23], v[88:91], v[176:179]
    v_mfma_f32_16x16x32_bf16 v[176:179], a[4:7], v[84:87], v[176:179]
    v_mfma_f32_16x16x32_bf16 v[180:183], a[8:11], v[84:87], v[180:183]
    v_mfma_f32_16x16x32_bf16 v[180:183], a[24:27], v[88:91], v[180:183]
    v_mfma_f32_16x16x32_bf16 v[184:187], a[28:31], v[88:91], v[184:187]
    v_mfma_f32_16x16x32_bf16 v[184:187], a[12:15], v[84:87], v[184:187]
    s_waitcnt lgkmcnt(2)
    v_mfma_f32_16x16x32_bf16 v[156:159], a[0:3], v[92:95], v[156:159]
    ds_read_b128 v[60:63], v25 offset:4096
    v_mfma_f32_16x16x32_bf16 v[156:159], a[16:19], v[96:99], v[156:159]
    ds_read_b128 v[64:67], v26 offset:4096
    v_mfma_f32_16x16x32_bf16 v[160:163], a[20:23], v[96:99], v[160:163]
    v_mfma_f32_16x16x32_bf16 v[160:163], a[4:7], v[92:95], v[160:163]
    v_mfma_f32_16x16x32_bf16 v[164:167], a[8:11], v[92:95], v[164:167]
    v_mfma_f32_16x16x32_bf16 v[164:167], a[24:27], v[96:99], v[164:167]
    v_mfma_f32_16x16x32_bf16 v[168:171], a[28:31], v[96:99], v[168:171]
    v_mfma_f32_16x16x32_bf16 v[168:171], a[12:15], v[92:95], v[168:171]
    s_waitcnt lgkmcnt(2)
    v_mfma_f32_16x16x32_bf16 v[140:143], a[0:3], v[52:55], v[140:143]
    ds_read_b128 v[68:71], v25 offset:8192
    v_mfma_f32_16x16x32_bf16 v[140:143], a[16:19], v[56:59], v[140:143]
    ds_read_b128 v[72:75], v26 offset:8192
    v_mfma_f32_16x16x32_bf16 v[144:147], a[20:23], v[56:59], v[144:147]
    v_mfma_f32_16x16x32_bf16 v[144:147], a[4:7], v[52:55], v[144:147]
    v_mfma_f32_16x16x32_bf16 v[148:151], a[8:11], v[52:55], v[148:151]
    v_mfma_f32_16x16x32_bf16 v[148:151], a[24:27], v[56:59], v[148:151]
    v_mfma_f32_16x16x32_bf16 v[152:155], a[28:31], v[56:59], v[152:155]
    v_mfma_f32_16x16x32_bf16 v[152:155], a[12:15], v[52:55], v[152:155]
    s_waitcnt lgkmcnt(2)
    v_mfma_f32_16x16x32_bf16 v[124:127], a[0:3], v[60:63], v[124:127]
    s_waitcnt vmcnt(15)
    v_readfirstlane_b32 s52, v8
    s_nop 0
    s_or_b32 s52, s52, s48
    s_cmp_eq_u32 s52, 0
    s_cbranch_scc1 L_go_c0s
L_go_c0:
    s_waitcnt vmcnt(8) lgkmcnt(0)
    s_barrier
    ds_read_b64_tr_b16 a[32:33], v30 offset:12288
    v_mfma_f32_16x16x32_bf16 v[124:127], a[16:19], v[64:67], v[124:127]
    ds_read_b64_tr_b16 a[34:35], v30 offset:12800
    ds_read_b128 v[76:79], v25 offset:28672
    v_mfma_f32_16x16x32_bf16 v[128:131], a[20:23], v[64:67], v[128:131]
    ds_read_b64_tr_b16 a[48:49], v30 offset:20480
    ds_read_b64_tr_b16 a[50:51], v30 offset:20992
    v_mfma_f32_16x16x32_bf16 v[128:131], a[4:7], v[60:63], v[128:131]
    ds_read_b128 v[80:83], v26 offset:28672
    ds_read_b64_tr_b16 a[52:53], v30 offset:24576
    v_mfma_f32_16x16x32_bf16 v[132:135], a[8:11], v[60:63], v[132:135]
    ds_read_b64_tr_b16 a[54:55], v30 offset:25088
    ds_read_b64_tr_b16 a[36:37], v30 offset:16384
    v_mfma_f32_16x16x32_bf16 v[132:135], a[24:27], v[64:67], v[132:135]
    ds_read_b64_tr_b16 a[38:39], v30 offset:16896
    ds_read_b64_tr_b16 a[40:41], v105 offset:12288
    v_mfma_f32_16x16x32_bf16 v[136:139], a[28:31], v[64:67], v[136:139]
    ds_read_b64_tr_b16 a[42:43], v105 offset:12800
    ds_read_b64_tr_b16 a[56:57], v105 offset:20480
    v_mfma_f32_16x16x32_bf16 v[136:139], a[12:15], v[60:63], v[136:139]
    ds_read_b64_tr_b16 a[58:59], v105 offset:20992
    ds_read_b64_tr_b16 a[60:61], v105 offset:24576
    v_mfma_f32_16x16x32_bf16 v[108:111], a[0:3], v[68:71], v[108:111]
    ds_read_b64_tr_b16 a[62:63], v105 offset:25088
    ds_read_b64_tr_b16 a[44:45], v105 offset:16384
    v_mfma_f32_16x16x32_bf16 v[108:111], a[16:19], v[72:75], v[108:111]
    ds_read_b64_tr_b16 a[46:47], v105 offset:16896
    v_mfma_f32_16x16x32_bf16 v[112:115], a[20:23], v[72:75], v[112:115]
    ds_read_b128 v[84:87], v25 offset:32768
    v_mfma_f32_16x16x32_bf16 v[112:115], a[4:7], v[68:71], v[112:115]
    ds_read_b128 v[88:91], v26 offset:32768
    v_mfma_f32_16x16x32_bf16 v[116:119], a[8:11], v[68:71], v[116:119]
    v_mfma_f32_16x16x32_bf16 v[116:119], a[24:27], v[72:75], v[116:119]
    v_mfma_f32_16x16x32_bf16 v[120:123], a[28:31], v[72:75], v[120:123]
    v_mfma_f32_16x16x32_bf16 v[120:123], a[12:15], v[68:71], v[120:123]
    s_waitcnt lgkmcnt(15)
    v_mfma_f32_16x16x32_bf16 v[204:207], a[32:35], v[76:79], v[204:207]
    ds_read_b128 v[92:95], v25 offset:36864
    s_waitcnt lgkmcnt(15)
    v_mfma_f32_16x16x32_bf16 v[204:207], a[48:51], v[80:83], v[204:207]
    ds_read_b128 v[96:99], v26 offset:36864
    s_waitcnt lgkmcnt(14)
    v_mfma_f32_16x16x32_bf16 v[208:211], a[52:55], v[80:83], v[208:211]
    s_waitcnt lgkmcnt(12)
    v_mfma_f32_16x16x32_bf16 v[208:211], a[36:39], v[76:79], v[208:211]
    s_waitcnt lgkmcnt(10)
    v_mfma_f32_16x16x32_bf16 v[212:215], a[40:43], v[76:79], v[212:215]
    s_waitcnt lgkmcnt(8)
    v_mfma_f32_16x16x32_bf16 v[212:215], a[56:59], v[80:83], v[212:215]
    s_waitcnt lgkmcnt(6)
    v_mfma_f32_16x16x32_bf16 v[216:219], a[60:63], v[80:83], v[216:219]
    s_waitcnt lgkmcnt(4)
    v_mfma_f32_16x16x32_bf16 v[216:219], a[44:47], v[76:79], v[216:219]
    s_waitcnt lgkmcnt(2)
    v_mfma_f32_16x16x32_bf16 v[188:191], a[32:35], v[84:87], v[188:191]
    ds_read_b128 v[52:55], v25 offset:40960
    v_mfma_f32_16x16x32_bf16 v[188:191], a[48:51], v[88:91], v[188:191]
    ds_read_b128 v[56:59], v26 offset:40960
    v_mfma_f32_16x16x32_bf16 v[192:195], a[52:55], v[88:91], v[192:195]
    v_mfma_f32_16x16x32_bf16 v[192:195], a[36:39], v[84:87], v[192:195]
    v_mfma_f32_16x16x32_bf16 v[196:199], a[40:43], v[84:87], v[196:199]
    v_mfma_f32_16x16x32_bf16 v[196:199], a[56:59], v[88:91], v[196:199]
    v_mfma_f32_16x16x32_bf16 v[200:203], a[60:63], v[88:91], v[200:203]
    v_mfma_f32_16x16x32_bf16 v[200:203], a[44:47], v[84:87], v[200:203]
    s_waitcnt lgkmcnt(2)
    v_mfma_f32_16x16x32_bf16 v[172:175], a[32:35], v[92:95], v[172:175]
    ds_read_b128 v[60:63], v25 offset:45056
    v_mfma_f32_16x16x32_bf16 v[172:175], a[48:51], v[96:99], v[172:175]
    ds_read_b128 v[64:67], v26 offset:45056
    v_mfma_f32_16x16x32_bf16 v[176:179], a[52:55], v[96:99], v[176:179]
    v_mfma_f32_16x16x32_bf16 v[176:179], a[36:39], v[92:95], v[176:179]
    v_mfma_f32_16x16x32_bf16 v[180:183], a[40:43], v[92:95], v[180:183]
    v_mfma_f32_16x16x32_bf16 v[180:183], a[56:59], v[96:99], v[180:183]
    v_mfma_f32_16x16x32_bf16 v[184:187], a[60:63], v[96:99], v[184:187]
    v_mfma_f32_16x16x32_bf16 v[184:187], a[44:47], v[92:95], v[184:187]
    s_waitcnt lgkmcnt(2)
    v_mfma_f32_16x16x32_bf16 v[156:159], a[32:35], v[52:55], v[156:159]
    ds_read_b128 v[68:71], v25 offset:49152
    v_mfma_f32_16x16x32_bf16 v[156:159], a[48:51], v[56:59], v[156:159]
    ds_read_b128 v[72:75], v26 offset:49152
    v_mfma_f32_16x16x32_bf16 v[160:163], a[52:55], v[56:59], v[160:163]
    v_mfma_f32_16x16x32_bf16 v[160:163], a[36:39], v[52:55], v[160:163]
    v_mfma_f32_16x16x32_bf16 v[164:167], a[40:43], v[52:55], v[164:167]
    v_mfma_f32_16x16x32_bf16 v[164:167], a[56:59], v[56:59], v[164:167]
    v_mfma_f32_16x16x32_bf16 v[168:171], a[60:63], v[56:59], v[168:171]
    v_mfma_f32_16x16x32_bf16 v[168:171], a[44:47], v[52:55], v[168:171]
    s_waitcnt lgkmcnt(2)
    v_mfma_f32_16x16x32_bf16 v[140:143], a[32:35], v[60:63], v[140:143]
    ds_read_b128 v[76:79], v25 offset:53248
    v_mfma_f32_16x16x32_bf16 v[140:143], a[48:51], v[64:67], v[140:143]
    ds_read_b128 v[80:83], v26 offset:53248
    v_mfma_f32_16x16x32_bf16 v[144:147], a[52:55], v[64:67], v[144:147]
    v_mfma_f32_16x16x32_bf16 v[144:147], a[36:39], v[60:63], v[144:147]
    v_mfma_f32_16x16x32_bf16 v[148:151], a[40:43], v[60:63], v[148:151]
    v_mfma_f32_16x16x32_bf16 v[148:151], a[56:59], v[64:67], v[148:151]
    v_mfma_f32_16x16x32_bf16 v[152:155], a[60:63], v[64:67], v[152:155]
    v_mfma_f32_16x16x32_bf16 v[152:155], a[44:47], v[60:63], v[152:155]
    s_waitcnt lgkmcnt(2)
    v_mfma_f32_16x16x32_bf16 v[124:127], a[32:35], v[68:71], v[124:127]
    v_mfma_f32_16x16x32_bf16 v[124:127], a[48:51], v[72:75], v[124:127]
    v_mfma_f32_16x16x32_bf16 v[128:131], a[52:55], v[72:75], v[128:131]
    v_mfma_f32_16x16x32_bf16 v[128:131], a[36:39], v[68:71], v[128:131]
    v_mfma_f32_16x16x32_bf16 v[132:135], a[40:43], v[68:71], v[132:135]
    v_mfma_f32_16x16x32_bf16 v[132:135], a[56:59], v[72:75], v[132:135]
    v_mfma_f32_16x16x32_bf16 v[136:139], a[60:63], v[72:75], v[136:139]
    v_mfma_f32_16x16x32_bf16 v[136:139], a[44:47], v[68:71], v[136:139]
    s_waitcnt lgkmcnt(0)
    v_mfma_f32_16x16x32_bf16 v[108:111], a[32:35], v[76:79], v[108:111]
    v_mfma_f32_16x16x32_bf16 v[108:111], a[48:51], v[80:83], v[108:111]
    v_mfma_f32_16x16x32_bf16 v[112:115], a[52:55], v[80:83], v[112:115]
    v_mfma_f32_16x16x32_bf16 v[112:115], a[36:39], v[76:79], v[112:115]
    v_mfma_f32_16x16x32_bf16 v[116:119], a[40:43], v[76:79], v[116:119]
    v_mfma_f32_16x16x32_bf16 v[116:119], a[56:59], v[80:83], v[116:119]
    v_mfma_f32_16x16x32_bf16 v[120:123], a[60:63], v[80:83], v[120:123]
    v_mfma_f32_16x16x32_bf16 v[120:123], a[44:47], v[76:79], v[120:123]
L_tail:
    .p2align 3
    v_pk_mul_f32 v[100:101], v[204:205], v[204:205]
    v_pk_mul_f32 v[102:103], v[206:207], v[206:207]
    v_pk_mul_f32 v[104:105], v[212:213], v[212:213]
    v_pk_mul_f32 v[106:107], v[214:215], v[214:215]
    v_pk_fma_f32 v[100:101], v[100:101], s[62:63], s[62:63] op_sel:[0,0,1] op_sel_hi:[1,0,1]
    v_pk_fma_f32 v[102:103], v[102:103], s[62:63], s[62:63] op_sel:[0,0,1] op_sel_hi:[1,0,1]
    v_pk_fma_f32 v[104:105], v[104:105], s[62:63], s[62:63] op_sel:[0,0,1] op_sel_hi:[1,0,1]
    v_pk_fma_f32 v[106:107], v[106:107], s[62:63], s[62:63] op_sel:[0,0,1] op_sel_hi:[1,0,1]
    v_pk_mul_f32 v[100:101], v[100:101], v[204:205]
    v_pk_mul_f32 v[102:103], v[102:103], v[206:207]
    v_pk_mul_f32 v[104:105], v[104:105], v[212:213]
    v_pk_mul_f32 v[106:107], v[106:107], v[214:215]
    v_exp_f32 v100, v100
    v_exp_f32 v101, v101
    v_exp_f32 v102, v102
    v_exp_f32 v103, v103
    v_exp_f32 v104, v104
    v_exp_f32 v105, v105
    v_exp_f32 v106, v106
    v_exp_f32 v107, v107
    v_pk_add_f32 v[100:101], v[100:101], 1.0 op_sel_hi:[1,0]
    v_pk_add_f32 v[102:103], v[102:103], 1.0 op_sel_hi:[1,0]
    v_pk_add_f32 v[104:105], v[104:105], 1.0 op_sel_hi:[1,0]
    v_pk_add_f32 v[106:107], v[106:107], 1.0 op_sel_hi:[1,0]
    v_rcp_f32 v100, v100
    v_rcp_f32 v101, v101
    v_rcp_f32 v102, v102
    v_rcp_f32 v103, v103
    v_rcp_f32 v104, v104
    v_rcp_f32 v105, v105
    v_rcp_f32 v106, v106
    v_rcp_f32 v107, v107
    v_pk_mul_f32 v[100:101], v[100:101], v[204:205]
    v_pk_mul_f32 v[102:103], v[102:103], v[206:207]
    v_pk_mul_f32 v[104:105], v[104:105], v[212:213]
    v_pk_mul_f32 v[106:107], v[106:107], v[214:215]
    v_pk_mul_f32 v[100:101], v[100:101], v[208:209]
    v_pk_mul_f32 v[102:103], v[102:103], v[210:211]
    v_pk_mul_f32 v[104:105], v[104:105], v[216:217]
    v_pk_mul_f32 v[106:107], v[106:107], v[218:219]
    v_cvt_pk_bf16_f32 v204, v100, v101
    v_cvt_pk_bf16_f32 v205, v102, v103
    v_cvt_pk_bf16_f32 v206, v104, v105
    v_cvt_pk_bf16_f32 v207, v106, v107
    buffer_store_dwordx4 v[204:207], v44, s[40:43], s54 offen sc1
    v_pk_mul_f32 v[100:101], v[188:189], v[188:189]
    v_pk_mul_f32 v[102:103], v[190:191], v[190:191]
    v_pk_mul_f32 v[104:105], v[196:197], v[196:197]
    v_pk_mul_f32 v[106:107], v[198:199], v[198:199]
    v_pk_fma_f32 v[100:101], v[100:101], s[62:63], s[62:63] op_sel:[0,0,1] op_sel_hi:[1,0,1]
    v_pk_fma_f32 v[102:103], v[102:103], s[62:63], s[62:63] op_sel:[0,0,1] op_sel_hi:[1,0,1]
    v_pk_fma_f32 v[104:105], v[104:105], s[62:63], s[62:63] op_sel:[0,0,1] op_sel_hi:[1,0,1]
    v_pk_fma_f32 v[106:107], v[106:107], s[62:63], s[62:63] op_sel:[0,0,1] op_sel_hi:[1,0,1]
    v_pk_mul_f32 v[100:101], v[100:101], v[188:189]
    v_pk_mul_f32 v[102:103], v[102:103], v[190:191]
    v_pk_mul_f32 v[104:105], v[104:105], v[196:197]
    v_pk_mul_f32 v[106:107], v[106:107], v[198:199]
    v_exp_f32_e64 v100, v100
    v_exp_f32 v101, v101
    s_add_u32 s54, s54, s60
    v_exp_f32 v102, v102
    v_exp_f32 v103, v103
    v_exp_f32 v104, v104
    v_exp_f32 v105, v105
    v_exp_f32 v106, v106
    v_exp_f32 v107, v107
    v_pk_add_f32 v[100:101], v[100:101], 1.0 op_sel_hi:[1,0]
    v_pk_add_f32 v[102:103], v[102:103], 1.0 op_sel_hi:[1,0]
    v_pk_add_f32 v[104:105], v[104:105], 1.0 op_sel_hi:[1,0]
    v_pk_add_f32 v[106:107], v[106:107], 1.0 op_sel_hi:[1,0]
    v_rcp_f32 v100, v100
    v_rcp_f32 v101, v101
    v_rcp_f32 v102, v102
    v_rcp_f32 v103, v103
    v_rcp_f32 v104, v104
    v_rcp_f32 v105, v105
    v_rcp_f32 v106, v106
    v_rcp_f32 v107, v107
    v_pk_mul_f32 v[100:101], v[100:101], v[188:189]
    v_pk_mul_f32 v[102:103], v[102:103], v[190:191]
    v_pk_mul_f32 v[104:105], v[104:105], v[196:197]
    v_pk_mul_f32 v[106:107], v[106:107], v[198:199]
    v_pk_mul_f32 v[100:101], v[100:101], v[192:193]
    v_pk_mul_f32 v[102:103], v[102:103], v[194:195]
    v_pk_mul_f32 v[104:105], v[104:105], v[200:201]
    v_pk_mul_f32 v[106:107], v[106:107], v[202:203]
    v_cvt_pk_bf16_f32 v188, v100, v101
    v_cvt_pk_bf16_f32 v189, v102, v103
    v_cvt_pk_bf16_f32 v190, v104, v105
    v_cvt_pk_bf16_f32 v191, v106, v107
    buffer_store_dwordx4 v[188:191], v44, s[40:43], s54 offen sc1
    v_pk_mul_f32 v[100:101], v[172:173], v[172:173]
    v_pk_mul_f32 v[102:103], v[174:175], v[174:175]
    v_pk_mul_f32 v[104:105], v[180:181], v[180:181]
    v_pk_mul_f32 v[106:107], v[182:183], v[182:183]
    v_pk_fma_f32 v[100:101], v[100:101], s[62:63], s[62:63] op_sel:[0,0,1] op_sel_hi:[1,0,1]
    v_pk_fma_f32 v[102:103], v[102:103], s[62:63], s[62:63] op_sel:[0,0,1] op_sel_hi:[1,0,1]
    v_pk_fma_f32 v[104:105], v[104:105], s[62:63], s[62:63] op_sel:[0,0,1] op_sel_hi:[1,0,1]
    v_pk_fma_f32 v[106:107], v[106:107], s[62:63], s[62:63] op_sel:[0,0,1] op_sel_hi:[1,0,1]
    v_pk_mul_f32 v[100:101], v[100:101], v[172:173]
    v_pk_mul_f32 v[102:103], v[102:103], v[174:175]
    v_pk_mul_f32 v[104:105], v[104:105], v[180:181]
    v_pk_mul_f32 v[106:107], v[106:107], v[182:183]
    v_exp_f32_e64 v100, v100
    v_exp_f32 v101, v101
    s_add_u32 s54, s54, s60
    v_exp_f32 v102, v102
    v_exp_f32 v103, v103
    v_exp_f32 v104, v104
    v_exp_f32 v105, v105
    v_exp_f32 v106, v106
    v_exp_f32 v107, v107
    v_pk_add_f32 v[100:101], v[100:101], 1.0 op_sel_hi:[1,0]
    v_pk_add_f32 v[102:103], v[102:103], 1.0 op_sel_hi:[1,0]
    v_pk_add_f32 v[104:105], v[104:105], 1.0 op_sel_hi:[1,0]
    v_pk_add_f32 v[106:107], v[106:107], 1.0 op_sel_hi:[1,0]
    v_rcp_f32 v100, v100
    v_rcp_f32 v101, v101
    v_rcp_f32 v102, v102
    v_rcp_f32 v103, v103
    v_rcp_f32 v104, v104
    v_rcp_f32 v105, v105
    v_rcp_f32 v106, v106
    v_rcp_f32 v107, v107
    v_pk_mul_f32 v[100:101], v[100:101], v[172:173]
    v_pk_mul_f32 v[102:103], v[102:103], v[174:175]
    v_pk_mul_f32 v[104:105], v[104:105], v[180:181]
    v_pk_mul_f32 v[106:107], v[106:107], v[182:183]
    v_pk_mul_f32 v[100:101], v[100:101], v[176:177]
    v_pk_mul_f32 v[102:103], v[102:103], v[178:179]
    v_pk_mul_f32 v[104:105], v[104:105], v[184:185]
    v_pk_mul_f32 v[106:107], v[106:107], v[186:187]
    v_cvt_pk_bf16_f32 v172, v100, v101
    v_cvt_pk_bf16_f32 v173, v102, v103
    v_cvt_pk_bf16_f32 v174, v104, v105
    v_cvt_pk_bf16_f32 v175, v106, v107
    buffer_store_dwordx4 v[172:175], v44, s[40:43], s54 offen sc1
    v_pk_mul_f32 v[100:101], v[156:157], v[156:157]
    v_pk_mul_f32 v[102:103], v[158:159], v[158:159]
    v_pk_mul_f32 v[104:105], v[164:165], v[164:165]
    v_pk_mul_f32 v[106:107], v[166:167], v[166:167]
    v_pk_fma_f32 v[100:101], v[100:101], s[62:63], s[62:63] op_sel:[0,0,1] op_sel_hi:[1,0,1]
    v_pk_fma_f32 v[102:103], v[102:103], s[62:63], s[62:63] op_sel:[0,0,1] op_sel_hi:[1,0,1]
    v_pk_fma_f32 v[104:105], v[104:105], s[62:63], s[62:63] op_sel:[0,0,1] op_sel_hi:[1,0,1]
    v_pk_fma_f32 v[106:107], v[106:107], s[62:63], s[62:63] op_sel:[0,0,1] op_sel_hi:[1,0,1]
    v_pk_mul_f32 v[100:101], v[100:101], v[156:157]
    v_pk_mul_f32 v[102:103], v[102:103], v[158:159]
    v_pk_mul_f32 v[104:105], v[104:105], v[164:165]
    v_pk_mul_f32 v[106:107], v[106:107], v[166:167]
    v_exp_f32_e64 v100, v100
    v_exp_f32 v101, v101
    s_add_u32 s54, s54, s60
    v_exp_f32 v102, v102
    v_exp_f32 v103, v103
    v_exp_f32 v104, v104
    v_exp_f32 v105, v105
    v_exp_f32 v106, v106
    v_exp_f32 v107, v107
    v_pk_add_f32 v[100:101], v[100:101], 1.0 op_sel_hi:[1,0]
    v_pk_add_f32 v[102:103], v[102:103], 1.0 op_sel_hi:[1,0]
    v_pk_add_f32 v[104:105], v[104:105], 1.0 op_sel_hi:[1,0]
    v_pk_add_f32 v[106:107], v[106:107], 1.0 op_sel_hi:[1,0]
    v_rcp_f32 v100, v100
    v_rcp_f32 v101, v101
    v_rcp_f32 v102, v102
    v_rcp_f32 v103, v103
    v_rcp_f32 v104, v104
    v_rcp_f32 v105, v105
    v_rcp_f32 v106, v106
    v_rcp_f32 v107, v107
    v_pk_mul_f32 v[100:101], v[100:101], v[156:157]
    v_pk_mul_f32 v[102:103], v[102:103], v[158:159]
    v_pk_mul_f32 v[104:105], v[104:105], v[164:165]
    v_pk_mul_f32 v[106:107], v[106:107], v[166:167]
    v_pk_mul_f32 v[100:101], v[100:101], v[160:161]
    v_pk_mul_f32 v[102:103], v[102:103], v[162:163]
    v_pk_mul_f32 v[104:105], v[104:105], v[168:169]
    v_pk_mul_f32 v[106:107], v[106:107], v[170:171]
    v_cvt_pk_bf16_f32 v156, v100, v101
    v_cvt_pk_bf16_f32 v157, v102, v103
    v_cvt_pk_bf16_f32 v158, v104, v105
    v_cvt_pk_bf16_f32 v159, v106, v107
    buffer_store_dwordx4 v[156:159], v44, s[40:43], s54 offen sc1
    v_pk_mul_f32 v[100:101], v[140:141], v[140:141]
    v_pk_mul_f32 v[102:103], v[142:143], v[142:143]
    v_pk_mul_f32 v[104:105], v[148:149], v[148:149]
    v_pk_mul_f32 v[106:107], v[150:151], v[150:151]
    v_pk_fma_f32 v[100:101], v[100:101], s[62:63], s[62:63] op_sel:[0,0,1] op_sel_hi:[1,0,1]
    v_pk_fma_f32 v[102:103], v[102:103], s[62:63], s[62:63] op_sel:[0,0,1] op_sel_hi:[1,0,1]
    v_pk_fma_f32 v[104:105], v[104:105], s[62:63], s[62:63] op_sel:[0,0,1] op_sel_hi:[1,0,1]
    v_pk_fma_f32 v[106:107], v[106:107], s[62:63], s[62:63] op_sel:[0,0,1] op_sel_hi:[1,0,1]
    v_pk_mul_f32 v[100:101], v[100:101], v[140:141]
    v_pk_mul_f32 v[102:103], v[102:103], v[142:143]
    v_pk_mul_f32 v[104:105], v[104:105], v[148:149]
    v_pk_mul_f32 v[106:107], v[106:107], v[150:151]
    v_exp_f32_e64 v100, v100
    v_exp_f32 v101, v101
    s_add_u32 s54, s54, s60
    v_exp_f32 v102, v102
    v_exp_f32 v103, v103
    v_exp_f32 v104, v104
    v_exp_f32 v105, v105
    v_exp_f32 v106, v106
    v_exp_f32 v107, v107
    v_pk_add_f32 v[100:101], v[100:101], 1.0 op_sel_hi:[1,0]
    v_pk_add_f32 v[102:103], v[102:103], 1.0 op_sel_hi:[1,0]
    v_pk_add_f32 v[104:105], v[104:105], 1.0 op_sel_hi:[1,0]
    v_pk_add_f32 v[106:107], v[106:107], 1.0 op_sel_hi:[1,0]
    v_rcp_f32 v100, v100
    v_rcp_f32 v101, v101
    v_rcp_f32 v102, v102
    v_rcp_f32 v103, v103
    v_rcp_f32 v104, v104
    v_rcp_f32 v105, v105
    v_rcp_f32 v106, v106
    v_rcp_f32 v107, v107
    v_pk_mul_f32 v[100:101], v[100:101], v[140:141]
    v_pk_mul_f32 v[102:103], v[102:103], v[142:143]
    v_pk_mul_f32 v[104:105], v[104:105], v[148:149]
    v_pk_mul_f32 v[106:107], v[106:107], v[150:151]
    v_pk_mul_f32 v[100:101], v[100:101], v[144:145]
    v_pk_mul_f32 v[102:103], v[102:103], v[146:147]
    v_pk_mul_f32 v[104:105], v[104:105], v[152:153]
    v_pk_mul_f32 v[106:107], v[106:107], v[154:155]
    v_cvt_pk_bf16_f32 v140, v100, v101
    v_cvt_pk_bf16_f32 v141, v102, v103
    v_cvt_pk_bf16_f32 v142, v104, v105
    v_cvt_pk_bf16_f32 v143, v106, v107
    buffer_store_dwordx4 v[140:143], v44, s[40:43], s54 offen sc1
    v_pk_mul_f32 v[100:101], v[124:125], v[124:125]
    v_pk_mul_f32 v[102:103], v[126:127], v[126:127]
    v_pk_mul_f32 v[104:105], v[132:133], v[132:133]
    v_pk_mul_f32 v[106:107], v[134:135], v[134:135]
    v_pk_fma_f32 v[100:101], v[100:101], s[62:63], s[62:63] op_sel:[0,0,1] op_sel_hi:[1,0,1]
    v_pk_fma_f32 v[102:103], v[102:103], s[62:63], s[62:63] op_sel:[0,0,1] op_sel_hi:[1,0,1]
    v_pk_fma_f32 v[104:105], v[104:105], s[62:63], s[62:63] op_sel:[0,0,1] op_sel_hi:[1,0,1]
    v_pk_fma_f32 v[106:107], v[106:107], s[62:63], s[62:63] op_sel:[0,0,1] op_sel_hi:[1,0,1]
    v_pk_mul_f32 v[100:101], v[100:101], v[124:125]
    v_pk_mul_f32 v[102:103], v[102:103], v[126:127]
    v_pk_mul_f32 v[104:105], v[104:105], v[132:133]
    v_pk_mul_f32 v[106:107], v[106:107], v[134:135]
    v_exp_f32_e64 v100, v100
    v_exp_f32 v101, v101
    s_add_u32 s54, s54, s60
    v_exp_f32 v102, v102
    v_exp_f32 v103, v103
    v_exp_f32 v104, v104
    v_exp_f32 v105, v105
    v_exp_f32 v106, v106
    v_exp_f32 v107, v107
    v_pk_add_f32 v[100:101], v[100:101], 1.0 op_sel_hi:[1,0]
    v_pk_add_f32 v[102:103], v[102:103], 1.0 op_sel_hi:[1,0]
    v_pk_add_f32 v[104:105], v[104:105], 1.0 op_sel_hi:[1,0]
    v_pk_add_f32 v[106:107], v[106:107], 1.0 op_sel_hi:[1,0]
    v_rcp_f32 v100, v100
    v_rcp_f32 v101, v101
    v_rcp_f32 v102, v102
    v_rcp_f32 v103, v103
    v_rcp_f32 v104, v104
    v_rcp_f32 v105, v105
    v_rcp_f32 v106, v106
    v_rcp_f32 v107, v107
    v_pk_mul_f32 v[100:101], v[100:101], v[124:125]
    v_pk_mul_f32 v[102:103], v[102:103], v[126:127]
    v_pk_mul_f32 v[104:105], v[104:105], v[132:133]
    v_pk_mul_f32 v[106:107], v[106:107], v[134:135]
    v_pk_mul_f32 v[100:101], v[100:101], v[128:129]
    v_pk_mul_f32 v[102:103], v[102:103], v[130:131]
    v_pk_mul_f32 v[104:105], v[104:105], v[136:137]
    v_pk_mul_f32 v[106:107], v[106:107], v[138:139]
    v_cvt_pk_bf16_f32 v124, v100, v101
    v_cvt_pk_bf16_f32 v125, v102, v103
    v_cvt_pk_bf16_f32 v126, v104, v105
    v_cvt_pk_bf16_f32 v127, v106, v107
    buffer_store_dwordx4 v[124:127], v44, s[40:43], s54 offen sc1
    v_pk_mul_f32 v[100:101], v[108:109], v[108:109]
    v_pk_mul_f32 v[102:103], v[110:111], v[110:111]
    v_pk_mul_f32 v[104:105], v[116:117], v[116:117]
    v_pk_mul_f32 v[106:107], v[118:119], v[118:119]
    v_pk_fma_f32 v[100:101], v[100:101], s[62:63], s[62:63] op_sel:[0,0,1] op_sel_hi:[1,0,1]
    v_pk_fma_f32 v[102:103], v[102:103], s[62:63], s[62:63] op_sel:[0,0,1] op_sel_hi:[1,0,1]
    v_pk_fma_f32 v[104:105], v[104:105], s[62:63], s[62:63] op_sel:[0,0,1] op_sel_hi:[1,0,1]
    v_pk_fma_f32 v[106:107], v[106:107], s[62:63], s[62:63] op_sel:[0,0,1] op_sel_hi:[1,0,1]
    v_pk_mul_f32 v[100:101], v[100:101], v[108:109]
    v_pk_mul_f32 v[102:103], v[102:103], v[110:111]
    v_pk_mul_f32 v[104:105], v[104:105], v[116:117]
    v_pk_mul_f32 v[106:107], v[106:107], v[118:119]
    v_exp_f32_e64 v100, v100
    v_exp_f32 v101, v101
    s_add_u32 s54, s54, s60
    v_exp_f32 v102, v102
    v_exp_f32 v103, v103
    v_exp_f32 v104, v104
    v_exp_f32 v105, v105
    v_exp_f32 v106, v106
    v_exp_f32 v107, v107
    v_pk_add_f32 v[100:101], v[100:101], 1.0 op_sel_hi:[1,0]
    v_pk_add_f32 v[102:103], v[102:103], 1.0 op_sel_hi:[1,0]
    v_pk_add_f32 v[104:105], v[104:105], 1.0 op_sel_hi:[1,0]
    v_pk_add_f32 v[106:107], v[106:107], 1.0 op_sel_hi:[1,0]
    v_rcp_f32 v100, v100
    v_rcp_f32 v101, v101
    v_rcp_f32 v102, v102
    v_rcp_f32 v103, v103
    v_rcp_f32 v104, v104
    v_rcp_f32 v105, v105
    v_rcp_f32 v106, v106
    v_rcp_f32 v107, v107
    v_pk_mul_f32 v[100:101], v[100:101], v[108:109]
    v_pk_mul_f32 v[102:103], v[102:103], v[110:111]
    v_pk_mul_f32 v[104:105], v[104:105], v[116:117]
    v_pk_mul_f32 v[106:107], v[106:107], v[118:119]
    v_pk_mul_f32 v[100:101], v[100:101], v[112:113]
    v_pk_mul_f32 v[102:103], v[102:103], v[114:115]
    v_pk_mul_f32 v[104:105], v[104:105], v[120:121]
    v_pk_mul_f32 v[106:107], v[106:107], v[122:123]
    v_cvt_pk_bf16_f32 v108, v100, v101
    v_cvt_pk_bf16_f32 v109, v102, v103
    v_cvt_pk_bf16_f32 v110, v104, v105
    v_cvt_pk_bf16_f32 v111, v106, v107
    buffer_store_dwordx4 v[108:111], v44, s[40:43], s54 offen sc1
    s_branch L_pg1
    .p2align 12
L_pg1:
    s_waitcnt lgkmcnt(0)
    s_barrier
    s_waitcnt vmcnt(11)
    ds_read_b64_tr_b16 a[160:161], v40 offset:0
    ds_read_b64_tr_b16 a[162:163], v40 offset:2048
    ds_read_b64_tr_b16 a[164:165], v41 offset:0
    ds_read_b64_tr_b16 a[166:167], v41 offset:2048
    ds_read_b64_tr_b16 a[168:169], v42 offset:0
    ds_read_b64_tr_b16 a[170:171], v42 offset:2048
    ds_read_b64_tr_b16 a[172:173], v43 offset:0
    ds_read_b64_tr_b16 a[174:175], v43 offset:2048
    s_waitcnt vmcnt(7)
    ds_read_b64_tr_b16 a[176:177], v40 offset:16384
    ds_read_b64_tr_b16 a[178:179], v40 offset:18432
    ds_read_b64_tr_b16 a[180:181], v41 offset:16384
    ds_read_b64_tr_b16 a[182:183], v41 offset:18432
    ds_read_b64_tr_b16 a[184:185], v42 offset:16384
    ds_read_b64_tr_b16 a[186:187], v42 offset:18432
    ds_read_b64_tr_b16 a[188:189], v43 offset:16384
    ds_read_b64_tr_b16 a[190:191], v43 offset:18432
    s_waitcnt lgkmcnt(0)
    s_waitcnt vmcnt(0)
    s_mov_b32 s57, 7
    s_atomic_umax s57, s[40:41], s69
    s_mul_i32 s55, s6, 40
    s_add_u32 m0, s50, 0
    s_nop 0
    buffer_load_dwordx4 v19, s[32:35], s55 offen lds
    s_add_u32 m0, s50, 1024
    s_nop 0
    buffer_load_dwordx4 v20, s[32:35], s55 offen lds
    s_add_u32 m0, s50, 2048
    s_nop 0
    buffer_load_dwordx4 v21, s[32:35], s55 offen lds
    s_add_u32 m0, s50, 3072
    s_nop 0
    buffer_load_dwordx4 v22, s[32:35], s55 offen lds
    s_mul_i32 s55, s7, 40
    s_add_u32 m0, s50, 16384
    s_nop 0
    buffer_load_dwordx4 v19, s[32:35], s55 offen lds
    s_add_u32 m0, s50, 17408
    s_nop 0
    buffer_load_dwordx4 v20, s[32:35], s55 offen lds
    s_add_u32 m0, s50, 18432
    s_nop 0
    buffer_load_dwordx4 v21, s[32:35], s55 offen lds
    s_add_u32 m0, s50, 19456
    s_nop 0
    buffer_load_dwordx4 v22, s[32:35], s55 offen lds
    s_mul_i32 s55, s8, 40
    s_add_u32 m0, s50, 32768
    s_nop 0
    buffer_load_dwordx4 v19, s[32:35], s55 offen lds
    s_add_u32 m0, s50, 33792
    s_nop 0
    buffer_load_dwordx4 v20, s[32:35], s55 offen lds
    s_add_u32 m0, s50, 34816
    s_nop 0
    buffer_load_dwordx4 v21, s[32:35], s55 offen lds
    s_waitcnt vmcnt(10)
    s_add_u32 m0, s50, 35840
    s_nop 0
    buffer_load_dwordx4 v22, s[32:35], s55 offen lds
    s_waitcnt vmcnt(10)
    s_mul_i32 s55, s9, 40
    s_add_u32 m0, s50, 49152
    s_nop 0
    buffer_load_dwordx4 v19, s[32:35], s55 offen lds
    s_waitcnt vmcnt(10)
    s_add_u32 m0, s50, 50176
    s_nop 0
    buffer_load_dwordx4 v20, s[32:35], s55 offen lds
    s_waitcnt vmcnt(10)
    ds_read_b64_tr_b16 a[192:193], v32 offset:0
    ds_read_b64_tr_b16 a[194:195], v32 offset:2048
    ds_read_b64_tr_b16 a[196:197], v33 offset:0
    s_add_u32 m0, s50, 51200
    s_nop 0
    buffer_load_dwordx4 v21, s[32:35], s55 offen lds
    s_waitcnt vmcnt(10)
    ds_read_b64_tr_b16 a[198:199], v33 offset:2048
    ds_read_b64_tr_b16 a[200:201], v34 offset:0
    ds_read_b64_tr_b16 a[202:203], v34 offset:2048
    s_add_u32 m0, s50, 52224
    s_nop 0
    buffer_load_dwordx4 v22, s[32:35], s55 offen lds
    s_waitcnt vmcnt(10)
    ds_read_b64_tr_b16 a[204:205], v35 offset:0
    ds_read_b64_tr_b16 a[206:207], v35 offset:2048
    s_mul_i32 s55, s10, 40
    s_add_u32 m0, s50, 65536
    s_nop 0
    buffer_load_dwordx4 v19, s[32:35], s55 offen lds
    s_waitcnt vmcnt(10)
    s_add_u32 m0, s50, 66560
    s_nop 0
    buffer_load_dwordx4 v20, s[32:35], s55 offen lds
    s_waitcnt vmcnt(10)
    ds_read_b64_tr_b16 a[208:209], v32 offset:16384
    ds_read_b64_tr_b16 a[210:211], v32 offset:18432
    ds_read_b64_tr_b16 a[212:213], v33 offset:16384
    s_add_u32 m0, s50, 67584
    s_nop 0
    buffer_load_dwordx4 v21, s[32:35], s55 offen lds
    s_waitcnt vmcnt(10)
    ds_read_b64_tr_b16 a[214:215], v33 offset:18432
    ds_read_b64_tr_b16 a[216:217], v34 offset:16384
    ds_read_b64_tr_b16 a[218:219], v34 offset:18432
    s_add_u32 m0, s50, 68608
    s_nop 0
    buffer_load_dwordx4 v22, s[32:35], s55 offen lds
    s_waitcnt vmcnt(10)
    ds_read_b64_tr_b16 a[220:221], v35 offset:16384
    ds_read_b64_tr_b16 a[222:223], v35 offset:18432
    s_mul_i32 s55, s11, 40
    s_add_u32 m0, s50, 81920
    s_nop 0
    buffer_load_dwordx4 v19, s[32:35], s55 offen lds
    s_waitcnt vmcnt(10)
    s_add_u32 m0, s50, 82944
    s_nop 0
    buffer_load_dwordx4 v20, s[32:35], s55 offen lds
    s_waitcnt vmcnt(10)
    ds_read_b64_tr_b16 a[224:225], v32 offset:32768
    ds_read_b64_tr_b16 a[226:227], v32 offset:34816
    ds_read_b64_tr_b16 a[228:229], v33 offset:32768
    s_add_u32 m0, s50, 83968
    s_nop 0
    buffer_load_dwordx4 v21, s[32:35], s55 offen lds
    s_waitcnt vmcnt(10)
    ds_read_b64_tr_b16 a[230:231], v33 offset:34816
    ds_read_b64_tr_b16 a[232:233], v34 offset:32768
    ds_read_b64_tr_b16 a[234:235], v34 offset:34816
    s_add_u32 m0, s50, 84992
    s_nop 0
    buffer_load_dwordx4 v22, s[32:35], s55 offen lds
    s_waitcnt vmcnt(10)
    ds_read_b64_tr_b16 a[236:237], v35 offset:32768
    ds_read_b64_tr_b16 a[238:239], v35 offset:34816
    s_mul_i32 s55, s12, 40
    s_add_u32 m0, s50, 98304
    s_nop 0
    buffer_load_dwordx4 v19, s[32:35], s55 offen lds
    s_waitcnt vmcnt(10)
    s_add_u32 m0, s50, 99328
    s_nop 0
    buffer_load_dwordx4 v20, s[32:35], s55 offen lds
    s_waitcnt vmcnt(10)
    ds_read_b64_tr_b16 a[240:241], v32 offset:49152
    ds_read_b64_tr_b16 a[242:243], v32 offset:51200
    ds_read_b64_tr_b16 a[244:245], v33 offset:49152
    s_add_u32 m0, s50, 100352
    s_nop 0
    buffer_load_dwordx4 v21, s[32:35], s55 offen lds
    s_waitcnt vmcnt(10)
    ds_read_b64_tr_b16 a[246:247], v33 offset:51200
    ds_read_b64_tr_b16 a[248:249], v34 offset:49152
    ds_read_b64_tr_b16 a[250:251], v34 offset:51200
    s_add_u32 m0, s50, 101376
    s_nop 0
    buffer_load_dwordx4 v22, s[32:35], s55 offen lds
    s_waitcnt vmcnt(10)
    ds_read_b64_tr_b16 a[252:253], v35 offset:49152
    ds_read_b64_tr_b16 a[254:255], v35 offset:51200
    s_mul_i32 s55, s13, 40
    s_add_u32 m0, s50, 114688
    s_nop 0
    buffer_load_dwordx4 v19, s[32:35], s55 offen lds
    s_waitcnt vmcnt(10)
    s_add_u32 m0, s50, 115712
    s_nop 0
    buffer_load_dwordx4 v20, s[32:35], s55 offen lds
    s_waitcnt vmcnt(10)
    ds_read_b64_tr_b16 v[220:221], v36 offset:0
    ds_read_b64_tr_b16 v[222:223], v36 offset:2048
    ds_read_b64_tr_b16 v[224:225], v37 offset:0
    s_add_u32 m0, s50, 116736
    s_nop 0
    buffer_load_dwordx4 v21, s[32:35], s55 offen lds
    s_waitcnt vmcnt(10)
    ds_read_b64_tr_b16 v[226:227], v37 offset:2048
    ds_read_b64_tr_b16 v[228:229], v38 offset:0
    ds_read_b64_tr_b16 v[230:231], v38 offset:2048
    s_add_u32 m0, s50, 117760
    s_nop 0
    buffer_load_dwordx4 v22, s[32:35], s55 offen lds
    s_waitcnt vmcnt(10)
    ds_read_b64_tr_b16 v[232:233], v39 offset:0
    ds_read_b64_tr_b16 v[234:235], v39 offset:2048
    s_mul_i32 s55, s14, 40
    s_add_u32 m0, s50, 131072
    s_nop 0
    buffer_load_dwordx4 v19, s[32:35], s55 offen lds
    s_waitcnt vmcnt(10)
    s_add_u32 m0, s50, 132096
    s_nop 0
    buffer_load_dwordx4 v20, s[32:35], s55 offen lds
    s_waitcnt vmcnt(10)
    ds_read_b64_tr_b16 v[236:237], v36 offset:16384
    ds_read_b64_tr_b16 v[238:239], v36 offset:18432
    ds_read_b64_tr_b16 v[240:241], v37 offset:16384
    s_add_u32 m0, s50, 133120
    s_nop 0
    buffer_load_dwordx4 v21, s[32:35], s55 offen lds
    s_waitcnt vmcnt(10)
    ds_read_b64_tr_b16 v[242:243], v37 offset:18432
    ds_read_b64_tr_b16 v[244:245], v38 offset:16384
    ds_read_b64_tr_b16 v[246:247], v38 offset:18432
    s_add_u32 m0, s50, 134144
    s_nop 0
    buffer_load_dwordx4 v22, s[32:35], s55 offen lds
    s_waitcnt vmcnt(10)
    ds_read_b64_tr_b16 v[248:249], v39 offset:16384
    ds_read_b64_tr_b16 v[250:251], v39 offset:18432
    s_mul_i32 s55, s15, 40
    s_add_u32 m0, s50, 147456
    s_nop 0
    buffer_load_dwordx4 v19, s[32:35], s55 offen lds
    s_waitcnt vmcnt(10)
    s_add_u32 m0, s50, 148480
    s_nop 0
    buffer_load_dwordx4 v20, s[32:35], s55 offen lds
    s_waitcnt vmcnt(10)
    ds_read_b64_tr_b16 a[144:145], v36 offset:32768
    ds_read_b64_tr_b16 a[146:147], v36 offset:34816
    ds_read_b64_tr_b16 a[148:149], v37 offset:32768
    s_add_u32 m0, s50, 149504
    s_nop 0
    buffer_load_dwordx4 v21, s[32:35], s55 offen lds
    s_waitcnt vmcnt(10)
    ds_read_b64_tr_b16 a[150:151], v37 offset:34816
    ds_read_b64_tr_b16 a[152:153], v38 offset:32768
    ds_read_b64_tr_b16 a[154:155], v38 offset:34816
    s_mov_b64 s[58:59], 0
    s_mov_b64 exec, 0xffff
    buffer_load_dwordx4 v[4:7], v47, s[40:43], 0 offen sc1
    s_mov_b64 exec, -1
    s_add_u32 m0, s50, 150528
    s_nop 0
    buffer_load_dwordx4 v22, s[32:35], s55 offen lds
    s_waitcnt vmcnt(10)
    ds_read_b64_tr_b16 a[156:157], v39 offset:32768
    ds_read_b64_tr_b16 a[158:159], v39 offset:34816
    s_waitcnt lgkmcnt(15)
    s_mul_i32 s55, s16, 40
    s_add_u32 m0, s50, 0
    s_nop 0
    buffer_load_dwordx4 v19, s[32:35], s55 offen lds
    s_waitcnt vmcnt(10)
    ds_read_b64_tr_b16 v[204:205], v36 offset:49152
    ds_read_b64_tr_b16 v[206:207], v36 offset:51200
    ds_read_b64_tr_b16 v[208:209], v37 offset:49152
    s_add_u32 m0, s50, 1024
    s_nop 0
    buffer_load_dwordx4 v20, s[32:35], s55 offen lds
    s_waitcnt vmcnt(10)
    ds_read_b64_tr_b16 v[210:211], v37 offset:51200
    ds_read_b64_tr_b16 v[212:213], v38 offset:49152
    ds_read_b64_tr_b16 v[214:215], v38 offset:51200
    s_add_u32 m0, s50, 2048
    s_nop 0
    buffer_load_dwordx4 v21, s[32:35], s55 offen lds
    s_waitcnt vmcnt(10)
    ds_read_b64_tr_b16 v[216:217], v39 offset:49152
    ds_read_b64_tr_b16 v[218:219], v39 offset:51200
    s_add_u32 m0, s50, 3072
    s_nop 0
    buffer_load_dwordx4 v22, s[32:35], s55 offen lds
    s_waitcnt vmcnt(10)
    s_mul_i32 s55, s17, 40
    s_add_u32 m0, s50, 16384
    s_nop 0
    buffer_load_dwordx4 v19, s[32:35], s55 offen lds
    s_waitcnt vmcnt(10)
    ds_read_b64_tr_b16 v[188:189], v40 offset:0
    ds_read_b64_tr_b16 v[190:191], v40 offset:2048
    ds_read_b64_tr_b16 v[192:193], v41 offset:0
    s_add_u32 m0, s50, 17408
    s_nop 0
    buffer_load_dwordx4 v20, s[32:35], s55 offen lds
    s_waitcnt vmcnt(10)
    ds_read_b64_tr_b16 v[194:195], v41 offset:2048
    ds_read_b64_tr_b16 v[196:197], v42 offset:0
    ds_read_b64_tr_b16 v[198:199], v42 offset:2048
    s_add_u32 m0, s50, 18432
    s_nop 0
    buffer_load_dwordx4 v21, s[32:35], s55 offen lds
    s_waitcnt vmcnt(10)
    ds_read_b64_tr_b16 v[200:201], v43 offset:0
    ds_read_b64_tr_b16 v[202:203], v43 offset:2048
    s_add_u32 m0, s50, 19456
    s_nop 0
    buffer_load_dwordx4 v22, s[32:35], s55 offen lds
    s_waitcnt vmcnt(10)
    s_waitcnt vmcnt(9)
    v_min_u32 v4, v4, v5
    v_min3_u32 v4, v4, v6, v7
    v_cmp_gt_u32 vcc, v4, v48
    s_nop 0
    s_or_b64 s[58:59], s[58:59], vcc
    s_and_b32 s52, s58, 0xffff
    s_cmp_eq_u32 s52, 0xffff
    s_cbranch_scc0 L_nu_c0_0s
L_nu_c0_0:
    s_mul_i32 s56, s72, 55296
    v_add_u32 v46, s56, v45
    buffer_load_dwordx4 a[104:107], v46, s[40:43], s4 offen sc1
    buffer_load_dwordx4 a[108:111], v46, s[40:43], s5 offen sc1
    buffer_load_dwordx4 a[112:115], v46, s[40:43], s6 offen sc1
    buffer_load_dwordx4 a[116:119], v46, s[40:43], s7 offen sc1
    buffer_load_dwordx4 a[120:123], v46, s[40:43], s8 offen sc1
    buffer_load_dwordx4 a[124:127], v46, s[40:43], s9 offen sc1
    buffer_load_dwordx4 a[128:131], v46, s[40:43], s10 offen sc1
    buffer_load_dwordx4 a[132:135], v46, s[40:43], s11 offen sc1
    buffer_load_dwordx4 a[136:139], v46, s[40:43], s12 offen sc1
    buffer_load_dwordx4 a[140:143], v46, s[40:43], s13 offen sc1
    buffer_load_dwordx4 v[52:55], v46, s[40:43], s14 offen sc1
    buffer_load_dwordx4 v[56:59], v46, s[40:43], s15 offen sc1
    s_branch L_pg2
    .p2align 12
L_pg2:
    s_waitcnt vmcnt(9)
    v_mfma_f32_16x16x32_bf16 v[108:111], a[160:163], a[104:107], 0
    buffer_load_dwordx4 v[60:63], v46, s[40:43], s16 offen sc1
    v_mfma_f32_16x16x32_bf16 v[108:111], a[176:179], a[108:111], v[108:111]
    ds_read_b64_tr_b16 v[172:173], v40 offset:16384
    ds_read_b64_tr_b16 v[174:175], v40 offset:18432
    v_mfma_f32_16x16x32_bf16 v[108:111], a[192:195], a[112:115], v[108:111]
    ds_read_b64_tr_b16 v[176:177], v41 offset:16384
    ds_read_b64_tr_b16 v[178:179], v41 offset:18432
    v_mfma_f32_16x16x32_bf16 a[0:3], a[196:199], a[112:115], 0
    buffer_load_dwordx4 v[64:67], v46, s[40:43], s17 offen sc1
    v_mfma_f32_16x16x32_bf16 a[0:3], a[180:183], a[108:111], a[0:3]
    ds_read_b64_tr_b16 v[180:181], v42 offset:16384
    ds_read_b64_tr_b16 v[182:183], v42 offset:18432
    v_mfma_f32_16x16x32_bf16 a[0:3], a[164:167], a[104:107], a[0:3]
    ds_read_b64_tr_b16 v[184:185], v43 offset:16384
    ds_read_b64_tr_b16 v[186:187], v43 offset:18432
    v_mfma_f32_16x16x32_bf16 a[4:7], a[168:171], a[104:107], 0
    s_mul_i32 s56, s73, 55296
    v_add_u32 v46, s56, v45
    v_mfma_f32_16x16x32_bf16 a[4:7], a[184:187], a[108:111], a[4:7]
    ds_read_b64_tr_b16 v[156:157], v32 offset:0
    ds_read_b64_tr_b16 v[158:159], v32 offset:2048
    v_mfma_f32_16x16x32_bf16 a[4:7], a[200:203], a[112:115], a[4:7]
    ds_read_b64_tr_b16 v[160:161], v33 offset:0
    ds_read_b64_tr_b16 v[162:163], v33 offset:2048
    v_mfma_f32_16x16x32_bf16 a[8:11], a[204:207], a[112:115], 0
    buffer_load_dwordx4 v[68:71], v46, s[40:43], s4 offen sc1
    v_mfma_f32_16x16x32_bf16 a[8:11], a[188:191], a[108:111], a[8:11]
    ds_read_b64_tr_b16 v[164:165], v34 offset:0
    ds_read_b64_tr_b16 v[166:167], v34 offset:2048
    v_mfma_f32_16x16x32_bf16 a[8:11], a[172:175], a[104:107], a[8:11]
    ds_read_b64_tr_b16 v[168:169], v35 offset:0
    ds_read_b64_tr_b16 v[170:171], v35 offset:2048
    buffer_load_dwordx4 v[72:75], v46, s[40:43], s5 offen sc1
    s_waitcnt vmcnt(9)
    v_mfma_f32_16x16x32_bf16 v[108:111], a[208:211], a[116:119], v[108:111]
    buffer_load_dwordx4 v[76:79], v46, s[40:43], s6 offen sc1
    v_mfma_f32_16x16x32_bf16 v[108:111], a[224:227], a[120:123], v[108:111]
    ds_read_b64_tr_b16 v[140:141], v32 offset:16384
    ds_read_b64_tr_b16 v[142:143], v32 offset:18432
    v_mfma_f32_16x16x32_bf16 v[108:111], a[240:243], a[124:127], v[108:111]
    ds_read_b64_tr_b16 v[144:145], v33 offset:16384
    ds_read_b64_tr_b16 v[146:147], v33 offset:18432
    v_mfma_f32_16x16x32_bf16 v[108:111], v[220:223], a[128:131], v[108:111]
    buffer_load_dwordx4 v[80:83], v46, s[40:43], s7 offen sc1
    v_mfma_f32_16x16x32_bf16 a[0:3], v[224:227], a[128:131], a[0:3]
    ds_read_b64_tr_b16 v[148:149], v34 offset:16384
    ds_read_b64_tr_b16 v[150:151], v34 offset:18432
    v_mfma_f32_16x16x32_bf16 a[0:3], a[244:247], a[124:127], a[0:3]
    ds_read_b64_tr_b16 v[152:153], v35 offset:16384
    ds_read_b64_tr_b16 v[154:155], v35 offset:18432
    v_mfma_f32_16x16x32_bf16 a[0:3], a[228:231], a[120:123], a[0:3]
    buffer_load_dwordx4 v[84:87], v46, s[40:43], s8 offen sc1
    v_mfma_f32_16x16x32_bf16 a[0:3], a[212:215], a[116:119], a[0:3]
    v_mfma_f32_16x16x32_bf16 a[4:7], a[216:219], a[116:119], a[4:7]
    v_mfma_f32_16x16x32_bf16 a[4:7], a[232:235], a[120:123], a[4:7]
    v_mfma_f32_16x16x32_bf16 a[4:7], a[248:251], a[124:127], a[4:7]
    v_mfma_f32_16x16x32_bf16 a[4:7], v[228:231], a[128:131], a[4:7]
    v_mfma_f32_16x16x32_bf16 a[8:11], v[232:235], a[128:131], a[8:11]
    v_mfma_f32_16x16x32_bf16 a[8:11], a[252:255], a[124:127], a[8:11]
    v_mfma_f32_16x16x32_bf16 a[8:11], a[236:239], a[120:123], a[8:11]
    v_mfma_f32_16x16x32_bf16 a[8:11], a[220:223], a[116:119], a[8:11]
    s_waitcnt vmcnt(9) lgkmcnt(15)
    v_mfma_f32_16x16x32_bf16 v[108:111], v[236:239], a[132:135], v[108:111]
    buffer_load_dwordx4 v[88:91], v46, s[40:43], s9 offen sc1
    v_mfma_f32_16x16x32_bf16 v[108:111], a[144:147], a[136:139], v[108:111]
    v_mfma_f32_16x16x32_bf16 v[108:111], v[204:207], a[140:143], v[108:111]
    v_mfma_f32_16x16x32_bf16 a[0:3], v[208:211], a[140:143], a[0:3]
    buffer_load_dwordx4 v[92:95], v46, s[40:43], s10 offen sc1
    v_mfma_f32_16x16x32_bf16 a[0:3], a[148:151], a[136:139], a[0:3]
    v_mfma_f32_16x16x32_bf16 a[0:3], v[240:243], a[132:135], a[0:3]
    v_mfma_f32_16x16x32_bf16 a[4:7], v[244:247], a[132:135], a[4:7]
    buffer_load_dwordx4 v[96:99], v46, s[40:43], s11 offen sc1
    v_mfma_f32_16x16x32_bf16 a[4:7], a[152:155], a[136:139], a[4:7]
    v_mfma_f32_16x16x32_bf16 a[4:7], v[212:215], a[140:143], a[4:7]
    v_mfma_f32_16x16x32_bf16 a[8:11], v[216:219], a[140:143], a[8:11]
    buffer_load_dwordx4 v[100:103], v46, s[40:43], s12 offen sc1
    v_mfma_f32_16x16x32_bf16 a[8:11], a[156:159], a[136:139], a[8:11]
    v_mfma_f32_16x16x32_bf16 a[8:11], v[248:251], a[132:135], a[8:11]
    s_waitcnt vmcnt(9) lgkmcnt(0)
    v_mfma_f32_16x16x32_bf16 v[108:111], v[188:191], v[52:55], v[108:111]
    buffer_load_dwordx4 v[104:107], v46, s[40:43], s13 offen sc1
    v_mfma_f32_16x16x32_bf16 v[108:111], v[172:175], v[56:59], v[108:111]
    v_mfma_f32_16x16x32_bf16 v[108:111], v[156:159], v[60:63], v[108:111]
    v_mfma_f32_16x16x32_bf16 v[108:111], v[140:143], v[64:67], v[108:111]
    buffer_load_dwordx4 a[72:75], v46, s[40:43], s14 offen sc1
    v_mfma_f32_16x16x32_bf16 a[0:3], v[144:147], v[64:67], a[0:3]
    v_mfma_f32_16x16x32_bf16 a[0:3], v[160:163], v[60:63], a[0:3]
    v_mfma_f32_16x16x32_bf16 a[0:3], v[176:179], v[56:59], a[0:3]
    buffer_load_dwordx4 a[76:79], v46, s[40:43], s15 offen sc1
    v_mfma_f32_16x16x32_bf16 a[0:3], v[192:195], v[52:55], a[0:3]
    v_mfma_f32_16x16x32_bf16 a[4:7], v[196:199], v[52:55], a[4:7]
    v_mfma_f32_16x16x32_bf16 a[4:7], v[180:183], v[56:59], a[4:7]
    v_mfma_f32_16x16x32_bf16 a[4:7], v[164:167], v[60:63], a[4:7]
    v_mfma_f32_16x16x32_bf16 a[4:7], v[148:151], v[64:67], a[4:7]
    v_mfma_f32_16x16x32_bf16 a[8:11], v[152:155], v[64:67], a[8:11]
    v_mfma_f32_16x16x32_bf16 a[8:11], v[168:171], v[60:63], a[8:11]
    v_mfma_f32_16x16x32_bf16 a[8:11], v[184:187], v[56:59], a[8:11]
    v_mfma_f32_16x16x32_bf16 a[8:11], v[200:203], v[52:55], a[8:11]
    s_barrier
    v_xor_b32 v32, 0, v50
    v_xor_b32 v33, 64, v50
    v_xor_b32 v34, 128, v50
    v_xor_b32 v35, 192, v50
    v_add_u32 v36, 65536, v32
    v_add_u32 v37, 65536, v33
    v_add_u32 v38, 65536, v34
    v_add_u32 v39, 65536, v35
    v_xor_b32 v40, 16, v253
    v_add_u32 v41, 65536, v253
    v_add_u32 v42, 65536, v40
    s_waitcnt vmcnt(9)
    v_mfma_f32_16x16x32_bf16 v[112:115], a[160:163], v[68:71], 0
    buffer_load_dwordx4 a[80:83], v46, s[40:43], s16 offen sc1
    v_mfma_f32_16x16x32_bf16 v[112:115], a[176:179], v[72:75], v[112:115]
    s_mov_b32 s80, s78
    s_mul_i32 s55, s73, 20480
    v_mfma_f32_16x16x32_bf16 v[112:115], a[192:195], v[76:79], v[112:115]
    s_cmp_lt_u32 s48, 2
    s_cselect_b32 s80, s80, s55
    s_mul_i32 s81, s74, 20480
    v_mfma_f32_16x16x32_bf16 a[12:15], a[196:199], v[76:79], 0
    ds_write_b128 v32, v[108:111] offset:0
    v_mfma_f32_16x16x32_bf16 a[12:15], a[180:183], v[72:75], a[12:15]
    s_mul_i32 s55, s75, 20480
    s_cmp_lt_u32 s48, 2
    s_cselect_b32 s81, s81, s55
    v_mfma_f32_16x16x32_bf16 a[12:15], a[164:167], v[68:71], a[12:15]
    ds_write_b128 v33, a[0:3] offset:0
    v_mfma_f32_16x16x32_bf16 a[16:19], a[168:171], v[68:71], 0
    buffer_load_dwordx4 a[84:87], v46, s[40:43], s17 offen sc1
    v_mfma_f32_16x16x32_bf16 a[16:19], a[184:187], v[72:75], a[16:19]
    ds_write_b128 v34, a[4:7] offset:0
    v_mfma_f32_16x16x32_bf16 a[16:19], a[200:203], v[76:79], a[16:19]
    s_mul_i32 s82, s76, 20480
    s_mov_b32 s55, 0x40000000
    v_mfma_f32_16x16x32_bf16 a[20:23], a[204:207], v[76:79], 0
    ds_write_b128 v35, a[8:11] offset:0
    v_mfma_f32_16x16x32_bf16 a[20:23], a[188:191], v[72:75], a[20:23]
    s_cmp_lt_u32 s48, 2
    s_cselect_b32 s82, s82, s55
    v_mfma_f32_16x16x32_bf16 a[20:23], a[172:175], v[68:71], a[20:23]
    s_mul_i32 s56, s74, 55296
    v_add_u32 v46, s56, v45
    buffer_load_dwordx4 a[88:91], v46, s[40:43], s4 offen sc1
    buffer_load_dwordx4 a[92:95], v46, s[40:43], s5 offen sc1
    s_waitcnt vmcnt(9)
    v_mfma_f32_16x16x32_bf16 v[112:115], a[208:211], v[80:83], v[112:115]
    buffer_load_dwordx4 a[96:99], v46, s[40:43], s6 offen sc1
    v_mfma_f32_16x16x32_bf16 v[112:115], a[224:227], v[84:87], v[112:115]
    v_mfma_f32_16x16x32_bf16 v[112:115], a[240:243], v[88:91], v[112:115]
    v_mfma_f32_16x16x32_bf16 v[112:115], v[220:223], v[92:95], v[112:115]
    buffer_load_dwordx4 a[100:103], v46, s[40:43], s7 offen sc1
    v_mfma_f32_16x16x32_bf16 a[12:15], v[224:227], v[92:95], a[12:15]
    v_mfma_f32_16x16x32_bf16 a[12:15], a[244:247], v[88:91], a[12:15]
    v_mfma_f32_16x16x32_bf16 a[12:15], a[228:231], v[84:87], a[12:15]
    buffer_load_dwordx4 a[104:107], v46, s[40:43], s8 offen sc1
    v_mfma_f32_16x16x32_bf16 a[12:15], a[212:215], v[80:83], a[12:15]
    v_mfma_f32_16x16x32_bf16 a[16:19], a[216:219], v[80:83], a[16:19]
    v_mfma_f32_16x16x32_bf16 a[16:19], a[232:235], v[84:87], a[16:19]
    v_mfma_f32_16x16x32_bf16 a[16:19], a[248:251], v[88:91], a[16:19]
    v_mfma_f32_16x16x32_bf16 a[16:19], v[228:231], v[92:95], a[16:19]
    v_mfma_f32_16x16x32_bf16 a[20:23], v[232:235], v[92:95], a[20:23]
    v_mfma_f32_16x16x32_bf16 a[20:23], a[252:255], v[88:91], a[20:23]
    v_mfma_f32_16x16x32_bf16 a[20:23], a[236:239], v[84:87], a[20:23]
    v_mfma_f32_16x16x32_bf16 a[20:23], a[220:223], v[80:83], a[20:23]
    s_waitcnt vmcnt(9)
    v_mfma_f32_16x16x32_bf16 v[112:115], v[236:239], v[96:99], v[112:115]
    buffer_load_dwordx4 a[108:111], v46, s[40:43], s9 offen sc1
    v_mfma_f32_16x16x32_bf16 v[112:115], a[144:147], v[100:103], v[112:115]
    v_mfma_f32_16x16x32_bf16 v[112:115], v[204:207], v[104:107], v[112:115]
    v_mfma_f32_16x16x32_bf16 a[12:15], v[208:211], v[104:107], a[12:15]
    buffer_load_dwordx4 a[112:115], v46, s[40:43], s10 offen sc1
    v_mfma_f32_16x16x32_bf16 a[12:15], a[148:151], v[100:103], a[12:15]
    v_mfma_f32_16x16x32_bf16 a[12:15], v[240:243], v[96:99], a[12:15]
    v_mfma_f32_16x16x32_bf16 a[16:19], v[244:247], v[96:99], a[16:19]
    buffer_load_dwordx4 a[116:119], v46, s[40:43], s11 offen sc1
    v_mfma_f32_16x16x32_bf16 a[16:19], a[152:155], v[100:103], a[16:19]
    v_mfma_f32_16x16x32_bf16 a[16:19], v[212:215], v[104:107], a[16:19]
    v_mfma_f32_16x16x32_bf16 a[20:23], v[216:219], v[104:107], a[20:23]
    buffer_load_dwordx4 a[120:123], v46, s[40:43], s12 offen sc1
    v_mfma_f32_16x16x32_bf16 a[20:23], a[156:159], v[100:103], a[20:23]
    v_mfma_f32_16x16x32_bf16 a[20:23], v[248:251], v[96:99], a[20:23]
    s_waitcnt vmcnt(9)
    v_mfma_f32_16x16x32_bf16 v[112:115], v[188:191], a[72:75], v[112:115]
    buffer_load_dwordx4 a[124:127], v46, s[40:43], s13 offen sc1
    v_mfma_f32_16x16x32_bf16 v[112:115], v[172:175], a[76:79], v[112:115]
    v_mfma_f32_16x16x32_bf16 v[112:115], v[156:159], a[80:83], v[112:115]
    v_mfma_f32_16x16x32_bf16 v[112:115], v[140:143], a[84:87], v[112:115]
    buffer_load_dwordx4 a[128:131], v46, s[40:43], s14 offen sc1
    v_mfma_f32_16x16x32_bf16 a[12:15], v[144:147], a[84:87], a[12:15]
    v_mfma_f32_16x16x32_bf16 a[12:15], v[160:163], a[80:83], a[12:15]
    v_mfma_f32_16x16x32_bf16 a[12:15], v[176:179], a[76:79], a[12:15]
    buffer_load_dwordx4 a[132:135], v46, s[40:43], s15 offen sc1
    v_mfma_f32_16x16x32_bf16 a[12:15], v[192:195], a[72:75], a[12:15]
    v_mfma_f32_16x16x32_bf16 a[16:19], v[196:199], a[72:75], a[16:19]
    v_mfma_f32_16x16x32_bf16 a[16:19], v[180:183], a[76:79], a[16:19]
    v_mfma_f32_16x16x32_bf16 a[16:19], v[164:167], a[80:83], a[16:19]
    v_mfma_f32_16x16x32_bf16 a[16:19], v[148:151], a[84:87], a[16:19]
    v_mfma_f32_16x16x32_bf16 a[20:23], v[152:155], a[84:87], a[20:23]
    v_mfma_f32_16x16x32_bf16 a[20:23], v[168:171], a[80:83], a[20:23]
    v_mfma_f32_16x16x32_bf16 a[20:23], v[184:187], a[76:79], a[20:23]
    v_mfma_f32_16x16x32_bf16 a[20:23], v[200:203], a[72:75], a[20:23]
    s_waitcnt vmcnt(9)
    v_mfma_f32_16x16x32_bf16 v[116:119], a[160:163], a[88:91], 0
    buffer_load_dwordx4 a[136:139], v46, s[40:43], s16 offen sc1
    v_mfma_f32_16x16x32_bf16 v[116:119], a[176:179], a[92:95], v[116:119]
    v_mfma_f32_16x16x32_bf16 v[116:119], a[192:195], a[96:99], v[116:119]
    v_mfma_f32_16x16x32_bf16 a[24:27], a[196:199], a[96:99], 0
    ds_write_b128 v32, v[112:115] offset:16384
    v_mfma_f32_16x16x32_bf16 a[24:27], a[180:183], a[92:95], a[24:27]
    v_mfma_f32_16x16x32_bf16 a[24:27], a[164:167], a[88:91], a[24:27]
    ds_write_b128 v33, a[12:15] offset:16384
    v_mfma_f32_16x16x32_bf16 a[28:31], a[168:171], a[88:91], 0
    buffer_load_dwordx4 a[140:143], v46, s[40:43], s17 offen sc1
    v_mfma_f32_16x16x32_bf16 a[28:31], a[184:187], a[92:95], a[28:31]
    ds_write_b128 v34, a[16:19] offset:16384
    v_mfma_f32_16x16x32_bf16 a[28:31], a[200:203], a[96:99], a[28:31]
    v_mfma_f32_16x16x32_bf16 a[32:35], a[204:207], a[96:99], 0
    ds_write_b128 v35, a[20:23] offset:16384
    v_mfma_f32_16x16x32_bf16 a[32:35], a[188:191], a[92:95], a[32:35]
    v_mfma_f32_16x16x32_bf16 a[32:35], a[172:175], a[88:91], a[32:35]
    s_mul_i32 s56, s75, 55296
    v_add_u32 v46, s56, v45
    buffer_load_dwordx4 v[52:55], v46, s[40:43], s4 offen sc1
    buffer_load_dwordx4 v[56:59], v46, s[40:43], s5 offen sc1
    s_waitcnt vmcnt(9)
    v_mfma_f32_16x16x32_bf16 v[116:119], a[208:211], a[100:103], v[116:119]
    buffer_load_dwordx4 v[60:63], v46, s[40:43], s6 offen sc1
    v_mfma_f32_16x16x32_bf16 v[116:119], a[224:227], a[104:107], v[116:119]
    v_mfma_f32_16x16x32_bf16 v[116:119], a[240:243], a[108:111], v[116:119]
    v_mfma_f32_16x16x32_bf16 v[116:119], v[220:223], a[112:115], v[116:119]
    buffer_load_dwordx4 v[64:67], v46, s[40:43], s7 offen sc1
    v_mfma_f32_16x16x32_bf16 a[24:27], v[224:227], a[112:115], a[24:27]
    v_mfma_f32_16x16x32_bf16 a[24:27], a[244:247], a[108:111], a[24:27]
    v_mfma_f32_16x16x32_bf16 a[24:27], a[228:231], a[104:107], a[24:27]
    buffer_load_dwordx4 v[68:71], v46, s[40:43], s8 offen sc1
    v_mfma_f32_16x16x32_bf16 a[24:27], a[212:215], a[100:103], a[24:27]
    v_mfma_f32_16x16x32_bf16 a[28:31], a[216:219], a[100:103], a[28:31]
    v_mfma_f32_16x16x32_bf16 a[28:31], a[232:235], a[104:107], a[28:31]
    v_mfma_f32_16x16x32_bf16 a[28:31], a[248:251], a[108:111], a[28:31]
    v_mfma_f32_16x16x32_bf16 a[28:31], v[228:231], a[112:115], a[28:31]
    v_mfma_f32_16x16x32_bf16 a[32:35], v[232:235], a[112:115], a[32:35]
    v_mfma_f32_16x16x32_bf16 a[32:35], a[252:255], a[108:111], a[32:35]
    v_mfma_f32_16x16x32_bf16 a[32:35], a[236:239], a[104:107], a[32:35]
    v_mfma_f32_16x16x32_bf16 a[32:35], a[220:223], a[100:103], a[32:35]
    s_waitcnt vmcnt(9)
    v_mfma_f32_16x16x32_bf16 v[116:119], v[236:239], a[116:119], v[116:119]
    buffer_load_dwordx4 v[72:75], v46, s[40:43], s9 offen sc1
    v_mfma_f32_16x16x32_bf16 v[116:119], a[144:147], a[120:123], v[116:119]
    v_mfma_f32_16x16x32_bf16 v[116:119], v[204:207], a[124:127], v[116:119]
    v_mfma_f32_16x16x32_bf16 a[24:27], v[208:211], a[124:127], a[24:27]
    buffer_load_dwordx4 v[76:79], v46, s[40:43], s10 offen sc1
    v_mfma_f32_16x16x32_bf16 a[24:27], a[148:151], a[120:123], a[24:27]
    v_mfma_f32_16x16x32_bf16 a[24:27], v[240:243], a[116:119], a[24:27]
    v_mfma_f32_16x16x32_bf16 a[28:31], v[244:247], a[116:119], a[28:31]
    buffer_load_dwordx4 v[80:83], v46, s[40:43], s11 offen sc1
    v_mfma_f32_16x16x32_bf16 a[28:31], a[152:155], a[120:123], a[28:31]
    v_mfma_f32_16x16x32_bf16 a[28:31], v[212:215], a[124:127], a[28:31]
    v_mfma_f32_16x16x32_bf16 a[32:35], v[216:219], a[124:127], a[32:35]
    buffer_load_dwordx4 v[84:87], v46, s[40:43], s12 offen sc1
    v_mfma_f32_16x16x32_bf16 a[32:35], a[156:159], a[120:123], a[32:35]
    v_mfma_f32_16x16x32_bf16 a[32:35], v[248:251], a[116:119], a[32:35]
    s_waitcnt vmcnt(9)
    v_mfma_f32_16x16x32_bf16 v[116:119], v[188:191], a[128:131], v[116:119]
    buffer_load_dwordx4 v[88:91], v46, s[40:43], s13 offen sc1
    v_mfma_f32_16x16x32_bf16 v[116:119], v[172:175], a[132:135], v[116:119]
    v_mfma_f32_16x16x32_bf16 v[116:119], v[156:159], a[136:139], v[116:119]
    v_mfma_f32_16x16x32_bf16 v[116:119], v[140:143], a[140:143], v[116:119]
    buffer_load_dwordx4 v[92:95], v46, s[40:43], s14 offen sc1
    v_mfma_f32_16x16x32_bf16 a[24:27], v[144:147], a[140:143], a[24:27]
    v_mfma_f32_16x16x32_bf16 a[24:27], v[160:163], a[136:139], a[24:27]
    v_mfma_f32_16x16x32_bf16 a[24:27], v[176:179], a[132:135], a[24:27]
    buffer_load_dwordx4 v[96:99], v46, s[40:43], s15 offen sc1
    v_mfma_f32_16x16x32_bf16 a[24:27], v[192:195], a[128:131], a[24:27]
    v_mfma_f32_16x16x32_bf16 a[28:31], v[196:199], a[128:131], a[28:31]
    v_mfma_f32_16x16x32_bf16 a[28:31], v[180:183], a[132:135], a[28:31]
    v_mfma_f32_16x16x32_bf16 a[28:31], v[164:167], a[136:139], a[28:31]
    v_mfma_f32_16x16x32_bf16 a[28:31], v[148:151], a[140:143], a[28:31]
    v_mfma_f32_16x16x32_bf16 a[32:35], v[152:155], a[140:143], a[32:35]
    v_mfma_f32_16x16x32_bf16 a[32:35], v[168:171], a[136:139], a[32:35]
    v_mfma_f32_16x16x32_bf16 a[32:35], v[184:187], a[132:135], a[32:35]
    v_mfma_f32_16x16x32_bf16 a[32:35], v[200:203], a[128:131], a[32:35]
    s_waitcnt vmcnt(9)
    v_mfma_f32_16x16x32_bf16 v[120:123], a[160:163], v[52:55], 0
    buffer_load_dwordx4 v[100:103], v46, s[40:43], s16 offen sc1
    v_mfma_f32_16x16x32_bf16 v[120:123], a[176:179], v[56:59], v[120:123]
    v_mfma_f32_16x16x32_bf16 v[120:123], a[192:195], v[60:63], v[120:123]
    v_mfma_f32_16x16x32_bf16 a[36:39], a[196:199], v[60:63], 0
    ds_write_b128 v32, v[116:119] offset:32768
    v_mfma_f32_16x16x32_bf16 a[36:39], a[180:183], v[56:59], a[36:39]
    v_mfma_f32_16x16x32_bf16 a[36:39], a[164:167], v[52:55], a[36:39]
    ds_write_b128 v33, a[24:27] offset:32768
    v_mfma_f32_16x16x32_bf16 a[40:43], a[168:171], v[52:55], 0
    buffer_load_dwordx4 v[104:107], v46, s[40:43], s17 offen sc1
    v_mfma_f32_16x16x32_bf16 a[40:43], a[184:187], v[56:59], a[40:43]
    ds_write_b128 v34, a[28:31] offset:32768
    v_mfma_f32_16x16x32_bf16 a[40:43], a[200:203], v[60:63], a[40:43]
    v_mfma_f32_16x16x32_bf16 a[44:47], a[204:207], v[60:63], 0
    ds_write_b128 v35, a[32:35] offset:32768
    v_mfma_f32_16x16x32_bf16 a[44:47], a[188:191], v[56:59], a[44:47]
    v_mfma_f32_16x16x32_bf16 a[44:47], a[172:175], v[52:55], a[44:47]
    s_mul_i32 s56, s76, 55296
    v_add_u32 v46, s56, v45
    buffer_load_dwordx4 a[72:75], v46, s[40:43], s4 offen sc1
    buffer_load_dwordx4 a[76:79], v46, s[40:43], s5 offen sc1
    s_waitcnt vmcnt(9)
    v_mfma_f32_16x16x32_bf16 v[120:123], a[208:211], v[64:67], v[120:123]
    buffer_load_dwordx4 a[80:83], v46, s[40:43], s6 offen sc1
    v_mfma_f32_16x16x32_bf16 v[120:123], a[224:227], v[68:71], v[120:123]
    v_mfma_f32_16x16x32_bf16 v[120:123], a[240:243], v[72:75], v[120:123]
    v_mfma_f32_16x16x32_bf16 v[120:123], v[220:223], v[76:79], v[120:123]
    buffer_load_dwordx4 a[84:87], v46, s[40:43], s7 offen sc1
    v_mfma_f32_16x16x32_bf16 a[36:39], v[224:227], v[76:79], a[36:39]
    v_mfma_f32_16x16x32_bf16 a[36:39], a[244:247], v[72:75], a[36:39]
    v_mfma_f32_16x16x32_bf16 a[36:39], a[228:231], v[68:71], a[36:39]
    buffer_load_dwordx4 a[88:91], v46, s[40:43], s8 offen sc1
    v_mfma_f32_16x16x32_bf16 a[36:39], a[212:215], v[64:67], a[36:39]
    v_mfma_f32_16x16x32_bf16 a[40:43], a[216:219], v[64:67], a[40:43]
    v_mfma_f32_16x16x32_bf16 a[40:43], a[232:235], v[68:71], a[40:43]
    v_mfma_f32_16x16x32_bf16 a[40:43], a[248:251], v[72:75], a[40:43]
    v_mfma_f32_16x16x32_bf16 a[40:43], v[228:231], v[76:79], a[40:43]
    v_mfma_f32_16x16x32_bf16 a[44:47], v[232:235], v[76:79], a[44:47]
    v_mfma_f32_16x16x32_bf16 a[44:47], a[252:255], v[72:75], a[44:47]
    v_mfma_f32_16x16x32_bf16 a[44:47], a[236:239], v[68:71], a[44:47]
    v_mfma_f32_16x16x32_bf16 a[44:47], a[220:223], v[64:67], a[44:47]
    s_waitcnt vmcnt(9)
    v_mfma_f32_16x16x32_bf16 v[120:123], v[236:239], v[80:83], v[120:123]
    buffer_load_dwordx4 a[92:95], v46, s[40:43], s9 offen sc1
    v_mfma_f32_16x16x32_bf16 v[120:123], a[144:147], v[84:87], v[120:123]
    v_mfma_f32_16x16x32_bf16 v[120:123], v[204:207], v[88:91], v[120:123]
    v_mfma_f32_16x16x32_bf16 a[36:39], v[208:211], v[88:91], a[36:39]
    buffer_load_dwordx4 a[96:99], v46, s[40:43], s10 offen sc1
    v_mfma_f32_16x16x32_bf16 a[36:39], a[148:151], v[84:87], a[36:39]
    v_mfma_f32_16x16x32_bf16 a[36:39], v[240:243], v[80:83], a[36:39]
    v_mfma_f32_16x16x32_bf16 a[40:43], v[244:247], v[80:83], a[40:43]
    buffer_load_dwordx4 a[100:103], v46, s[40:43], s11 offen sc1
    v_mfma_f32_16x16x32_bf16 a[40:43], a[152:155], v[84:87], a[40:43]
    v_mfma_f32_16x16x32_bf16 a[40:43], v[212:215], v[88:91], a[40:43]
    v_mfma_f32_16x16x32_bf16 a[44:47], v[216:219], v[88:91], a[44:47]
    buffer_load_dwordx4 a[104:107], v46, s[40:43], s12 offen sc1
    v_mfma_f32_16x16x32_bf16 a[44:47], a[156:159], v[84:87], a[44:47]
    v_mfma_f32_16x16x32_bf16 a[44:47], v[248:251], v[80:83], a[44:47]
    s_waitcnt vmcnt(9)
    v_mfma_f32_16x16x32_bf16 v[120:123], v[188:191], v[92:95], v[120:123]
    buffer_load_dwordx4 a[108:111], v46, s[40:43], s13 offen sc1
    v_mfma_f32_16x16x32_bf16 v[120:123], v[172:175], v[96:99], v[120:123]
    v_mfma_f32_16x16x32_bf16 v[120:123], v[156:159], v[100:103], v[120:123]
    v_mfma_f32_16x16x32_bf16 v[120:123], v[140:143], v[104:107], v[120:123]
    buffer_load_dwordx4 a[112:115], v46, s[40:43], s14 offen sc1
    v_mfma_f32_16x16x32_bf16 a[36:39], v[144:147], v[104:107], a[36:39]
    v_mfma_f32_16x16x32_bf16 a[36:39], v[160:163], v[100:103], a[36:39]
    v_mfma_f32_16x16x32_bf16 a[36:39], v[176:179], v[96:99], a[36:39]
    buffer_load_dwordx4 a[116:119], v46, s[40:43], s15 offen sc1
    v_mfma_f32_16x16x32_bf16 a[36:39], v[192:195], v[92:95], a[36:39]
    v_mfma_f32_16x16x32_bf16 a[40:43], v[196:199], v[92:95], a[40:43]
    v_mfma_f32_16x16x32_bf16 a[40:43], v[180:183], v[96:99], a[40:43]
    buffer_load_dwordx4 a[120:123], v46, s[40:43], s16 offen sc1
    v_mfma_f32_16x16x32_bf16 a[40:43], v[164:167], v[100:103], a[40:43]
    v_mfma_f32_16x16x32_bf16 a[40:43], v[148:151], v[104:107], a[40:43]
    v_mfma_f32_16x16x32_bf16 a[44:47], v[152:155], v[104:107], a[44:47]
    v_mfma_f32_16x16x32_bf16 a[44:47], v[168:171], v[100:103], a[44:47]
    v_mfma_f32_16x16x32_bf16 a[44:47], v[184:187], v[96:99], a[44:47]
    v_mfma_f32_16x16x32_bf16 a[44:47], v[200:203], v[92:95], a[44:47]
    s_waitcnt vmcnt(9)
    v_mfma_f32_16x16x32_bf16 v[124:127], a[160:163], a[72:75], 0
    buffer_load_dwordx4 a[124:127], v46, s[40:43], s17 offen sc1
    v_mfma_f32_16x16x32_bf16 v[124:127], a[176:179], a[76:79], v[124:127]
    v_mfma_f32_16x16x32_bf16 v[124:127], a[192:195], a[80:83], v[124:127]
    v_mfma_f32_16x16x32_bf16 v[124:127], a[208:211], a[84:87], v[124:127]
    ds_write_b128 v32, v[120:123] offset:49152
    v_mfma_f32_16x16x32_bf16 a[48:51], a[212:215], a[84:87], 0
    v_mfma_f32_16x16x32_bf16 a[48:51], a[196:199], a[80:83], a[48:51]
    ds_write_b128 v33, a[36:39] offset:49152
    v_mfma_f32_16x16x32_bf16 a[48:51], a[180:183], a[76:79], a[48:51]
    v_mfma_f32_16x16x32_bf16 a[48:51], a[164:167], a[72:75], a[48:51]
    ds_write_b128 v34, a[40:43] offset:49152
    v_mfma_f32_16x16x32_bf16 a[52:55], a[168:171], a[72:75], 0
    v_mfma_f32_16x16x32_bf16 a[52:55], a[184:187], a[76:79], a[52:55]
    ds_write_b128 v35, a[44:47] offset:49152
    v_mfma_f32_16x16x32_bf16 a[52:55], a[200:203], a[80:83], a[52:55]
    v_mfma_f32_16x16x32_bf16 a[52:55], a[216:219], a[84:87], a[52:55]
    v_mfma_f32_16x16x32_bf16 a[56:59], a[220:223], a[84:87], 0
    v_mfma_f32_16x16x32_bf16 a[56:59], a[204:207], a[80:83], a[56:59]
    v_mfma_f32_16x16x32_bf16 a[56:59], a[188:191], a[76:79], a[56:59]
    v_mfma_f32_16x16x32_bf16 a[56:59], a[172:175], a[72:75], a[56:59]
    s_waitcnt lgkmcnt(0)
    s_barrier
    s_waitcnt vmcnt(6)
    v_mfma_f32_16x16x32_bf16 v[124:127], a[224:227], a[88:91], v[124:127]
    ds_read_b128 v[52:55], v253 offset:0
    v_mfma_f32_16x16x32_bf16 v[124:127], a[240:243], a[92:95], v[124:127]
    ds_read_b128 v[56:59], v40 offset:0
    v_mfma_f32_16x16x32_bf16 v[124:127], v[220:223], a[96:99], v[124:127]
    ds_read_b128 v[60:63], v253 offset:4096
    v_mfma_f32_16x16x32_bf16 v[124:127], v[236:239], a[100:103], v[124:127]
    ds_read_b128 v[64:67], v40 offset:4096
    v_mfma_f32_16x16x32_bf16 a[48:51], v[240:243], a[100:103], a[48:51]
    ds_read_b128 v[68:71], v253 offset:8192
    v_mfma_f32_16x16x32_bf16 a[48:51], v[224:227], a[96:99], a[48:51]
    ds_read_b128 v[72:75], v40 offset:8192
    v_mfma_f32_16x16x32_bf16 a[48:51], a[244:247], a[92:95], a[48:51]
    ds_read_b128 v[76:79], v253 offset:12288
    v_mfma_f32_16x16x32_bf16 a[48:51], a[228:231], a[88:91], a[48:51]
    ds_read_b128 v[80:83], v40 offset:12288
    v_mfma_f32_16x16x32_bf16 a[52:55], a[232:235], a[88:91], a[52:55]
    ds_read_b128 v[84:87], v253 offset:32768
    s_waitcnt lgkmcnt(5)
    v_mfma_f32_16x16x32_bf16 a[52:55], a[248:251], a[92:95], a[52:55]
    ds_read_b128 v[88:91], v40 offset:32768
    v_add_f32 v52, v52, v60
    v_mfma_f32_16x16x32_bf16 a[52:55], v[228:231], a[96:99], a[52:55]
    ds_read_b128 v[92:95], v253 offset:36864
    v_add_f32 v53, v53, v61
    v_mfma_f32_16x16x32_bf16 a[52:55], v[244:247], a[100:103], a[52:55]
    ds_read_b128 v[96:99], v40 offset:36864
    v_add_f32 v54, v54, v62
    v_mfma_f32_16x16x32_bf16 a[56:59], v[248:251], a[100:103], a[56:59]
    ds_read_b128 v[100:103], v253 offset:40960
    v_add_f32 v55, v55, v63
    v_mfma_f32_16x16x32_bf16 a[56:59], v[232:235], a[96:99], a[56:59]
    ds_read_b128 v[104:107], v40 offset:40960
    v_add_f32 v56, v56, v64
    v_mfma_f32_16x16x32_bf16 a[56:59], a[252:255], a[92:95], a[56:59]
    ds_read_b128 v[8:11], v253 offset:45056
    v_add_f32 v57, v57, v65
    v_mfma_f32_16x16x32_bf16 a[56:59], a[236:239], a[88:91], a[56:59]
    ds_read_b128 v[12:15], v40 offset:45056
    v_add_f32 v58, v58, v66
    s_waitcnt vmcnt(3)
    v_mfma_f32_16x16x32_bf16 v[124:127], a[144:147], a[104:107], v[124:127]
    v_add_f32 v59, v59, v67
    s_waitcnt lgkmcnt(8)
    v_mfma_f32_16x16x32_bf16 v[124:127], v[204:207], a[108:111], v[124:127]
    v_add_f32 v68, v68, v76
    v_add_f32 v69, v69, v77
    v_mfma_f32_16x16x32_bf16 v[124:127], v[188:191], a[112:115], v[124:127]
    v_add_f32 v70, v70, v78
    v_add_f32 v71, v71, v79
    v_mfma_f32_16x16x32_bf16 a[48:51], v[192:195], a[112:115], a[48:51]
    v_add_f32 v72, v72, v80
    v_add_f32 v73, v73, v81
    v_mfma_f32_16x16x32_bf16 a[48:51], v[208:211], a[108:111], a[48:51]
    v_add_f32 v74, v74, v82
    v_add_f32 v75, v75, v83
    v_mfma_f32_16x16x32_bf16 a[48:51], a[148:151], a[104:107], a[48:51]
    v_add_f32 v52, v52, v68
    v_mfma_f32_16x16x32_bf16 a[52:55], a[152:155], a[104:107], a[52:55]
    v_add_f32 v53, v53, v69
    v_add_f32 v54, v54, v70
    v_mfma_f32_16x16x32_bf16 a[52:55], v[212:215], a[108:111], a[52:55]
    v_add_f32 v55, v55, v71
    v_add_f32 v56, v56, v72
    v_mfma_f32_16x16x32_bf16 a[52:55], v[196:199], a[112:115], a[52:55]
    v_add_f32 v57, v57, v73
    v_add_f32 v58, v58, v74
    v_mfma_f32_16x16x32_bf16 a[56:59], v[200:203], a[112:115], a[56:59]
    v_add_f32 v59, v59, v75
    v_cvt_pk_bf16_f32 v60, v52, v53
    v_mfma_f32_16x16x32_bf16 a[56:59], v[216:219], a[108:111], a[56:59]
    v_cvt_pk_bf16_f32 v61, v54, v55
    v_cvt_pk_bf16_f32 v62, v56, v57
    v_mfma_f32_16x16x32_bf16 a[56:59], a[156:159], a[104:107], a[56:59]
    v_cvt_pk_bf16_f32 v63, v58, v59
    s_waitcnt lgkmcnt(4)
    s_waitcnt vmcnt(1)
    v_mfma_f32_16x16x32_bf16 v[124:127], v[172:175], a[116:119], v[124:127]
    v_add_f32 v84, v84, v92
    v_add_f32 v85, v85, v93
    v_mfma_f32_16x16x32_bf16 v[124:127], v[156:159], a[120:123], v[124:127]
    v_add_f32 v86, v86, v94
    v_add_f32 v87, v87, v95
    v_mfma_f32_16x16x32_bf16 a[48:51], v[160:163], a[120:123], a[48:51]
    v_add_f32 v88, v88, v96
    v_add_f32 v89, v89, v97
    v_mfma_f32_16x16x32_bf16 a[48:51], v[176:179], a[116:119], a[48:51]
    v_add_f32 v90, v90, v98
    v_add_f32 v91, v91, v99
    v_mfma_f32_16x16x32_bf16 a[52:55], v[180:183], a[116:119], a[52:55]
    s_waitcnt lgkmcnt(0)
    v_add_f32 v100, v100, v8
    v_mfma_f32_16x16x32_bf16 a[52:55], v[164:167], a[120:123], a[52:55]
    v_add_f32 v101, v101, v9
    v_add_f32 v102, v102, v10
    v_mfma_f32_16x16x32_bf16 a[56:59], v[168:171], a[120:123], a[56:59]
    v_add_f32 v103, v103, v11
    v_add_f32 v104, v104, v12
    v_mfma_f32_16x16x32_bf16 a[56:59], v[184:187], a[116:119], a[56:59]
    v_add_f32 v105, v105, v13
    v_add_f32 v106, v106, v14
    s_waitcnt vmcnt(0)
    v_mfma_f32_16x16x32_bf16 a[48:51], v[144:147], a[124:127], a[48:51]
    v_add_f32 v107, v107, v15
    v_mfma_f32_16x16x32_bf16 a[52:55], v[148:151], a[124:127], a[52:55]
    v_add_f32 v84, v84, v100
    v_add_f32 v85, v85, v101
    v_mfma_f32_16x16x32_bf16 a[56:59], v[152:155], a[124:127], a[56:59]
    v_add_f32 v86, v86, v102
    v_add_f32 v87, v87, v103
    v_mfma_f32_16x16x32_bf16 v[124:127], v[140:143], a[124:127], v[124:127]
    v_add_f32 v88, v88, v104
    v_add_f32 v89, v89, v105
    v_add_f32 v90, v90, v106
    v_add_f32 v91, v91, v107
    v_cvt_pk_bf16_f32 v92, v84, v85
    v_cvt_pk_bf16_f32 v93, v86, v87
    v_cvt_pk_bf16_f32 v94, v88, v89
    ds_write_b128 v37, a[48:51] offset:0
    ds_write_b128 v38, a[52:55] offset:0
    ds_write_b128 v39, a[56:59] offset:0
    ds_write_b128 v36, v[124:127] offset:0
    v_cvt_pk_bf16_f32 v95, v90, v91
    buffer_store_dwordx4 v[60:63], v51, s[36:39], s80 offen sc1
    buffer_store_dwordx4 v[92:95], v51, s[36:39], s81 offen sc1
    s_waitcnt lgkmcnt(0)
    s_barrier
    ds_read_b128 v[204:207], v41 offset:0
    ds_read_b128 v[208:211], v42 offset:0
    ds_read_b128 v[212:215], v41 offset:4096
    ds_read_b128 v[216:219], v42 offset:4096
    ds_read_b128 v[220:223], v41 offset:8192
    ds_read_b128 v[224:227], v42 offset:8192
    ds_read_b128 v[228:231], v41 offset:12288
    ds_read_b128 v[232:235], v42 offset:12288
    s_waitcnt lgkmcnt(4)
    v_pk_add_f32 v[204:205], v[204:205], v[212:213]
    v_pk_add_f32 v[206:207], v[206:207], v[214:215]
    v_pk_add_f32 v[208:209], v[208:209], v[216:217]
    v_pk_add_f32 v[210:211], v[210:211], v[218:219]
    s_waitcnt lgkmcnt(0)
    v_pk_add_f32 v[220:221], v[220:221], v[228:229]
    v_pk_add_f32 v[222:223], v[222:223], v[230:231]
    v_pk_add_f32 v[224:225], v[224:225], v[232:233]
    v_pk_add_f32 v[226:227], v[226:227], v[234:235]
    v_pk_add_f32 v[204:205], v[204:205], v[220:221]
    v_pk_add_f32 v[206:207], v[206:207], v[222:223]
    v_pk_add_f32 v[208:209], v[208:209], v[224:225]
    v_pk_add_f32 v[210:211], v[210:211], v[226:227]
    v_cvt_pk_bf16_f32 v212, v204, v205
    v_cvt_pk_bf16_f32 v213, v206, v207
    v_cvt_pk_bf16_f32 v214, v208, v209
    v_cvt_pk_bf16_f32 v215, v210, v211
    buffer_store_dwordx4 v[212:215], v51, s[36:39], s82 offen sc1
    s_endpgm
L_go_c0s:
    s_waitcnt lgkmcnt(0)
    s_mov_b32 s90, 0
L_go_c0w:
    s_sleep 2
    buffer_load_dword v1, v9, s[44:47], 0 offen sc1
    s_waitcnt vmcnt(0)
    v_readfirstlane_b32 s52, v1
    s_add_u32 s90, s90, 1
    s_cmp_gt_u32 s90, 0x80000
    s_cbranch_scc1 L_go_c0
    s_cmp_eq_u32 s52, 0
    s_cbranch_scc1 L_go_c0w
    s_branch L_go_c0
L_nu_c0_0s:
    s_waitcnt lgkmcnt(0)
    s_mov_b32 s90, 0
L_nu_c0_0w:
    s_mov_b64 exec, 0xffff
    buffer_load_dwordx4 v[4:7], v47, s[40:43], 0 offen sc1
    s_mov_b64 exec, -1
    s_waitcnt vmcnt(0) lgkmcnt(0)
    v_min_u32 v4, v4, v5
    v_min3_u32 v4, v4, v6, v7
    v_cmp_gt_u32 vcc, v4, v48
    s_nop 0
    s_or_b64 s[58:59], s[58:59], vcc
    s_and_b32 s52, s58, 0xffff
    s_cmp_eq_u32 s52, 0xffff
    s_cbranch_scc1 L_nu_c0_0
    s_sleep 4
    s_add_u32 s90, s90, 1
    s_cmp_gt_u32 s90, 0x80000
    s_cbranch_scc0 L_nu_c0_0w
    s_branch L_nu_c0_0
L_codeend_c0:
L_spec:
    s_load_dwordx16 s[64:79], s[100:101], s3
    s_mov_b32 s34, 2211840
    s_mov_b32 s35, 0x20000
    s_mov_b32 s38, 2621440
    s_mov_b32 s39, 0x20000
    s_mov_b32 s42, 8423168
    s_mov_b32 s43, 0x20000
    s_mov_b32 s46, 256
    s_mov_b32 s47, 0x20000
    s_mov_b32 s62, 0xbdd2d3e8
    s_mov_b32 s63, 0xc0135761
    s_mul_i32 s52, s48, 448
    v_add_u32 v100, s52, v2
    v_mul_u32_u24 v100, 1280, v100
    v_and_b32 v101, 6, v2
    v_xor_b32 v101, v101, v3
    v_lshl_add_u32 v19, v101, 4, v100
    v_add_u32 v20, 10240, v19
    v_lshrrev_b32 v100, 1, v4
    v_xor_b32 v100, v100, v5
    v_lshlrev_b32 v100, 4, v100
    v_lshl_add_u32 v23, v4, 7, v100
    s_lshr_b32 s52, s48, 1
    s_lshl_b32 s52, s52, 11
    v_add_u32 v23, s52, v23
    v_xor_b32 v24, 64, v23
    v_lshrrev_b32 v100, 1, v6
    v_and_b32 v101, 1, v5
    v_lshl_or_b32 v100, v101, 1, v100
    v_lshlrev_b32 v100, 5, v100
    v_lshl_add_u32 v100, v7, 3, v100
    v_lshl_add_u32 v101, v5, 3, v6
    v_lshl_add_u32 v29, v101, 7, v100
    s_and_b32 s52, s48, 1
    s_lshl_b32 s52, s52, 6
    v_xor_b32 v29, s52, v29
    v_lshl_add_u32 v101, v5, 2, v6
    v_lshl_add_u32 v32, v101, 7, v100
    s_lshl_b32 s52, s48, 5
    v_xor_b32 v32, s52, v32
    v_add_u32 v32, s50, v32
    v_add_u32 v25, 65536, v23
    v_add_u32 v26, 65536, v24
    v_add_u32 v30, 65536, v29
    v_add_u32 v27, 131072, v23
    v_add_u32 v28, 131072, v24
    v_add_u32 v31, 131072, v29
    v_xor_b32 v104, 32, v29
    v_xor_b32 v105, 32, v30
    v_xor_b32 v106, 32, v31
    s_waitcnt lgkmcnt(0)
    s_sub_u32 s22, 2621440, s65
    s_sub_u32 s26, 2211840, s66
    s_sub_u32 s30, 2211840, s66
    s_bitcmp1_b32 s79, 8
    s_cselect_b32 s52, 245760, 0
    s_mov_b32 s53, 40960
    s_cselect_b32 s53, -40960, s53
    s_cselect_b32 s54, 663552, 0
    s_mov_b32 s60, 110592
    s_cselect_b32 s60, -110592, s60
    v_add_u32 v10, s52, v10
    v_add_u32 v11, s53, v10
    v_add_u32 v12, s53, v11
    v_add_u32 v13, s53, v12
    v_add_u32 v14, s53, v13
    v_add_u32 v15, s53, v14
    v_add_u32 v16, s53, v15
    s_add_u32 s24, s6, s66
    s_addc_u32 s25, s7, 0
    s_add_u32 s28, s8, s66
    s_addc_u32 s29, s9, 0
    s_add_u32 s20, s4, s65
    s_addc_u32 s21, s5, 0
    s_cmp_eq_u32 s64, 2
    s_cbranch_scc1 L_cls2
L_cls1:
    s_mov_b64 s[32:33], s[10:11]
    s_mov_b64 s[36:37], s[12:13]
    s_mov_b64 s[44:45], s[14:15]
    s_mov_b64 s[40:41], s[16:17]
    s_cmp_lg_u32 s48, 0
    s_cbranch_scc1 L_norst
    s_bitcmp0_b32 s79, 9
    s_cbranch_scc1 L_norst
    v_mov_b32 v108, 0
    v_mov_b32 v109, 0
    v_mov_b32 v110, 0
    v_mov_b32 v111, 0
    s_mov_b32 s52, 8388608
    buffer_store_dwordx4 v[108:111], v49, s[40:43], s52 offen sc1
    s_mov_b32 s52, 8396800
    buffer_store_dwordx4 v[108:111], v49, s[40:43], s52 offen sc1
    s_mov_b32 s52, 8404992
    buffer_store_dwordx4 v[108:111], v49, s[40:43], s52 offen sc1
    s_mov_b32 s52, 8413184
    buffer_store_dwordx4 v[108:111], v49, s[40:43], s52 offen sc1
    s_mov_b32 s52, 8421376
    buffer_store_dwordx4 v[108:111], v49, s[40:43], s52 offen sc1
L_norst:
    s_bfe_u32 s80, s67, 0x40000
    s_lshl_b32 s80, s80, 7
    s_mul_i32 s51, s80, 1728
    s_add_u32 m0, s49, 0
    s_nop 0
    buffer_load_dwordx4 v17, s[24:27], s51 offen lds
    s_add_u32 m0, s49, 4096
    s_nop 0
    buffer_load_dwordx4 v17, s[28:31], s51 offen lds
    s_add_u32 m0, s49, 8192
    s_nop 0
    buffer_load_dwordx4 v18, s[24:27], s51 offen lds
    s_add_u32 m0, s49, 12288
    s_nop 0
    buffer_load_dwordx4 v18, s[28:31], s51 offen lds
    s_add_u32 m0, s49, 16384
    s_nop 0
    buffer_load_dwordx4 v10, s[20:23], s80 offen lds
    s_mul_i32 s51, s80, 1728
    s_add_u32 s51, s51, 128
    s_add_u32 m0, s49, 20480
    s_nop 0
    buffer_load_dwordx4 v17, s[24:27], s51 offen lds
    s_add_u32 m0, s49, 24576
    s_nop 0
    buffer_load_dwordx4 v17, s[28:31], s51 offen lds
    s_add_u32 m0, s49, 28672
    s_nop 0
    buffer_load_dwordx4 v18, s[24:27], s51 offen lds
    s_add_u32 m0, s49, 32768
    s_nop 0
    buffer_load_dwordx4 v18, s[28:31], s51 offen lds
    s_add_u32 s92, s18, L_code_c1-L_pc
    s_addc_u32 s93, s19, 0
    s_mov_b32 s94, L_codeend_c1-L_code_c1
    s_mov_b32 s95, 0x20000
    buffer_load_dword v254, v49, s[92:95], 0 offen
    s_barrier
    s_bfe_u32 s81, s67, 0x40004
    s_lshl_b32 s81, s81, 7
    s_mul_i32 s51, s81, 1728
    s_add_u32 m0, s49, 36864
    s_nop 0
    buffer_load_dwordx4 v17, s[24:27], s51 offen lds
    s_add_u32 m0, s49, 40960
    s_nop 0
    buffer_load_dwordx4 v17, s[28:31], s51 offen lds
    s_add_u32 m0, s49, 45056
    s_nop 0
    buffer_load_dwordx4 v18, s[24:27], s51 offen lds
    v_xor_b32 v33, 32, v32
    v_xor_b32 v34, 64, v32
    v_xor_b32 v35, 96, v32
    v_add_u32 v36, 65536, v32
    v_add_u32 v37, 65536, v33
    v_add_u32 v38, 65536, v34
    v_add_u32 v39, 65536, v35
    v_add_u32 v40, 131072, v32
    v_add_u32 v41, 131072, v33
    v_add_u32 v42, 131072, v34
    v_add_u32 v43, 131072, v35
    v_add_u32 v19, s70, v19
    v_add_u32 v20, s70, v20
    v_add_u32 v21, 20480, v19
    v_add_u32 v22, 20480, v20
    s_lshr_b32 s52, s48, 1
    s_mul_i32 s52, s52, 53248
    s_add_u32 s52, s52, s49
    s_add_u32 s52, s52, s68
    v_lshlrev_b32 v100, 4, v0
    v_add_u32 v44, s52, v100
    s_mul_i32 s52, s48, 14336
    v_add_u32 v45, s52, v100
    s_cmp_eq_u32 s48, 3
    s_cselect_b32 s53, 5, 6
    s_movk_i32 s56, 14336
    s_cselect_b32 s56, 12288, s56
    s_and_b32 s91, s71, 0xff
    s_lshl_b32 s91, s91, 10
    s_cmp_ge_u32 s91, s56
    s_cselect_b32 s4, 0x2000000, s91
    s_add_u32 s91, s91, 1024
    s_cmp_eq_u32 s91, 14336
    s_cselect_b32 s91, 0, s91
    s_cmp_ge_u32 s91, s56
    s_cselect_b32 s5, 0x2000000, s91
    s_add_u32 s91, s91, 1024
    s_cmp_eq_u32 s91, 14336
    s_cselect_b32 s91, 0, s91
    s_cmp_ge_u32 s91, s56
    s_cselect_b32 s6, 0x2000000, s91
    s_add_u32 s91, s91, 1024
    s_cmp_eq_u32 s91, 14336
    s_cselect_b32 s91, 0, s91
    s_cmp_ge_u32 s91, s56
    s_cselect_b32 s7, 0x2000000, s91
    s_add_u32 s91, s91, 1024
    s_cmp_eq_u32 s91, 14336
    s_cselect_b32 s91, 0, s91
    s_cmp_ge_u32 s91, s56
    s_cselect_b32 s8, 0x2000000, s91
    s_add_u32 s91, s91, 1024
    s_cmp_eq_u32 s91, 14336
    s_cselect_b32 s91, 0, s91
    s_cmp_ge_u32 s91, s56
    s_cselect_b32 s9, 0x2000000, s91
    s_add_u32 s91, s91, 1024
    s_cmp_eq_u32 s91, 14336
    s_cselect_b32 s91, 0, s91
    s_cmp_ge_u32 s91, s56
    s_cselect_b32 s10, 0x2000000, s91
    s_add_u32 s91, s91, 1024
    s_cmp_eq_u32 s91, 14336
    s_cselect_b32 s91, 0, s91
    s_cmp_ge_u32 s91, s56
    s_cselect_b32 s11, 0x2000000, s91
    s_add_u32 s91, s91, 1024
    s_cmp_eq_u32 s91, 14336
    s_cselect_b32 s91, 0, s91
    s_cmp_ge_u32 s91, s56
    s_cselect_b32 s12, 0x2000000, s91
    s_add_u32 s91, s91, 1024
    s_cmp_eq_u32 s91, 14336
    s_cselect_b32 s91, 0, s91
    s_cmp_ge_u32 s91, s56
    s_cselect_b32 s13, 0x2000000, s91
    s_add_u32 s91, s91, 1024
    s_cmp_eq_u32 s91, 14336
    s_cselect_b32 s91, 0, s91
    s_cmp_ge_u32 s91, s56
    s_cselect_b32 s14, 0x2000000, s91
    s_add_u32 s91, s91, 1024
    s_cmp_eq_u32 s91, 14336
    s_cselect_b32 s91, 0, s91
    s_cmp_ge_u32 s91, s56
    s_cselect_b32 s15, 0x2000000, s91
    s_add_u32 s91, s91, 1024
    s_cmp_eq_u32 s91, 14336
    s_cselect_b32 s91, 0, s91
    s_cmp_ge_u32 s91, s56
    s_cselect_b32 s16, 0x2000000, s91
    s_add_u32 s91, s91, 1024
    s_cmp_eq_u32 s91, 14336
    s_cselect_b32 s91, 0, s91
    s_cmp_ge_u32 s91, s56
    s_cselect_b32 s17, 0x2000000, s91
    s_lshl_b32 s52, s48, 2
    v_add_u32 v100, s52, v5
    v_xor_b32 v100, v100, v4
    v_lshlrev_b32 v100, 4, v100
    v_lshl_add_u32 v100, v4, 8, v100
    v_add_u32 v50, s50, v100
    s_and_b32 s52, s48, 1
    s_lshl_b32 s52, s52, 3
    v_add_u32 v100, s52, v2
    v_lshlrev_b32 v102, 1, v3
    v_xor_b32 v102, v102, v100
    v_lshlrev_b32 v102, 4, v102
    v_lshl_add_u32 v102, v100, 8, v102
    s_lshr_b32 s52, s48, 1
    s_lshl_b32 s52, s52, 14
    v_add_u32 v253, s52, v102
    v_mul_u32_u24 v100, 1280, v100
    v_lshl_add_u32 v100, v3, 4, v100
    v_add_u32 v51, s70, v100
    v_lshl_add_u32 v102, v2, 3, 8
    v_lshrrev_b32 v100, v102, s71
    v_and_b32 v100, 0x7f, v100
    v_lshrrev_b32 v100, 1, v100
    v_mul_u32_u24 v102, 37, v100
    v_lshrrev_b32 v102, 8, v102
    v_mul_u32_u24 v48, 7, v102
    v_sub_u32 v48, v100, v48
    v_mul_u32_u24 v102, 27, v102
    v_min_u32 v100, s53, v3
    s_mul_i32 s52, s48, 7
    v_add3_u32 v100, v100, v102, s52
    v_lshlrev_b32 v100, 7, v100
    v_add_u32 v47, 8388608, v100
    s_add_u32 s69, s69, 8388608
    s_lshl_b32 s52, s48, 2
    s_add_u32 s69, s69, s52
L_code_c1:
    s_add_u32 m0, s49, 49152
    s_nop 0
    buffer_load_dwordx4 v18, s[28:31], s51 offen lds
    s_add_u32 m0, s49, 53248
    s_nop 0
    buffer_load_dwordx4 v10, s[20:23], s81 offen lds
    s_mul_i32 s51, s81, 1728
    s_add_u32 s51, s51, 128
    s_add_u32 m0, s49, 57344
    s_nop 0
    buffer_load_dwordx4 v17, s[24:27], s51 offen lds
    s_add_u32 m0, s49, 61440
    s_nop 0
    buffer_load_dwordx4 v17, s[28:31], s51 offen lds
    s_add_u32 m0, s49, 65536
    s_nop 0
    buffer_load_dwordx4 v18, s[24:27], s51 offen lds
    s_add_u32 m0, s49, 69632
    s_nop 0
    buffer_load_dwordx4 v18, s[28:31], s51 offen lds
    s_waitcnt vmcnt(10)
    s_barrier
    s_cmp_lg_u32 s48, 0
    s_cbranch_scc1 L_nogo
    s_bitcmp0_b32 s79, 9
    s_cbranch_scc1 L_nogo
    s_waitcnt vmcnt(0)
    s_mov_b32 s61, 1
    s_atomic_umax s61, s[44:45], 0
L_nogo:
    ds_read_b64_tr_b16 a[0:1], v29 offset:0
    ds_read_b64_tr_b16 a[2:3], v29 offset:512
    ds_read_b128 v[52:55], v23 offset:16384
    ds_read_b64_tr_b16 a[16:17], v29 offset:8192
    ds_read_b64_tr_b16 a[18:19], v29 offset:8704
    ds_read_b128 v[56:59], v24 offset:16384
    ds_read_b64_tr_b16 a[20:21], v29 offset:12288
    ds_read_b64_tr_b16 a[22:23], v29 offset:12800
    ds_read_b64_tr_b16 a[4:5], v29 offset:4096
    ds_read_b64_tr_b16 a[6:7], v29 offset:4608
    ds_read_b64_tr_b16 a[8:9], v104 offset:0
    ds_read_b64_tr_b16 a[10:11], v104 offset:512
    ds_read_b64_tr_b16 a[24:25], v104 offset:8192
    ds_read_b64_tr_b16 a[26:27], v104 offset:8704
    ds_read_b64_tr_b16 a[28:29], v104 offset:12288
    s_waitcnt lgkmcnt(12)
    v_mfma_f32_16x16x32_bf16 v[204:207], a[0:3], v[52:55], 0
    s_bfe_u32 s82, s67, 0x40008
    s_lshl_b32 s82, s82, 7
    s_mul_i32 s51, s82, 1728
    s_add_u32 m0, s49, 73728
    ds_read_b64_tr_b16 a[30:31], v104 offset:12800
    ds_read_b64_tr_b16 a[12:13], v104 offset:4096
    ds_read_b64_tr_b16 a[14:15], v104 offset:4608
    s_waitcnt lgkmcnt(12)
    v_mfma_f32_16x16x32_bf16 v[204:207], a[16:19], v[56:59], v[204:207]
    buffer_load_dwordx4 v17, s[24:27], s51 offen lds
    s_add_u32 m0, s49, 77824
    ds_read_b64_tr_b16 a[32:33], v29 offset:20480
    ds_read_b64_tr_b16 a[34:35], v29 offset:20992
    ds_read_b128 v[60:63], v23 offset:16384
    s_waitcnt lgkmcnt(13)
    v_mfma_f32_16x16x32_bf16 v[208:211], a[20:23], v[56:59], 0
    buffer_load_dwordx4 v17, s[28:31], s51 offen lds
    s_add_u32 m0, s49, 81920
    ds_read_b64_tr_b16 a[48:49], v29 offset:28672
    ds_read_b64_tr_b16 a[50:51], v29 offset:29184
    ds_read_b128 v[64:67], v24 offset:16384
    s_waitcnt lgkmcnt(14)
    v_mfma_f32_16x16x32_bf16 v[208:211], a[4:7], v[52:55], v[208:211]
    buffer_load_dwordx4 v18, s[24:27], s51 offen lds
    s_add_u32 m0, s49, 86016
    ds_read_b64_tr_b16 a[52:53], v29 offset:32768
    ds_read_b64_tr_b16 a[54:55], v29 offset:33280
    ds_read_b64_tr_b16 a[36:37], v29 offset:24576
    s_waitcnt lgkmcnt(15)
    v_mfma_f32_16x16x32_bf16 v[212:215], a[8:11], v[52:55], 0
    buffer_load_dwordx4 v18, s[28:31], s51 offen lds
    s_add_u32 m0, s49, 90112
    ds_read_b64_tr_b16 a[38:39], v29 offset:25088
    ds_read_b64_tr_b16 a[40:41], v104 offset:20480
    ds_read_b64_tr_b16 a[42:43], v104 offset:20992
    s_waitcnt lgkmcnt(15)
    v_mfma_f32_16x16x32_bf16 v[212:215], a[24:27], v[56:59], v[212:215]
    buffer_load_dwordx4 v10, s[20:23], s82 offen lds
    s_mul_i32 s51, s82, 1728
    s_add_u32 s51, s51, 128
    s_add_u32 m0, s49, 94208
    ds_read_b64_tr_b16 a[56:57], v104 offset:28672
    ds_read_b64_tr_b16 a[58:59], v104 offset:29184
    ds_read_b64_tr_b16 a[60:61], v104 offset:32768
    s_waitcnt lgkmcnt(15)
    v_mfma_f32_16x16x32_bf16 v[216:219], a[28:31], v[56:59], 0
    buffer_load_dwordx4 v17, s[24:27], s51 offen lds
    s_add_u32 m0, s49, 98304
    ds_read_b64_tr_b16 a[62:63], v104 offset:33280
    ds_read_b64_tr_b16 a[44:45], v104 offset:24576
    ds_read_b64_tr_b16 a[46:47], v104 offset:25088
    v_mfma_f32_16x16x32_bf16 v[216:219], a[12:15], v[52:55], v[216:219]
    buffer_load_dwordx4 v17, s[28:31], s51 offen lds
    s_add_u32 m0, s49, 102400
    s_waitcnt lgkmcnt(15)
    v_mfma_f32_16x16x32_bf16 v[188:191], a[32:35], v[60:63], 0
    buffer_load_dwordx4 v18, s[24:27], s51 offen lds
    s_add_u32 m0, s49, 106496
    s_waitcnt lgkmcnt(12)
    v_mfma_f32_16x16x32_bf16 v[188:191], a[48:51], v[64:67], v[188:191]
    buffer_load_dwordx4 v18, s[28:31], s51 offen lds
    s_bfe_u32 s83, s67, 0x4000c
    s_lshl_b32 s83, s83, 7
    s_mul_i32 s51, s83, 1728
    s_add_u32 m0, s49, 110592
    s_waitcnt lgkmcnt(10)
    v_mfma_f32_16x16x32_bf16 v[192:195], a[52:55], v[64:67], 0
    buffer_load_dwordx4 v17, s[24:27], s51 offen lds
    s_add_u32 m0, s49, 114688
    s_waitcnt lgkmcnt(8)
    v_mfma_f32_16x16x32_bf16 v[192:195], a[36:39], v[60:63], v[192:195]
    buffer_load_dwordx4 v17, s[28:31], s51 offen lds
    s_add_u32 m0, s49, 118784
    s_waitcnt lgkmcnt(6)
    v_mfma_f32_16x16x32_bf16 v[196:199], a[40:43], v[60:63], 0
    buffer_load_dwordx4 v18, s[24:27], s51 offen lds
    s_waitcnt vmcnt(12) lgkmcnt(0)
    s_barrier
    ds_read_b64_tr_b16 a[64:65], v29 offset:36864
    ds_read_b64_tr_b16 a[66:67], v29 offset:37376
    v_mfma_f32_16x16x32_bf16 v[196:199], a[56:59], v[64:67], v[196:199]
    s_add_u32 m0, s49, 122880
    ds_read_b128 v[68:71], v23 offset:53248
    ds_read_b64_tr_b16 a[80:81], v29 offset:45056
    ds_read_b64_tr_b16 a[82:83], v29 offset:45568
    v_mfma_f32_16x16x32_bf16 v[200:203], a[60:63], v[64:67], 0
    buffer_load_dwordx4 v18, s[28:31], s51 offen lds
    s_add_u32 m0, s49, 126976
    ds_read_b128 v[72:75], v24 offset:53248
    ds_read_b64_tr_b16 a[84:85], v29 offset:49152
    ds_read_b64_tr_b16 a[86:87], v29 offset:49664
    v_mfma_f32_16x16x32_bf16 v[200:203], a[44:47], v[60:63], v[200:203]
    buffer_load_dwordx4 v10, s[20:23], s83 offen lds
    s_mul_i32 s51, s83, 1728
    s_add_u32 s51, s51, 128
    s_add_u32 m0, s49, 131072
    ds_read_b64_tr_b16 a[68:69], v29 offset:40960
    ds_read_b64_tr_b16 a[70:71], v29 offset:41472
    ds_read_b64_tr_b16 a[72:73], v104 offset:36864
    s_waitcnt lgkmcnt(8)
    v_mfma_f32_16x16x32_bf16 v[204:207], a[64:67], v[68:71], v[204:207]
    buffer_load_dwordx4 v17, s[24:27], s51 offen lds
    s_add_u32 m0, s49, 135168
    ds_read_b64_tr_b16 a[74:75], v104 offset:37376
    ds_read_b64_tr_b16 a[88:89], v104 offset:45056
    ds_read_b64_tr_b16 a[90:91], v104 offset:45568
    s_waitcnt lgkmcnt(8)
    v_mfma_f32_16x16x32_bf16 v[204:207], a[80:83], v[72:75], v[204:207]
    buffer_load_dwordx4 v17, s[28:31], s51 offen lds
    s_add_u32 m0, s49, 139264
    ds_read_b64_tr_b16 a[92:93], v104 offset:49152
    ds_read_b64_tr_b16 a[94:95], v104 offset:49664
    ds_read_b64_tr_b16 a[76:77], v104 offset:40960
    s_waitcnt lgkmcnt(9)
    v_mfma_f32_16x16x32_bf16 v[208:211], a[84:87], v[72:75], v[208:211]
    buffer_load_dwordx4 v18, s[24:27], s51 offen lds
    s_add_u32 m0, s49, 143360
    ds_read_b64_tr_b16 a[78:79], v104 offset:41472
    ds_read_b64_tr_b16 a[96:97], v29 offset:57344
    ds_read_b64_tr_b16 a[98:99], v29 offset:57856
    s_waitcnt lgkmcnt(10)
    v_mfma_f32_16x16x32_bf16 v[208:211], a[68:71], v[68:71], v[208:211]
    buffer_load_dwordx4 v18, s[28:31], s51 offen lds
    s_bfe_u32 s84, s67, 0x40010
    s_lshl_b32 s84, s84, 7
    s_mul_i32 s51, s84, 1728
    s_add_u32 m0, s49, 147456
    ds_read_b128 v[76:79], v23 offset:53248
    ds_read_b64_tr_b16 a[112:113], v30 offset:0
    ds_read_b64_tr_b16 a[114:115], v30 offset:512
    s_waitcnt lgkmcnt(11)
    v_mfma_f32_16x16x32_bf16 v[212:215], a[72:75], v[68:71], v[212:215]
    buffer_load_dwordx4 v17, s[24:27], s51 offen lds
    s_add_u32 m0, s49, 151552
    ds_read_b128 v[80:83], v24 offset:53248
    ds_read_b64_tr_b16 a[116:117], v30 offset:4096
    ds_read_b64_tr_b16 a[118:119], v30 offset:4608
    s_waitcnt lgkmcnt(12)
    v_mfma_f32_16x16x32_bf16 v[212:215], a[88:91], v[72:75], v[212:215]
    buffer_load_dwordx4 v17, s[28:31], s51 offen lds
    s_add_u32 m0, s49, 155648
    ds_read_b64_tr_b16 a[100:101], v29 offset:61440
    ds_read_b64_tr_b16 a[102:103], v29 offset:61952
    ds_read_b64_tr_b16 a[104:105], v104 offset:57344
    s_waitcnt lgkmcnt(13)
    v_mfma_f32_16x16x32_bf16 v[216:219], a[92:95], v[72:75], v[216:219]
    buffer_load_dwordx4 v18, s[24:27], s51 offen lds
    ds_read_b64_tr_b16 a[106:107], v104 offset:57856
    ds_read_b64_tr_b16 a[120:121], v105 offset:0
    ds_read_b64_tr_b16 a[122:123], v105 offset:512
    s_waitcnt lgkmcnt(14)
    v_mfma_f32_16x16x32_bf16 v[216:219], a[76:79], v[68:71], v[216:219]
    ds_read_b64_tr_b16 a[124:125], v105 offset:4096
    ds_read_b64_tr_b16 a[126:127], v105 offset:4608
    ds_read_b64_tr_b16 a[108:109], v104 offset:61440
    s_waitcnt lgkmcnt(14)
    v_mfma_f32_16x16x32_bf16 v[188:191], a[96:99], v[76:79], v[188:191]
    ds_read_b64_tr_b16 a[110:111], v104 offset:61952
    s_waitcnt lgkmcnt(12)
    v_mfma_f32_16x16x32_bf16 v[188:191], a[112:115], v[80:83], v[188:191]
    s_waitcnt lgkmcnt(10)
    v_mfma_f32_16x16x32_bf16 v[192:195], a[116:119], v[80:83], v[192:195]
    s_waitcnt lgkmcnt(8)
    v_mfma_f32_16x16x32_bf16 v[192:195], a[100:103], v[76:79], v[192:195]
    s_waitcnt lgkmcnt(6)
    v_mfma_f32_16x16x32_bf16 v[196:199], a[104:107], v[76:79], v[196:199]
    s_waitcnt lgkmcnt(4)
    v_mfma_f32_16x16x32_bf16 v[196:199], a[120:123], v[80:83], v[196:199]
    s_waitcnt vmcnt(12) lgkmcnt(0)
    s_barrier
    ds_read_b64_tr_b16 a[0:1], v30 offset:8192
    ds_read_b64_tr_b16 a[2:3], v30 offset:8704
    v_mfma_f32_16x16x32_bf16 v[200:203], a[124:127], v[80:83], v[200:203]
    s_add_u32 m0, s49, 159744
    ds_read_b128 v[84:87], v25 offset:24576
    ds_read_b64_tr_b16 a[16:17], v30 offset:16384
    ds_read_b64_tr_b16 a[18:19], v30 offset:16896
    v_mfma_f32_16x16x32_bf16 v[200:203], a[108:111], v[76:79], v[200:203]
    buffer_load_dwordx4 v18, s[28:31], s51 offen lds
    s_add_u32 m0, s49, 0
    ds_read_b128 v[88:91], v26 offset:24576
    ds_read_b64_tr_b16 a[20:21], v30 offset:20480
    ds_read_b64_tr_b16 a[22:23], v30 offset:20992
    s_waitcnt lgkmcnt(5)
    v_mfma_f32_16x16x32_bf16 v[204:207], a[0:3], v[84:87], v[204:207]
    buffer_load_dwordx4 v10, s[20:23], s84 offen lds
    s_mul_i32 s51, s84, 1728
    s_add_u32 s51, s51, 128
    s_add_u32 m0, s49, 4096
    ds_read_b64_tr_b16 a[4:5], v30 offset:12288
    ds_read_b64_tr_b16 a[6:7], v30 offset:12800
    ds_read_b64_tr_b16 a[8:9], v105 offset:8192
    s_waitcnt lgkmcnt(5)
    v_mfma_f32_16x16x32_bf16 v[204:207], a[16:19], v[88:91], v[204:207]
    buffer_load_dwordx4 v17, s[24:27], s51 offen lds
    s_add_u32 m0, s49, 8192
    ds_read_b64_tr_b16 a[10:11], v105 offset:8704
    ds_read_b64_tr_b16 a[24:25], v105 offset:16384
    ds_read_b64_tr_b16 a[26:27], v105 offset:16896
    s_waitcnt lgkmcnt(6)
    v_mfma_f32_16x16x32_bf16 v[208:211], a[20:23], v[88:91], v[208:211]
    buffer_load_dwordx4 v17, s[28:31], s51 offen lds
    s_add_u32 m0, s49, 12288
    ds_read_b64_tr_b16 a[28:29], v105 offset:20480
    ds_read_b64_tr_b16 a[30:31], v105 offset:20992
    ds_read_b64_tr_b16 a[12:13], v105 offset:12288
    s_waitcnt lgkmcnt(7)
    v_mfma_f32_16x16x32_bf16 v[208:211], a[4:7], v[84:87], v[208:211]
    buffer_load_dwordx4 v18, s[24:27], s51 offen lds
    s_add_u32 m0, s49, 16384
    ds_read_b64_tr_b16 a[14:15], v105 offset:12800
    ds_read_b64_tr_b16 a[32:33], v30 offset:28672
    ds_read_b64_tr_b16 a[34:35], v30 offset:29184
    s_waitcnt lgkmcnt(8)
    v_mfma_f32_16x16x32_bf16 v[212:215], a[8:11], v[84:87], v[212:215]
    buffer_load_dwordx4 v18, s[28:31], s51 offen lds
    s_bfe_u32 s85, s67, 0x40014
    s_lshl_b32 s85, s85, 7
    s_mul_i32 s51, s85, 1728
    s_add_u32 m0, s49, 20480
    ds_read_b128 v[92:95], v25 offset:24576
    ds_read_b64_tr_b16 a[48:49], v30 offset:36864
    ds_read_b64_tr_b16 a[50:51], v30 offset:37376
    s_waitcnt lgkmcnt(9)
    v_mfma_f32_16x16x32_bf16 v[212:215], a[24:27], v[88:91], v[212:215]
    buffer_load_dwordx4 v17, s[24:27], s51 offen lds
    s_add_u32 m0, s49, 24576
    ds_read_b128 v[96:99], v26 offset:24576
    ds_read_b64_tr_b16 a[52:53], v30 offset:40960
    ds_read_b64_tr_b16 a[54:55], v30 offset:41472
    s_waitcnt lgkmcnt(10)
    v_mfma_f32_16x16x32_bf16 v[216:219], a[28:31], v[88:91], v[216:219]
    buffer_load_dwordx4 v17, s[28:31], s51 offen lds
    s_add_u32 m0, s49, 28672
    ds_read_b64_tr_b16 a[36:37], v30 offset:32768
    ds_read_b64_tr_b16 a[38:39], v30 offset:33280
    ds_read_b64_tr_b16 a[40:41], v105 offset:28672
    s_waitcnt lgkmcnt(11)
    v_mfma_f32_16x16x32_bf16 v[216:219], a[12:15], v[84:87], v[216:219]
    buffer_load_dwordx4 v18, s[24:27], s51 offen lds
    ds_read_b64_tr_b16 a[42:43], v105 offset:29184
    ds_read_b64_tr_b16 a[56:57], v105 offset:36864
    ds_read_b64_tr_b16 a[58:59], v105 offset:37376
    s_waitcnt lgkmcnt(11)
    v_mfma_f32_16x16x32_bf16 v[188:191], a[32:35], v[92:95], v[188:191]
    ds_read_b64_tr_b16 a[60:61], v105 offset:40960
    ds_read_b64_tr_b16 a[62:63], v105 offset:41472
    ds_read_b64_tr_b16 a[44:45], v105 offset:32768
    s_waitcnt lgkmcnt(11)
    v_mfma_f32_16x16x32_bf16 v[188:191], a[48:51], v[96:99], v[188:191]
    ds_read_b64_tr_b16 a[46:47], v105 offset:33280
    s_waitcnt lgkmcnt(10)
    v_mfma_f32_16x16x32_bf16 v[192:195], a[52:55], v[96:99], v[192:195]
    s_waitcnt lgkmcnt(8)
    v_mfma_f32_16x16x32_bf16 v[192:195], a[36:39], v[92:95], v[192:195]
    s_waitcnt lgkmcnt(6)
    v_mfma_f32_16x16x32_bf16 v[196:199], a[40:43], v[92:95], v[196:199]
    s_waitcnt lgkmcnt(4)
    v_mfma_f32_16x16x32_bf16 v[196:199], a[56:59], v[96:99], v[196:199]
    s_waitcnt lgkmcnt(2)
    v_mfma_f32_16x16x32_bf16 v[200:203], a[60:63], v[96:99], v[200:203]
    s_waitcnt vmcnt(12) lgkmcnt(0)
    s_barrier
    ds_read_b64_tr_b16 a[64:65], v30 offset:45056
    ds_read_b64_tr_b16 a[66:67], v30 offset:45568
    v_mfma_f32_16x16x32_bf16 v[200:203], a[44:47], v[92:95], v[200:203]
    s_add_u32 m0, s49, 32768
    ds_read_b128 v[52:55], v25 offset:61440
    ds_read_b64_tr_b16 a[80:81], v30 offset:53248
    ds_read_b64_tr_b16 a[82:83], v30 offset:53760
    s_waitcnt lgkmcnt(2)
    v_mfma_f32_16x16x32_bf16 v[204:207], a[64:67], v[52:55], v[204:207]
    buffer_load_dwordx4 v18, s[28:31], s51 offen lds
    s_add_u32 m0, s49, 36864
    ds_read_b128 v[56:59], v26 offset:61440
    ds_read_b64_tr_b16 a[84:85], v30 offset:57344
    ds_read_b64_tr_b16 a[86:87], v30 offset:57856
    s_waitcnt lgkmcnt(2)
    v_mfma_f32_16x16x32_bf16 v[204:207], a[80:83], v[56:59], v[204:207]
    buffer_load_dwordx4 v10, s[20:23], s85 offen lds
    s_mul_i32 s51, s85, 1728
    s_add_u32 s51, s51, 128
    s_add_u32 m0, s49, 40960
    ds_read_b64_tr_b16 a[68:69], v30 offset:49152
    ds_read_b64_tr_b16 a[70:71], v30 offset:49664
    ds_read_b64_tr_b16 a[72:73], v105 offset:45056
    s_waitcnt lgkmcnt(3)
    v_mfma_f32_16x16x32_bf16 v[208:211], a[84:87], v[56:59], v[208:211]
    buffer_load_dwordx4 v17, s[24:27], s51 offen lds
    s_add_u32 m0, s49, 45056
    ds_read_b64_tr_b16 a[74:75], v105 offset:45568
    ds_read_b64_tr_b16 a[88:89], v105 offset:53248
    ds_read_b64_tr_b16 a[90:91], v105 offset:53760
    s_waitcnt lgkmcnt(4)
    v_mfma_f32_16x16x32_bf16 v[208:211], a[68:71], v[52:55], v[208:211]
    buffer_load_dwordx4 v17, s[28:31], s51 offen lds
    s_add_u32 m0, s49, 49152
    ds_read_b64_tr_b16 a[92:93], v105 offset:57344
    ds_read_b64_tr_b16 a[94:95], v105 offset:57856
    ds_read_b64_tr_b16 a[76:77], v105 offset:49152
    s_waitcnt lgkmcnt(5)
    v_mfma_f32_16x16x32_bf16 v[212:215], a[72:75], v[52:55], v[212:215]
    buffer_load_dwordx4 v18, s[24:27], s51 offen lds
    s_add_u32 m0, s49, 53248
    ds_read_b64_tr_b16 a[78:79], v105 offset:49664
    ds_read_b64_tr_b16 a[96:97], v31 offset:0
    ds_read_b64_tr_b16 a[98:99], v31 offset:512
    s_waitcnt lgkmcnt(6)
    v_mfma_f32_16x16x32_bf16 v[212:215], a[88:91], v[56:59], v[212:215]
    buffer_load_dwordx4 v18, s[28:31], s51 offen lds
    s_bfe_u32 s86, s67, 0x40018
    s_lshl_b32 s86, s86, 7
    s_mul_i32 s51, s86, 1728
    s_add_u32 m0, s49, 57344
    ds_read_b128 v[60:63], v25 offset:61440
    ds_read_b64_tr_b16 a[112:113], v31 offset:8192
    ds_read_b64_tr_b16 a[114:115], v31 offset:8704
    s_waitcnt lgkmcnt(7)
    v_mfma_f32_16x16x32_bf16 v[216:219], a[92:95], v[56:59], v[216:219]
    buffer_load_dwordx4 v17, s[24:27], s51 offen lds
    s_add_u32 m0, s49, 61440
    ds_read_b128 v[64:67], v26 offset:61440
    ds_read_b64_tr_b16 a[116:117], v31 offset:12288
    ds_read_b64_tr_b16 a[118:119], v31 offset:12800
    s_waitcnt lgkmcnt(8)
    v_mfma_f32_16x16x32_bf16 v[216:219], a[76:79], v[52:55], v[216:219]
    buffer_load_dwordx4 v17, s[28:31], s51 offen lds
    s_add_u32 m0, s49, 65536
    ds_read_b64_tr_b16 a[100:101], v31 offset:4096
    ds_read_b64_tr_b16 a[102:103], v31 offset:4608
    ds_read_b64_tr_b16 a[104:105], v106 offset:0
    s_waitcnt lgkmcnt(8)
    v_mfma_f32_16x16x32_bf16 v[188:191], a[96:99], v[60:63], v[188:191]
    buffer_load_dwordx4 v18, s[24:27], s51 offen lds
    ds_read_b64_tr_b16 a[106:107], v106 offset:512
    ds_read_b64_tr_b16 a[120:121], v106 offset:8192
    ds_read_b64_tr_b16 a[122:123], v106 offset:8704
    s_waitcnt lgkmcnt(8)
    v_mfma_f32_16x16x32_bf16 v[188:191], a[112:115], v[64:67], v[188:191]
    ds_read_b64_tr_b16 a[124:125], v106 offset:12288
    ds_read_b64_tr_b16 a[126:127], v106 offset:12800
    ds_read_b64_tr_b16 a[108:109], v106 offset:4096
    s_waitcnt lgkmcnt(9)
    v_mfma_f32_16x16x32_bf16 v[192:195], a[116:119], v[64:67], v[192:195]
    ds_read_b64_tr_b16 a[110:111], v106 offset:4608
    s_waitcnt lgkmcnt(8)
    v_mfma_f32_16x16x32_bf16 v[192:195], a[100:103], v[60:63], v[192:195]
    s_waitcnt lgkmcnt(6)
    v_mfma_f32_16x16x32_bf16 v[196:199], a[104:107], v[60:63], v[196:199]
    s_waitcnt lgkmcnt(4)
    v_mfma_f32_16x16x32_bf16 v[196:199], a[120:123], v[64:67], v[196:199]
    s_waitcnt lgkmcnt(2)
    v_mfma_f32_16x16x32_bf16 v[200:203], a[124:127], v[64:67], v[200:203]
    s_waitcnt lgkmcnt(0)
    v_mfma_f32_16x16x32_bf16 v[200:203], a[108:111], v[60:63], v[200:203]
    s_waitcnt vmcnt(12)
    s_barrier
    ds_read_b64_tr_b16 a[0:1], v31 offset:16384
    ds_read_b64_tr_b16 a[2:3], v31 offset:16896
    ds_read_b128 v[68:71], v23 offset:0
    s_waitcnt lgkmcnt(0)
    v_mfma_f32_16x16x32_bf16 v[204:207], a[0:3], v[68:71], v[204:207]
    s_add_u32 m0, s49, 69632
    ds_read_b64_tr_b16 a[16:17], v31 offset:24576
    ds_read_b64_tr_b16 a[18:19], v31 offset:25088
    ds_read_b128 v[72:75], v24 offset:0
    s_waitcnt lgkmcnt(0)
    v_mfma_f32_16x16x32_bf16 v[204:207], a[16:19], v[72:75], v[204:207]
    buffer_load_dwordx4 v18, s[28:31], s51 offen lds
    s_add_u32 m0, s49, 73728
    ds_read_b64_tr_b16 a[20:21], v31 offset:28672
    ds_read_b64_tr_b16 a[22:23], v31 offset:29184
    ds_read_b64_tr_b16 a[4:5], v31 offset:20480
    s_waitcnt lgkmcnt(1)
    v_mfma_f32_16x16x32_bf16 v[208:211], a[20:23], v[72:75], v[208:211]
    buffer_load_dwordx4 v10, s[20:23], s86 offen lds
    s_mul_i32 s51, s86, 1728
    s_add_u32 s51, s51, 128
    s_add_u32 m0, s49, 77824
    ds_read_b64_tr_b16 a[6:7], v31 offset:20992
    ds_read_b64_tr_b16 a[8:9], v106 offset:16384
    ds_read_b64_tr_b16 a[10:11], v106 offset:16896
    s_waitcnt lgkmcnt(2)
    v_mfma_f32_16x16x32_bf16 v[208:211], a[4:7], v[68:71], v[208:211]
    buffer_load_dwordx4 v17, s[24:27], s51 offen lds
    s_add_u32 m0, s49, 81920
    ds_read_b64_tr_b16 a[24:25], v106 offset:24576
    ds_read_b64_tr_b16 a[26:27], v106 offset:25088
    ds_read_b64_tr_b16 a[28:29], v106 offset:28672
    s_waitcnt lgkmcnt(3)
    v_mfma_f32_16x16x32_bf16 v[212:215], a[8:11], v[68:71], v[212:215]
    buffer_load_dwordx4 v17, s[28:31], s51 offen lds
    s_add_u32 m0, s49, 86016
    ds_read_b64_tr_b16 a[30:31], v106 offset:29184
    ds_read_b64_tr_b16 a[12:13], v106 offset:20480
    ds_read_b64_tr_b16 a[14:15], v106 offset:20992
    s_waitcnt lgkmcnt(4)
    v_mfma_f32_16x16x32_bf16 v[212:215], a[24:27], v[72:75], v[212:215]
    buffer_load_dwordx4 v18, s[24:27], s51 offen lds
    s_add_u32 m0, s49, 90112
    ds_read_b64_tr_b16 a[32:33], v29 offset:4096
    ds_read_b64_tr_b16 a[34:35], v29 offset:4608
    ds_read_b128 v[76:79], v23 offset:0
    s_waitcnt lgkmcnt(5)
    v_mfma_f32_16x16x32_bf16 v[216:219], a[28:31], v[72:75], v[216:219]
    buffer_load_dwordx4 v18, s[28:31], s51 offen lds
    s_bfe_u32 s87, s67, 0x4001c
    s_lshl_b32 s87, s87, 7
    s_mul_i32 s51, s87, 1728
    s_add_u32 m0, s49, 94208
    ds_read_b64_tr_b16 a[48:49], v29 offset:12288
    ds_read_b64_tr_b16 a[50:51], v29 offset:12800
    ds_read_b128 v[80:83], v24 offset:0
    s_waitcnt lgkmcnt(6)
    v_mfma_f32_16x16x32_bf16 v[216:219], a[12:15], v[68:71], v[216:219]
    buffer_load_dwordx4 v17, s[24:27], s51 offen lds
    s_add_u32 m0, s49, 98304
    ds_read_b64_tr_b16 a[52:53], v29 offset:16384
    ds_read_b64_tr_b16 a[54:55], v29 offset:16896
    ds_read_b64_tr_b16 a[36:37], v29 offset:8192
    s_waitcnt lgkmcnt(6)
    v_mfma_f32_16x16x32_bf16 v[188:191], a[32:35], v[76:79], v[188:191]
    buffer_load_dwordx4 v17, s[28:31], s51 offen lds
    s_add_u32 m0, s49, 102400
    ds_read_b64_tr_b16 a[38:39], v29 offset:8704
    ds_read_b64_tr_b16 a[40:41], v104 offset:4096
    ds_read_b64_tr_b16 a[42:43], v104 offset:4608
    s_waitcnt lgkmcnt(6)
    v_mfma_f32_16x16x32_bf16 v[188:191], a[48:51], v[80:83], v[188:191]
    buffer_load_dwordx4 v18, s[24:27], s51 offen lds
    ds_read_b64_tr_b16 a[56:57], v104 offset:12288
    ds_read_b64_tr_b16 a[58:59], v104 offset:12800
    ds_read_b64_tr_b16 a[60:61], v104 offset:16384
    s_waitcnt lgkmcnt(7)
    v_mfma_f32_16x16x32_bf16 v[192:195], a[52:55], v[80:83], v[192:195]
    ds_read_b64_tr_b16 a[62:63], v104 offset:16896
    ds_read_b64_tr_b16 a[44:45], v104 offset:8192
    ds_read_b64_tr_b16 a[46:47], v104 offset:8704
    s_waitcnt lgkmcnt(8)
    v_mfma_f32_16x16x32_bf16 v[192:195], a[36:39], v[76:79], v[192:195]
    s_waitcnt lgkmcnt(6)
    v_mfma_f32_16x16x32_bf16 v[196:199], a[40:43], v[76:79], v[196:199]
    s_waitcnt lgkmcnt(4)
    v_mfma_f32_16x16x32_bf16 v[196:199], a[56:59], v[80:83], v[196:199]
    s_waitcnt lgkmcnt(2)
    v_mfma_f32_16x16x32_bf16 v[200:203], a[60:63], v[80:83], v[200:203]
    s_waitcnt lgkmcnt(0)
    v_mfma_f32_16x16x32_bf16 v[200:203], a[44:47], v[76:79], v[200:203]
    s_waitcnt vmcnt(12)
    s_barrier
    ds_read_b64_tr_b16 a[64:65], v29 offset:20480
    ds_read_b64_tr_b16 a[66:67], v29 offset:20992
    ds_read_b128 v[84:87], v23 offset:36864
    s_waitcnt lgkmcnt(0)
    v_mfma_f32_16x16x32_bf16 v[204:207], a[64:67], v[84:87], v[204:207]
    s_add_u32 m0, s49, 106496
    ds_read_b64_tr_b16 a[80:81], v29 offset:28672
    ds_read_b64_tr_b16 a[82:83], v29 offset:29184
    ds_read_b128 v[88:91], v24 offset:36864
    s_waitcnt lgkmcnt(0)
    v_mfma_f32_16x16x32_bf16 v[204:207], a[80:83], v[88:91], v[204:207]
    buffer_load_dwordx4 v18, s[28:31], s51 offen lds
    s_add_u32 m0, s49, 110592
    ds_read_b64_tr_b16 a[84:85], v29 offset:32768
    ds_read_b64_tr_b16 a[86:87], v29 offset:33280
    ds_read_b64_tr_b16 a[68:69], v29 offset:24576
    s_waitcnt lgkmcnt(1)
    v_mfma_f32_16x16x32_bf16 v[208:211], a[84:87], v[88:91], v[208:211]
    buffer_load_dwordx4 v10, s[20:23], s87 offen lds
    s_mul_i32 s51, s87, 1728
    s_add_u32 s51, s51, 128
    s_add_u32 m0, s49, 131072
    ds_read_b64_tr_b16 a[70:71], v29 offset:25088
    ds_read_b64_tr_b16 a[72:73], v104 offset:20480
    ds_read_b64_tr_b16 a[74:75], v104 offset:20992
    s_waitcnt lgkmcnt(2)
    v_mfma_f32_16x16x32_bf16 v[208:211], a[68:71], v[84:87], v[208:211]
    buffer_load_dwordx4 v17, s[24:27], s51 offen lds
    s_add_u32 m0, s49, 135168
    ds_read_b64_tr_b16 a[88:89], v104 offset:28672
    ds_read_b64_tr_b16 a[90:91], v104 offset:29184
    ds_read_b64_tr_b16 a[92:93], v104 offset:32768
    s_waitcnt lgkmcnt(3)
    v_mfma_f32_16x16x32_bf16 v[212:215], a[72:75], v[84:87], v[212:215]
    buffer_load_dwordx4 v17, s[28:31], s51 offen lds
    s_add_u32 m0, s49, 139264
    ds_read_b64_tr_b16 a[94:95], v104 offset:33280
    ds_read_b64_tr_b16 a[76:77], v104 offset:24576
    ds_read_b64_tr_b16 a[78:79], v104 offset:25088
    s_waitcnt lgkmcnt(4)
    v_mfma_f32_16x16x32_bf16 v[212:215], a[88:91], v[88:91], v[212:215]
    buffer_load_dwordx4 v18, s[24:27], s51 offen lds
    s_add_u32 m0, s49, 143360
    ds_read_b64_tr_b16 a[96:97], v29 offset:40960
    ds_read_b64_tr_b16 a[98:99], v29 offset:41472
    ds_read_b128 v[92:95], v23 offset:36864
    s_waitcnt lgkmcnt(5)
    v_mfma_f32_16x16x32_bf16 v[216:219], a[92:95], v[88:91], v[216:219]
    buffer_load_dwordx4 v18, s[28:31], s51 offen lds
    s_bfe_u32 s88, s79, 0x40000
    s_lshl_b32 s88, s88, 7
    s_mul_i32 s51, s88, 1728
    s_add_u32 m0, s49, 114688
    ds_read_b64_tr_b16 a[112:113], v29 offset:49152
    ds_read_b64_tr_b16 a[114:115], v29 offset:49664
    ds_read_b128 v[96:99], v24 offset:36864
    s_waitcnt lgkmcnt(6)
    v_mfma_f32_16x16x32_bf16 v[216:219], a[76:79], v[84:87], v[216:219]
    buffer_load_dwordx4 v17, s[24:27], s51 offen lds
    s_add_u32 m0, s49, 118784
    ds_read_b64_tr_b16 a[116:117], v29 offset:53248
    ds_read_b64_tr_b16 a[118:119], v29 offset:53760
    ds_read_b64_tr_b16 a[100:101], v29 offset:45056
    s_waitcnt lgkmcnt(6)
    v_mfma_f32_16x16x32_bf16 v[188:191], a[96:99], v[92:95], v[188:191]
    buffer_load_dwordx4 v17, s[28:31], s51 offen lds
    s_add_u32 m0, s49, 122880
    ds_read_b64_tr_b16 a[102:103], v29 offset:45568
    ds_read_b64_tr_b16 a[104:105], v104 offset:40960
    ds_read_b64_tr_b16 a[106:107], v104 offset:41472
    s_waitcnt lgkmcnt(6)
    v_mfma_f32_16x16x32_bf16 v[188:191], a[112:115], v[96:99], v[188:191]
    buffer_load_dwordx4 v18, s[24:27], s51 offen lds
    ds_read_b64_tr_b16 a[120:121], v104 offset:49152
    ds_read_b64_tr_b16 a[122:123], v104 offset:49664
    ds_read_b64_tr_b16 a[124:125], v104 offset:53248
    s_waitcnt lgkmcnt(7)
    v_mfma_f32_16x16x32_bf16 v[192:195], a[116:119], v[96:99], v[192:195]
    ds_read_b64_tr_b16 a[126:127], v104 offset:53760
    ds_read_b64_tr_b16 a[108:109], v104 offset:45056
    ds_read_b64_tr_b16 a[110:111], v104 offset:45568
    s_waitcnt lgkmcnt(8)
    v_mfma_f32_16x16x32_bf16 v[192:195], a[100:103], v[92:95], v[192:195]
    s_waitcnt lgkmcnt(6)
    v_mfma_f32_16x16x32_bf16 v[196:199], a[104:107], v[92:95], v[196:199]
    s_waitcnt lgkmcnt(4)
    v_mfma_f32_16x16x32_bf16 v[196:199], a[120:123], v[96:99], v[196:199]
    s_waitcnt lgkmcnt(2)
    v_mfma_f32_16x16x32_bf16 v[200:203], a[124:127], v[96:99], v[200:203]
    s_waitcnt lgkmcnt(0)
    v_mfma_f32_16x16x32_bf16 v[200:203], a[108:111], v[92:95], v[200:203]
    s_waitcnt vmcnt(12)
    s_barrier
    ds_read_b64_tr_b16 a[0:1], v29 offset:57344
    ds_read_b64_tr_b16 a[2:3], v29 offset:57856
    ds_read_b128 v[52:55], v25 offset:8192
    s_waitcnt lgkmcnt(0)
    v_mfma_f32_16x16x32_bf16 v[204:207], a[0:3], v[52:55], v[204:207]
    s_add_u32 m0, s49, 126976
    ds_read_b64_tr_b16 a[16:17], v30 offset:0
    ds_read_b64_tr_b16 a[18:19], v30 offset:512
    ds_read_b128 v[56:59], v26 offset:8192
    s_waitcnt lgkmcnt(0)
    v_mfma_f32_16x16x32_bf16 v[204:207], a[16:19], v[56:59], v[204:207]
    buffer_load_dwordx4 v18, s[28:31], s51 offen lds
    s_add_u32 m0, s49, 147456
    ds_read_b64_tr_b16 a[20:21], v30 offset:4096
    ds_read_b64_tr_b16 a[22:23], v30 offset:4608
    ds_read_b64_tr_b16 a[4:5], v29 offset:61440
    s_waitcnt lgkmcnt(1)
    v_mfma_f32_16x16x32_bf16 v[208:211], a[20:23], v[56:59], v[208:211]
    buffer_load_dwordx4 v10, s[20:23], s88 offen lds
    s_mul_i32 s51, s88, 1728
    s_add_u32 s51, s51, 128
    s_add_u32 m0, s49, 151552
    ds_read_b64_tr_b16 a[6:7], v29 offset:61952
    ds_read_b64_tr_b16 a[8:9], v104 offset:57344
    ds_read_b64_tr_b16 a[10:11], v104 offset:57856
    s_waitcnt lgkmcnt(2)
    v_mfma_f32_16x16x32_bf16 v[208:211], a[4:7], v[52:55], v[208:211]
    buffer_load_dwordx4 v17, s[24:27], s51 offen lds
    s_add_u32 m0, s49, 155648
    ds_read_b64_tr_b16 a[24:25], v105 offset:0
    ds_read_b64_tr_b16 a[26:27], v105 offset:512
    ds_read_b64_tr_b16 a[28:29], v105 offset:4096
    s_waitcnt lgkmcnt(3)
    v_mfma_f32_16x16x32_bf16 v[212:215], a[8:11], v[52:55], v[212:215]
    buffer_load_dwordx4 v17, s[28:31], s51 offen lds
    s_add_u32 m0, s49, 159744
    ds_read_b64_tr_b16 a[30:31], v105 offset:4608
    ds_read_b64_tr_b16 a[12:13], v104 offset:61440
    ds_read_b64_tr_b16 a[14:15], v104 offset:61952
    s_waitcnt lgkmcnt(4)
    v_mfma_f32_16x16x32_bf16 v[212:215], a[24:27], v[56:59], v[212:215]
    buffer_load_dwordx4 v18, s[24:27], s51 offen lds
    s_add_u32 m0, s49, 0
    ds_read_b64_tr_b16 a[32:33], v30 offset:12288
    ds_read_b64_tr_b16 a[34:35], v30 offset:12800
    ds_read_b128 v[60:63], v25 offset:8192
    s_waitcnt lgkmcnt(5)
    v_mfma_f32_16x16x32_bf16 v[216:219], a[28:31], v[56:59], v[216:219]
    buffer_load_dwordx4 v18, s[28:31], s51 offen lds
    s_bfe_u32 s89, s79, 0x40004
    s_lshl_b32 s89, s89, 7
    s_mul_i32 s51, s89, 1728
    s_add_u32 m0, s49, 4096
    ds_read_b64_tr_b16 a[48:49], v30 offset:20480
    ds_read_b64_tr_b16 a[50:51], v30 offset:20992
    ds_read_b128 v[64:67], v26 offset:8192
    s_waitcnt lgkmcnt(6)
    v_mfma_f32_16x16x32_bf16 v[216:219], a[12:15], v[52:55], v[216:219]
    buffer_load_dwordx4 v17, s[24:27], s51 offen lds
    s_add_u32 m0, s49, 8192
    ds_read_b64_tr_b16 a[52:53], v30 offset:24576
    ds_read_b64_tr_b16 a[54:55], v30 offset:25088
    ds_read_b64_tr_b16 a[36:37], v30 offset:16384
    s_waitcnt lgkmcnt(6)
    v_mfma_f32_16x16x32_bf16 v[188:191], a[32:35], v[60:63], v[188:191]
    buffer_load_dwordx4 v17, s[28:31], s51 offen lds
    s_add_u32 m0, s49, 12288
    ds_read_b64_tr_b16 a[38:39], v30 offset:16896
    ds_read_b64_tr_b16 a[40:41], v105 offset:12288
    ds_read_b64_tr_b16 a[42:43], v105 offset:12800
    s_waitcnt lgkmcnt(6)
    v_mfma_f32_16x16x32_bf16 v[188:191], a[48:51], v[64:67], v[188:191]
    buffer_load_dwordx4 v18, s[24:27], s51 offen lds
    ds_read_b64_tr_b16 a[56:57], v105 offset:20480
    ds_read_b64_tr_b16 a[58:59], v105 offset:20992
    ds_read_b64_tr_b16 a[60:61], v105 offset:24576
    s_waitcnt lgkmcnt(7)
    v_mfma_f32_16x16x32_bf16 v[192:195], a[52:55], v[64:67], v[192:195]
    ds_read_b64_tr_b16 a[62:63], v105 offset:25088
    ds_read_b64_tr_b16 a[44:45], v105 offset:16384
    ds_read_b64_tr_b16 a[46:47], v105 offset:16896
    s_waitcnt lgkmcnt(8)
    v_mfma_f32_16x16x32_bf16 v[192:195], a[36:39], v[60:63], v[192:195]
    s_waitcnt lgkmcnt(6)
    v_mfma_f32_16x16x32_bf16 v[196:199], a[40:43], v[60:63], v[196:199]
    s_waitcnt lgkmcnt(4)
    v_mfma_f32_16x16x32_bf16 v[196:199], a[56:59], v[64:67], v[196:199]
    s_waitcnt lgkmcnt(2)
    v_mfma_f32_16x16x32_bf16 v[200:203], a[60:63], v[64:67], v[200:203]
    s_waitcnt lgkmcnt(0)
    v_mfma_f32_16x16x32_bf16 v[200:203], a[44:47], v[60:63], v[200:203]
    s_waitcnt vmcnt(12)
    s_barrier
    buffer_load_dword v8, v9, s[44:47], s49 offen sc1
    ds_read_b64_tr_b16 a[64:65], v30 offset:28672
    ds_read_b64_tr_b16 a[66:67], v30 offset:29184
    ds_read_b128 v[68:71], v25 offset:45056
    s_waitcnt lgkmcnt(0)
    v_mfma_f32_16x16x32_bf16 v[204:207], a[64:67], v[68:71], v[204:207]
    s_add_u32 m0, s49, 16384
    ds_read_b64_tr_b16 a[80:81], v30 offset:36864
    ds_read_b64_tr_b16 a[82:83], v30 offset:37376
    ds_read_b128 v[72:75], v26 offset:45056
    s_waitcnt lgkmcnt(0)
    v_mfma_f32_16x16x32_bf16 v[204:207], a[80:83], v[72:75], v[204:207]
    buffer_load_dwordx4 v18, s[28:31], s51 offen lds
    s_add_u32 m0, s49, 20480
    ds_read_b64_tr_b16 a[84:85], v30 offset:40960
    ds_read_b64_tr_b16 a[86:87], v30 offset:41472
    ds_read_b64_tr_b16 a[68:69], v30 offset:32768
    s_waitcnt lgkmcnt(1)
    v_mfma_f32_16x16x32_bf16 v[208:211], a[84:87], v[72:75], v[208:211]
    buffer_load_dwordx4 v10, s[20:23], s89 offen lds
    s_mul_i32 s51, s89, 1728
    s_add_u32 s51, s51, 128
    s_add_u32 m0, s49, 24576
    ds_read_b64_tr_b16 a[70:71], v30 offset:33280
    ds_read_b64_tr_b16 a[72:73], v105 offset:28672
    ds_read_b64_tr_b16 a[74:75], v105 offset:29184
    s_waitcnt lgkmcnt(2)
    v_mfma_f32_16x16x32_bf16 v[208:211], a[68:71], v[68:71], v[208:211]
    buffer_load_dwordx4 v17, s[24:27], s51 offen lds
    s_add_u32 m0, s49, 28672
    ds_read_b64_tr_b16 a[88:89], v105 offset:36864
    ds_read_b64_tr_b16 a[90:91], v105 offset:37376
    ds_read_b64_tr_b16 a[92:93], v105 offset:40960
    s_waitcnt lgkmcnt(3)
    v_mfma_f32_16x16x32_bf16 v[212:215], a[72:75], v[68:71], v[212:215]
    buffer_load_dwordx4 v17, s[28:31], s51 offen lds
    s_add_u32 m0, s49, 32768
    ds_read_b64_tr_b16 a[94:95], v105 offset:41472
    ds_read_b64_tr_b16 a[76:77], v105 offset:32768
    ds_read_b64_tr_b16 a[78:79], v105 offset:33280
    s_waitcnt lgkmcnt(4)
    v_mfma_f32_16x16x32_bf16 v[212:215], a[88:91], v[72:75], v[212:215]
    buffer_load_dwordx4 v18, s[24:27], s51 offen lds
    s_add_u32 m0, s49, 36864
    ds_read_b64_tr_b16 a[96:97], v31 offset:0
    ds_read_b64_tr_b16 a[98:99], v31 offset:512
    ds_read_b128 v[76:79], v25 offset:45056
    s_waitcnt lgkmcnt(5)
    v_mfma_f32_16x16x32_bf16 v[216:219], a[92:95], v[72:75], v[216:219]
    buffer_load_dwordx4 v18, s[28:31], s51 offen lds
    s_mul_i32 s55, s4, 40
    s_add_u32 m0, s50, 49152
    ds_read_b64_tr_b16 a[112:113], v31 offset:8192
    ds_read_b64_tr_b16 a[114:115], v31 offset:8704
    ds_read_b128 v[80:83], v26 offset:45056
    s_waitcnt lgkmcnt(6)
    v_mfma_f32_16x16x32_bf16 v[216:219], a[76:79], v[68:71], v[216:219]
    buffer_load_dwordx4 v19, s[32:35], s55 offen lds
    s_add_u32 m0, s50, 50176
    ds_read_b64_tr_b16 a[116:117], v31 offset:12288
    ds_read_b64_tr_b16 a[118:119], v31 offset:12800
    ds_read_b64_tr_b16 a[100:101], v31 offset:4096
    s_waitcnt lgkmcnt(6)
    v_mfma_f32_16x16x32_bf16 v[188:191], a[96:99], v[76:79], v[188:191]
    buffer_load_dwordx4 v20, s[32:35], s55 offen lds
    s_add_u32 m0, s50, 51200
    ds_read_b64_tr_b16 a[102:103], v31 offset:4608
    ds_read_b64_tr_b16 a[104:105], v106 offset:0
    ds_read_b64_tr_b16 a[106:107], v106 offset:512
    s_waitcnt lgkmcnt(6)
    v_mfma_f32_16x16x32_bf16 v[188:191], a[112:115], v[80:83], v[188:191]
    buffer_load_dwordx4 v21, s[32:35], s55 offen lds
    s_add_u32 m0, s50, 52224
    ds_read_b64_tr_b16 a[120:121], v106 offset:8192
    ds_read_b64_tr_b16 a[122:123], v106 offset:8704
    ds_read_b64_tr_b16 a[124:125], v106 offset:12288
    s_waitcnt lgkmcnt(7)
    v_mfma_f32_16x16x32_bf16 v[192:195], a[116:119], v[80:83], v[192:195]
    buffer_load_dwordx4 v22, s[32:35], s55 offen lds
    s_mul_i32 s55, s5, 40
    s_add_u32 m0, s50, 65536
    ds_read_b64_tr_b16 a[126:127], v106 offset:12800
    ds_read_b64_tr_b16 a[108:109], v106 offset:4096
    ds_read_b64_tr_b16 a[110:111], v106 offset:4608
    s_waitcnt lgkmcnt(8)
    v_mfma_f32_16x16x32_bf16 v[192:195], a[100:103], v[76:79], v[192:195]
    buffer_load_dwordx4 v19, s[32:35], s55 offen lds
    s_add_u32 m0, s50, 66560
    s_waitcnt lgkmcnt(6)
    v_mfma_f32_16x16x32_bf16 v[196:199], a[104:107], v[76:79], v[196:199]
    buffer_load_dwordx4 v20, s[32:35], s55 offen lds
    s_add_u32 m0, s50, 67584
    s_waitcnt lgkmcnt(4)
    v_mfma_f32_16x16x32_bf16 v[196:199], a[120:123], v[80:83], v[196:199]
    buffer_load_dwordx4 v21, s[32:35], s55 offen lds
    s_add_u32 m0, s50, 68608
    s_waitcnt lgkmcnt(2)
    v_mfma_f32_16x16x32_bf16 v[200:203], a[124:127], v[80:83], v[200:203]
    buffer_load_dwordx4 v22, s[32:35], s55 offen lds
    s_waitcnt vmcnt(18) lgkmcnt(0)
    s_barrier
    ds_read_b64_tr_b16 a[0:1], v30 offset:49152
    ds_read_b64_tr_b16 a[2:3], v30 offset:49664
    v_mfma_f32_16x16x32_bf16 v[200:203], a[108:111], v[76:79], v[200:203]
    s_mul_i32 s55, s6, 40
    s_add_u32 m0, s50, 81920
    ds_read_b128 v[84:87], v27 offset:16384
    ds_read_b64_tr_b16 a[16:17], v30 offset:57344
    ds_read_b64_tr_b16 a[18:19], v30 offset:57856
    s_waitcnt lgkmcnt(2)
    v_mfma_f32_16x16x32_bf16 v[204:207], a[0:3], v[84:87], v[204:207]
    buffer_load_dwordx4 v19, s[32:35], s55 offen lds
    s_add_u32 m0, s50, 82944
    ds_read_b128 v[88:91], v28 offset:16384
    ds_read_b64_tr_b16 a[20:21], v30 offset:61440
    ds_read_b64_tr_b16 a[22:23], v30 offset:61952
    s_waitcnt lgkmcnt(2)
    v_mfma_f32_16x16x32_bf16 v[204:207], a[16:19], v[88:91], v[204:207]
    buffer_load_dwordx4 v20, s[32:35], s55 offen lds
    s_add_u32 m0, s50, 83968
    ds_read_b64_tr_b16 a[4:5], v30 offset:53248
    ds_read_b64_tr_b16 a[6:7], v30 offset:53760
    ds_read_b64_tr_b16 a[8:9], v105 offset:49152
    s_waitcnt lgkmcnt(3)
    v_mfma_f32_16x16x32_bf16 v[208:211], a[20:23], v[88:91], v[208:211]
    buffer_load_dwordx4 v21, s[32:35], s55 offen lds
    s_add_u32 m0, s50, 84992
    ds_read_b64_tr_b16 a[10:11], v105 offset:49664
    ds_read_b64_tr_b16 a[24:25], v105 offset:57344
    ds_read_b64_tr_b16 a[26:27], v105 offset:57856
    s_waitcnt lgkmcnt(4)
    v_mfma_f32_16x16x32_bf16 v[208:211], a[4:7], v[84:87], v[208:211]
    buffer_load_dwordx4 v22, s[32:35], s55 offen lds
    s_mul_i32 s55, s7, 40
    s_add_u32 m0, s50, 131072
    ds_read_b64_tr_b16 a[28:29], v105 offset:61440
    ds_read_b64_tr_b16 a[30:31], v105 offset:61952
    ds_read_b64_tr_b16 a[12:13], v105 offset:53248
    s_waitcnt lgkmcnt(5)
    v_mfma_f32_16x16x32_bf16 v[212:215], a[8:11], v[84:87], v[212:215]
    buffer_load_dwordx4 v19, s[32:35], s55 offen lds
    s_add_u32 m0, s50, 132096
    ds_read_b64_tr_b16 a[14:15], v105 offset:53760
    ds_read_b64_tr_b16 a[32:33], v31 offset:20480
    ds_read_b64_tr_b16 a[34:35], v31 offset:20992
    s_waitcnt lgkmcnt(6)
    v_mfma_f32_16x16x32_bf16 v[212:215], a[24:27], v[88:91], v[212:215]
    buffer_load_dwordx4 v20, s[32:35], s55 offen lds
    s_add_u32 m0, s50, 133120
    ds_read_b128 v[92:95], v27 offset:16384
    ds_read_b64_tr_b16 a[48:49], v31 offset:28672
    ds_read_b64_tr_b16 a[50:51], v31 offset:29184
    s_waitcnt lgkmcnt(7)
    v_mfma_f32_16x16x32_bf16 v[216:219], a[28:31], v[88:91], v[216:219]
    buffer_load_dwordx4 v21, s[32:35], s55 offen lds
    s_add_u32 m0, s50, 134144
    ds_read_b128 v[96:99], v28 offset:16384
    ds_read_b64_tr_b16 a[52:53], v29 offset:0
    ds_read_b64_tr_b16 a[54:55], v29 offset:512
    s_waitcnt lgkmcnt(8)
    v_mfma_f32_16x16x32_bf16 v[216:219], a[12:15], v[84:87], v[216:219]
    buffer_load_dwordx4 v22, s[32:35], s55 offen lds
    s_mul_i32 s55, s8, 40
    s_add_u32 m0, s50, 98304
    ds_read_b64_tr_b16 a[36:37], v31 offset:24576
    ds_read_b64_tr_b16 a[38:39], v31 offset:25088
    ds_read_b64_tr_b16 a[40:41], v106 offset:20480
    s_waitcnt lgkmcnt(8)
    v_mfma_f32_16x16x32_bf16 v[188:191], a[32:35], v[92:95], v[188:191]
    buffer_load_dwordx4 v19, s[32:35], s55 offen lds
    s_add_u32 m0, s50, 99328
    ds_read_b64_tr_b16 a[42:43], v106 offset:20992
    ds_read_b64_tr_b16 a[56:57], v106 offset:28672
    ds_read_b64_tr_b16 a[58:59], v106 offset:29184
    s_waitcnt lgkmcnt(8)
    v_mfma_f32_16x16x32_bf16 v[188:191], a[48:51], v[96:99], v[188:191]
    buffer_load_dwordx4 v20, s[32:35], s55 offen lds
    s_add_u32 m0, s50, 100352
    ds_read_b64_tr_b16 a[60:61], v104 offset:0
    ds_read_b64_tr_b16 a[62:63], v104 offset:512
    ds_read_b64_tr_b16 a[44:45], v106 offset:24576
    s_waitcnt lgkmcnt(9)
    v_mfma_f32_16x16x32_bf16 v[192:195], a[52:55], v[96:99], v[192:195]
    buffer_load_dwordx4 v21, s[32:35], s55 offen lds
    s_add_u32 m0, s50, 101376
    ds_read_b64_tr_b16 a[46:47], v106 offset:25088
    s_waitcnt lgkmcnt(8)
    v_mfma_f32_16x16x32_bf16 v[192:195], a[36:39], v[92:95], v[192:195]
    buffer_load_dwordx4 v22, s[32:35], s55 offen lds
    s_waitcnt lgkmcnt(6)
    v_mfma_f32_16x16x32_bf16 v[196:199], a[40:43], v[92:95], v[196:199]
    s_waitcnt vmcnt(26)
    v_readfirstlane_b32 s52, v8
    s_nop 0
    s_or_b32 s52, s52, s48
    s_cmp_eq_u32 s52, 0
    s_cbranch_scc1 L_go_c1s
L_go_c1:
    s_waitcnt vmcnt(20) lgkmcnt(0)
    s_barrier
    ds_read_b64_tr_b16 a[64:65], v29 offset:4096
    ds_read_b64_tr_b16 a[66:67], v29 offset:4608
    v_mfma_f32_16x16x32_bf16 v[196:199], a[56:59], v[96:99], v[196:199]
    s_mul_i32 s55, s9, 40
    s_add_u32 m0, s50, 114688
    ds_read_b128 v[52:55], v23 offset:20480
    ds_read_b64_tr_b16 a[80:81], v29 offset:12288
    ds_read_b64_tr_b16 a[82:83], v29 offset:12800
    v_mfma_f32_16x16x32_bf16 v[200:203], a[60:63], v[96:99], v[200:203]
    buffer_load_dwordx4 v19, s[32:35], s55 offen lds
    s_add_u32 m0, s50, 115712
    ds_read_b128 v[56:59], v24 offset:20480
    ds_read_b64_tr_b16 a[84:85], v29 offset:16384
    ds_read_b64_tr_b16 a[86:87], v29 offset:16896
    v_mfma_f32_16x16x32_bf16 v[200:203], a[44:47], v[92:95], v[200:203]
    buffer_load_dwordx4 v20, s[32:35], s55 offen lds
    s_add_u32 m0, s50, 116736
    ds_read_b64_tr_b16 a[68:69], v29 offset:8192
    ds_read_b64_tr_b16 a[70:71], v29 offset:8704
    ds_read_b64_tr_b16 a[72:73], v104 offset:4096
    s_waitcnt lgkmcnt(8)
    v_mfma_f32_16x16x32_bf16 v[204:207], a[64:67], v[52:55], v[204:207]
    buffer_load_dwordx4 v21, s[32:35], s55 offen lds
    s_add_u32 m0, s50, 117760
    ds_read_b64_tr_b16 a[74:75], v104 offset:4608
    ds_read_b64_tr_b16 a[88:89], v104 offset:12288
    ds_read_b64_tr_b16 a[90:91], v104 offset:12800
    s_waitcnt lgkmcnt(8)
    v_mfma_f32_16x16x32_bf16 v[204:207], a[80:83], v[56:59], v[204:207]
    buffer_load_dwordx4 v22, s[32:35], s55 offen lds
    s_mul_i32 s55, s10, 40
    s_add_u32 m0, s50, 147456
    ds_read_b64_tr_b16 a[92:93], v104 offset:16384
    ds_read_b64_tr_b16 a[94:95], v104 offset:16896
    ds_read_b64_tr_b16 a[76:77], v104 offset:8192
    s_waitcnt lgkmcnt(9)
    v_mfma_f32_16x16x32_bf16 v[208:211], a[84:87], v[56:59], v[208:211]
    buffer_load_dwordx4 v19, s[32:35], s55 offen lds
    s_add_u32 m0, s50, 148480
    ds_read_b64_tr_b16 a[78:79], v104 offset:8704
    ds_read_b64_tr_b16 a[96:97], v29 offset:24576
    ds_read_b64_tr_b16 a[98:99], v29 offset:25088
    s_waitcnt lgkmcnt(10)
    v_mfma_f32_16x16x32_bf16 v[208:211], a[68:71], v[52:55], v[208:211]
    buffer_load_dwordx4 v20, s[32:35], s55 offen lds
    s_add_u32 m0, s50, 149504
    ds_read_b128 v[60:63], v23 offset:20480
    ds_read_b64_tr_b16 a[112:113], v29 offset:32768
    ds_read_b64_tr_b16 a[114:115], v29 offset:33280
    s_waitcnt lgkmcnt(11)
    v_mfma_f32_16x16x32_bf16 v[212:215], a[72:75], v[52:55], v[212:215]
    buffer_load_dwordx4 v21, s[32:35], s55 offen lds
    s_add_u32 m0, s50, 150528
    ds_read_b128 v[64:67], v24 offset:20480
    ds_read_b64_tr_b16 a[116:117], v29 offset:36864
    ds_read_b64_tr_b16 a[118:119], v29 offset:37376
    s_waitcnt lgkmcnt(12)
    v_mfma_f32_16x16x32_bf16 v[212:215], a[88:91], v[56:59], v[212:215]
    buffer_load_dwordx4 v22, s[32:35], s55 offen lds
    ds_read_b64_tr_b16 a[100:101], v29 offset:28672
    ds_read_b64_tr_b16 a[102:103], v29 offset:29184
    ds_read_b64_tr_b16 a[104:105], v104 offset:24576
    s_waitcnt lgkmcnt(13)
    v_mfma_f32_16x16x32_bf16 v[216:219], a[92:95], v[56:59], v[216:219]
    ds_read_b64_tr_b16 a[106:107], v104 offset:25088
    ds_read_b64_tr_b16 a[120:121], v104 offset:32768
    ds_read_b64_tr_b16 a[122:123], v104 offset:33280
    s_waitcnt lgkmcnt(14)
    v_mfma_f32_16x16x32_bf16 v[216:219], a[76:79], v[52:55], v[216:219]
    ds_read_b64_tr_b16 a[124:125], v104 offset:36864
    ds_read_b64_tr_b16 a[126:127], v104 offset:37376
    ds_read_b64_tr_b16 a[108:109], v104 offset:28672
    s_waitcnt lgkmcnt(14)
    v_mfma_f32_16x16x32_bf16 v[188:191], a[96:99], v[60:63], v[188:191]
    ds_read_b64_tr_b16 a[110:111], v104 offset:29184
    s_waitcnt lgkmcnt(12)
    v_mfma_f32_16x16x32_bf16 v[188:191], a[112:115], v[64:67], v[188:191]
    s_waitcnt lgkmcnt(10)
    v_mfma_f32_16x16x32_bf16 v[192:195], a[116:119], v[64:67], v[192:195]
    s_waitcnt lgkmcnt(8)
    v_mfma_f32_16x16x32_bf16 v[192:195], a[100:103], v[60:63], v[192:195]
    s_waitcnt lgkmcnt(6)
    v_mfma_f32_16x16x32_bf16 v[196:199], a[104:107], v[60:63], v[196:199]
    s_waitcnt lgkmcnt(4)
    v_mfma_f32_16x16x32_bf16 v[196:199], a[120:123], v[64:67], v[196:199]
    s_waitcnt lgkmcnt(2)
    v_mfma_f32_16x16x32_bf16 v[200:203], a[124:127], v[64:67], v[200:203]
    s_waitcnt lgkmcnt(0)
    v_mfma_f32_16x16x32_bf16 v[200:203], a[108:111], v[60:63], v[200:203]
    s_barrier
    s_nop 7
    v_pk_mul_f32 v[100:101], v[204:205], v[204:205]
    s_mul_i32 s55, s11, 40
    s_add_u32 m0, s50, 0
    v_pk_mul_f32 v[102:103], v[206:207], v[206:207]
    buffer_load_dwordx4 v19, s[32:35], s55 offen lds
    v_pk_mul_f32 v[104:105], v[212:213], v[212:213]
    s_waitcnt vmcnt(25)
    v_pk_mul_f32 v[106:107], v[214:215], v[214:215]
    ds_read_b64_tr_b16 a[160:161], v32 offset:49152
    v_pk_fma_f32 v[100:101], v[100:101], s[62:63], s[62:63] op_sel:[0,0,1] op_sel_hi:[1,0,1]
    ds_read_b64_tr_b16 a[162:163], v32 offset:51200
    v_pk_fma_f32 v[102:103], v[102:103], s[62:63], s[62:63] op_sel:[0,0,1] op_sel_hi:[1,0,1]
    ds_read_b64_tr_b16 a[164:165], v33 offset:49152
    v_pk_fma_f32 v[104:105], v[104:105], s[62:63], s[62:63] op_sel:[0,0,1] op_sel_hi:[1,0,1]
    ds_read_b64_tr_b16 a[166:167], v33 offset:51200
    v_pk_fma_f32 v[106:107], v[106:107], s[62:63], s[62:63] op_sel:[0,0,1] op_sel_hi:[1,0,1]
    s_add_u32 m0, s50, 1024
    v_pk_mul_f32 v[100:101], v[100:101], v[204:205]
    buffer_load_dwordx4 v20, s[32:35], s55 offen lds
    v_pk_mul_f32 v[102:103], v[102:103], v[206:207]
    ds_read_b64_tr_b16 a[168:169], v34 offset:49152
    v_pk_mul_f32 v[104:105], v[104:105], v[212:213]
    ds_read_b64_tr_b16 a[170:171], v34 offset:51200
    v_pk_mul_f32 v[106:107], v[106:107], v[214:215]
    ds_read_b64_tr_b16 a[172:173], v35 offset:49152
    v_exp_f32 v100, v100
    ds_read_b64_tr_b16 a[174:175], v35 offset:51200
    v_exp_f32 v101, v101
    s_add_u32 m0, s50, 2048
    v_exp_f32 v102, v102
    buffer_load_dwordx4 v21, s[32:35], s55 offen lds
    v_exp_f32 v103, v103
    s_waitcnt vmcnt(23)
    v_exp_f32 v104, v104
    ds_read_b64_tr_b16 a[176:177], v36 offset:0
    v_exp_f32 v105, v105
    ds_read_b64_tr_b16 a[178:179], v36 offset:2048
    v_exp_f32 v106, v106
    s_add_u32 m0, s50, 3072
    v_exp_f32 v107, v107
    buffer_load_dwordx4 v22, s[32:35], s55 offen lds
    v_pk_add_f32 v[100:101], v[100:101], 1.0 op_sel_hi:[1,0]
    ds_read_b64_tr_b16 a[180:181], v37 offset:0
    v_pk_add_f32 v[102:103], v[102:103], 1.0 op_sel_hi:[1,0]
    ds_read_b64_tr_b16 a[182:183], v37 offset:2048
    v_pk_add_f32 v[104:105], v[104:105], 1.0 op_sel_hi:[1,0]
    ds_read_b64_tr_b16 a[184:185], v38 offset:0
    v_pk_add_f32 v[106:107], v[106:107], 1.0 op_sel_hi:[1,0]
    ds_read_b64_tr_b16 a[186:187], v38 offset:2048
    v_rcp_f32 v100, v100
    s_mul_i32 s55, s12, 40
    s_add_u32 m0, s50, 32768
    v_rcp_f32 v101, v101
    buffer_load_dwordx4 v19, s[32:35], s55 offen lds
    v_rcp_f32 v102, v102
    ds_read_b64_tr_b16 a[188:189], v39 offset:0
    v_rcp_f32 v103, v103
    ds_read_b64_tr_b16 a[190:191], v39 offset:2048
    v_rcp_f32 v104, v104
    s_waitcnt vmcnt(21)
    v_rcp_f32 v105, v105
    s_add_u32 m0, s50, 33792
    v_rcp_f32 v106, v106
    buffer_load_dwordx4 v20, s[32:35], s55 offen lds
    v_rcp_f32 v107, v107
    ds_read_b64_tr_b16 a[192:193], v36 offset:16384
    v_pk_mul_f32 v[100:101], v[100:101], v[204:205]
    ds_read_b64_tr_b16 a[194:195], v36 offset:18432
    v_pk_mul_f32 v[102:103], v[102:103], v[206:207]
    ds_read_b64_tr_b16 a[196:197], v37 offset:16384
    v_pk_mul_f32 v[104:105], v[104:105], v[212:213]
    ds_read_b64_tr_b16 a[198:199], v37 offset:18432
    v_pk_mul_f32 v[106:107], v[106:107], v[214:215]
    s_add_u32 m0, s50, 34816
    v_pk_mul_f32 v[100:101], v[100:101], v[208:209]
    buffer_load_dwordx4 v21, s[32:35], s55 offen lds
    v_pk_mul_f32 v[102:103], v[102:103], v[210:211]
    ds_read_b64_tr_b16 a[200:201], v38 offset:16384
    v_pk_mul_f32 v[104:105], v[104:105], v[216:217]
    ds_read_b64_tr_b16 a[202:203], v38 offset:18432
    v_pk_mul_f32 v[106:107], v[106:107], v[218:219]
    ds_read_b64_tr_b16 a[204:205], v39 offset:16384
    v_cvt_pk_bf16_f32 v204, v100, v101
    ds_read_b64_tr_b16 a[206:207], v39 offset:18432
    v_cvt_pk_bf16_f32 v205, v102, v103
    s_waitcnt vmcnt(19)
    v_cvt_pk_bf16_f32 v206, v104, v105
    s_add_u32 m0, s50, 35840
    v_cvt_pk_bf16_f32 v207, v106, v107
    buffer_load_dwordx4 v22, s[32:35], s55 offen lds
    s_mov_b32 s54, 0
    buffer_store_dwordx4 v[204:207], v44, s[40:43], s54 offen sc1
    v_pk_mul_f32 v[100:101], v[188:189], v[188:189]
    ds_read_b64_tr_b16 a[208:209], v40 offset:0
    v_pk_mul_f32 v[102:103], v[190:191], v[190:191]
    ds_read_b64_tr_b16 a[210:211], v40 offset:2048
    v_pk_mul_f32 v[104:105], v[196:197], v[196:197]
    s_mul_i32 s55, s13, 40
    s_add_u32 m0, s50, 16384
    v_pk_mul_f32 v[106:107], v[198:199], v[198:199]
    buffer_load_dwordx4 v19, s[32:35], s55 offen lds
    v_pk_fma_f32 v[100:101], v[100:101], s[62:63], s[62:63] op_sel:[0,0,1] op_sel_hi:[1,0,1]
    ds_read_b64_tr_b16 a[212:213], v41 offset:0
    v_pk_fma_f32 v[102:103], v[102:103], s[62:63], s[62:63] op_sel:[0,0,1] op_sel_hi:[1,0,1]
    ds_read_b64_tr_b16 a[214:215], v41 offset:2048
    v_pk_fma_f32 v[104:105], v[104:105], s[62:63], s[62:63] op_sel:[0,0,1] op_sel_hi:[1,0,1]
    ds_read_b64_tr_b16 a[216:217], v42 offset:0
    v_pk_fma_f32 v[106:107], v[106:107], s[62:63], s[62:63] op_sel:[0,0,1] op_sel_hi:[1,0,1]
    ds_read_b64_tr_b16 a[218:219], v42 offset:2048
    v_pk_mul_f32 v[100:101], v[100:101], v[188:189]
    ds_read_b64_tr_b16 a[220:221], v43 offset:0
    v_pk_mul_f32 v[102:103], v[102:103], v[190:191]
    s_add_u32 m0, s50, 17408
    v_pk_mul_f32 v[104:105], v[104:105], v[196:197]
    buffer_load_dwordx4 v20, s[32:35], s55 offen lds
    v_pk_mul_f32 v[106:107], v[106:107], v[198:199]
    ds_read_b64_tr_b16 a[222:223], v43 offset:2048
    v_exp_f32 v100, v100
    s_waitcnt vmcnt(19)
    v_exp_f32 v101, v101
    ds_read_b64_tr_b16 a[224:225], v36 offset:32768
    v_exp_f32 v102, v102
    s_add_u32 m0, s50, 18432
    v_exp_f32 v103, v103
    buffer_load_dwordx4 v21, s[32:35], s55 offen lds
    v_exp_f32 v104, v104
    ds_read_b64_tr_b16 a[226:227], v36 offset:34816
    v_exp_f32 v105, v105
    ds_read_b64_tr_b16 a[228:229], v37 offset:32768
    v_exp_f32 v106, v106
    ds_read_b64_tr_b16 a[230:231], v37 offset:34816
    v_exp_f32 v107, v107
    s_add_u32 m0, s50, 19456
    v_pk_add_f32 v[100:101], v[100:101], 1.0 op_sel_hi:[1,0]
    buffer_load_dwordx4 v22, s[32:35], s55 offen lds
    v_pk_add_f32 v[102:103], v[102:103], 1.0 op_sel_hi:[1,0]
    ds_read_b64_tr_b16 a[232:233], v38 offset:32768
    v_pk_add_f32 v[104:105], v[104:105], 1.0 op_sel_hi:[1,0]
    ds_read_b64_tr_b16 a[234:235], v38 offset:34816
    v_pk_add_f32 v[106:107], v[106:107], 1.0 op_sel_hi:[1,0]
    ds_read_b64_tr_b16 a[236:237], v39 offset:32768
    v_rcp_f32 v100, v100
    ds_read_b64_tr_b16 a[238:239], v39 offset:34816
    v_rcp_f32 v101, v101
    s_waitcnt vmcnt(17)
    v_rcp_f32 v102, v102
    ds_read_b64_tr_b16 a[240:241], v36 offset:49152
    v_rcp_f32 v103, v103
    ds_read_b64_tr_b16 a[242:243], v36 offset:51200
    v_rcp_f32 v104, v104
    ds_read_b64_tr_b16 a[244:245], v37 offset:49152
    v_rcp_f32 v105, v105
    ds_read_b64_tr_b16 a[246:247], v37 offset:51200
    v_rcp_f32 v106, v106
    ds_read_b64_tr_b16 a[248:249], v38 offset:49152
    v_rcp_f32 v107, v107
    ds_read_b64_tr_b16 a[250:251], v38 offset:51200
    v_pk_mul_f32 v[100:101], v[100:101], v[188:189]
    ds_read_b64_tr_b16 a[252:253], v39 offset:49152
    v_pk_mul_f32 v[102:103], v[102:103], v[190:191]
    ds_read_b64_tr_b16 a[254:255], v39 offset:51200
    v_pk_mul_f32 v[104:105], v[104:105], v[196:197]
    s_waitcnt vmcnt(13)
    v_pk_mul_f32 v[106:107], v[106:107], v[198:199]
    ds_read_b64_tr_b16 v[220:221], v40 offset:16384
    v_pk_mul_f32 v[100:101], v[100:101], v[192:193]
    ds_read_b64_tr_b16 v[222:223], v40 offset:18432
    v_pk_mul_f32 v[102:103], v[102:103], v[194:195]
    ds_read_b64_tr_b16 v[224:225], v41 offset:16384
    v_pk_mul_f32 v[104:105], v[104:105], v[200:201]
    ds_read_b64_tr_b16 v[226:227], v41 offset:18432
    v_pk_mul_f32 v[106:107], v[106:107], v[202:203]
    ds_read_b64_tr_b16 v[228:229], v42 offset:16384
    v_cvt_pk_bf16_f32 v188, v100, v101
    ds_read_b64_tr_b16 v[230:231], v42 offset:18432
    v_cvt_pk_bf16_f32 v189, v102, v103
    ds_read_b64_tr_b16 v[232:233], v43 offset:16384
    v_cvt_pk_bf16_f32 v190, v104, v105
    ds_read_b64_tr_b16 v[234:235], v43 offset:18432
    v_cvt_pk_bf16_f32 v191, v106, v107
    s_waitcnt vmcnt(9)
    s_mov_b32 s54, 2048
    buffer_store_dwordx4 v[188:191], v44, s[40:43], s54 offen sc1
    ds_read_b64_tr_b16 v[236:237], v32 offset:0
    ds_read_b64_tr_b16 v[238:239], v32 offset:2048
    ds_read_b64_tr_b16 v[240:241], v33 offset:0
    ds_read_b64_tr_b16 v[242:243], v33 offset:2048
    ds_read_b64_tr_b16 v[244:245], v34 offset:0
    ds_read_b64_tr_b16 v[246:247], v34 offset:2048
    ds_read_b64_tr_b16 v[248:249], v35 offset:0
    ds_read_b64_tr_b16 v[250:251], v35 offset:2048
    s_waitcnt vmcnt(6)
    ds_read_b64_tr_b16 a[144:145], v32 offset:32768
    ds_read_b64_tr_b16 a[146:147], v32 offset:34816
    ds_read_b64_tr_b16 a[148:149], v33 offset:32768
    ds_read_b64_tr_b16 a[150:151], v33 offset:34816
    ds_read_b64_tr_b16 a[152:153], v34 offset:32768
    ds_read_b64_tr_b16 a[154:155], v34 offset:34816
    ds_read_b64_tr_b16 a[156:157], v35 offset:32768
    ds_read_b64_tr_b16 a[158:159], v35 offset:34816
    s_waitcnt vmcnt(1)
    ds_read_b64_tr_b16 v[172:173], v32 offset:16384
    ds_read_b64_tr_b16 v[174:175], v32 offset:18432
    ds_read_b64_tr_b16 v[176:177], v33 offset:16384
    ds_read_b64_tr_b16 v[178:179], v33 offset:18432
    ds_read_b64_tr_b16 v[180:181], v34 offset:16384
    ds_read_b64_tr_b16 v[182:183], v34 offset:18432
    ds_read_b64_tr_b16 v[184:185], v35 offset:16384
    ds_read_b64_tr_b16 v[186:187], v35 offset:18432
    s_waitcnt lgkmcnt(0)
    s_waitcnt vmcnt(0)
    s_mov_b32 s57, 1
    s_atomic_umax s57, s[40:41], s69
    s_atomic_umax s57, s[40:41], s69 offset:128
    s_mul_i32 s55, s14, 40
    s_add_u32 m0, s50, 49152
    s_nop 0
    buffer_load_dwordx4 v19, s[32:35], s55 offen lds
    s_add_u32 m0, s50, 50176
    s_nop 0
    buffer_load_dwordx4 v20, s[32:35], s55 offen lds
    s_add_u32 m0, s50, 51200
    s_nop 0
    buffer_load_dwordx4 v21, s[32:35], s55 offen lds
    s_add_u32 m0, s50, 52224
    s_nop 0
    buffer_load_dwordx4 v22, s[32:35], s55 offen lds
    s_mul_i32 s55, s15, 40
    s_add_u32 m0, s50, 65536
    s_nop 0
    buffer_load_dwordx4 v19, s[32:35], s55 offen lds
    s_add_u32 m0, s50, 66560
    s_nop 0
    buffer_load_dwordx4 v20, s[32:35], s55 offen lds
    s_add_u32 m0, s50, 67584
    s_nop 0
    buffer_load_dwordx4 v21, s[32:35], s55 offen lds
    s_mov_b64 s[58:59], 0
    s_mov_b64 exec, 0xffffff
    buffer_load_dwordx4 v[4:7], v47, s[40:43], 0 offen sc1
    s_mov_b64 exec, -1
    s_add_u32 m0, s50, 68608
    s_nop 0
    buffer_load_dwordx4 v22, s[32:35], s55 offen lds
    s_mul_i32 s55, s16, 40
    s_add_u32 m0, s50, 81920
    s_nop 0
    buffer_load_dwordx4 v19, s[32:35], s55 offen lds
    s_add_u32 m0, s50, 82944
    s_nop 0
    buffer_load_dwordx4 v20, s[32:35], s55 offen lds
    s_waitcnt vmcnt(10)
    s_add_u32 m0, s50, 83968
    s_nop 0
    buffer_load_dwordx4 v21, s[32:35], s55 offen lds
    s_waitcnt vmcnt(10)
    s_add_u32 m0, s50, 84992
    s_nop 0
    buffer_load_dwordx4 v22, s[32:35], s55 offen lds
    s_waitcnt vmcnt(10)
    s_mul_i32 s55, s17, 40
    s_add_u32 m0, s50, 131072
    s_nop 0
    buffer_load_dwordx4 v19, s[32:35], s55 offen lds
    s_waitcnt vmcnt(10)
    ds_read_b64_tr_b16 v[156:157], v32 offset:49152
    ds_read_b64_tr_b16 v[158:159], v32 offset:51200
    ds_read_b64_tr_b16 v[160:161], v33 offset:49152
    s_add_u32 m0, s50, 132096
    s_nop 0
    buffer_load_dwordx4 v20, s[32:35], s55 offen lds
    s_waitcnt vmcnt(10)
    ds_read_b64_tr_b16 v[162:163], v33 offset:51200
    ds_read_b64_tr_b16 v[164:165], v34 offset:49152
    ds_read_b64_tr_b16 v[166:167], v34 offset:51200
    s_add_u32 m0, s50, 133120
    s_nop 0
    buffer_load_dwordx4 v21, s[32:35], s55 offen lds
    s_waitcnt vmcnt(10)
    ds_read_b64_tr_b16 v[168:169], v35 offset:49152
    ds_read_b64_tr_b16 v[170:171], v35 offset:51200
    s_add_u32 m0, s50, 134144
    s_nop 0
    buffer_load_dwordx4 v22, s[32:35], s55 offen lds
    s_waitcnt vmcnt(10)
    s_waitcnt vmcnt(9)
    v_min_u32 v4, v4, v5
    v_min3_u32 v4, v4, v6, v7
    v_cmp_gt_u32 vcc, v4, v48
    s_nop 0
    s_or_b64 s[58:59], s[58:59], vcc
    s_and_b32 s52, s58, 0xffffff
    s_cmp_eq_u32 s52, 0xffffff
    s_cbranch_scc0 L_nu_c1_0s
L_nu_c1_0:
    s_mul_i32 s56, s72, 55296
    v_add_u32 v46, s56, v45
    buffer_load_dwordx4 v[84:87], v46, s[40:43], s4 offen sc1
    buffer_load_dwordx4 v[88:91], v46, s[40:43], s5 offen sc1
    buffer_load_dwordx4 v[92:95], v46, s[40:43], s6 offen sc1
    buffer_load_dwordx4 v[96:99], v46, s[40:43], s7 offen sc1
    buffer_load_dwordx4 v[100:103], v46, s[40:43], s8 offen sc1
    buffer_load_dwordx4 v[104:107], v46, s[40:43], s9 offen sc1
    buffer_load_dwordx4 a[72:75], v46, s[40:43], s10 offen sc1
    buffer_load_dwordx4 a[76:79], v46, s[40:43], s11 offen sc1
    buffer_load_dwordx4 a[80:83], v46, s[40:43], s12 offen sc1
    buffer_load_dwordx4 a[84:87], v46, s[40:43], s13 offen sc1
    buffer_load_dwordx4 a[88:91], v46, s[40:43], s14 offen sc1
    buffer_load_dwordx4 a[92:95], v46, s[40:43], s15 offen sc1
    s_waitcnt vmcnt(9)
    v_mfma_f32_16x16x32_bf16 v[108:111], a[160:163], v[84:87], 0
    buffer_load_dwordx4 a[96:99], v46, s[40:43], s16 offen sc1
    v_mfma_f32_16x16x32_bf16 v[108:111], a[176:179], v[88:91], v[108:111]
    ds_read_b64_tr_b16 v[140:141], v36 offset:0
    ds_read_b64_tr_b16 v[142:143], v36 offset:2048
    v_mfma_f32_16x16x32_bf16 v[108:111], a[192:195], v[92:95], v[108:111]
    ds_read_b64_tr_b16 v[144:145], v37 offset:0
    ds_read_b64_tr_b16 v[146:147], v37 offset:2048
    v_mfma_f32_16x16x32_bf16 a[0:3], a[196:199], v[92:95], 0
    buffer_load_dwordx4 a[100:103], v46, s[40:43], s17 offen sc1
    v_mfma_f32_16x16x32_bf16 a[0:3], a[180:183], v[88:91], a[0:3]
    ds_read_b64_tr_b16 v[148:149], v38 offset:0
    ds_read_b64_tr_b16 v[150:151], v38 offset:2048
    v_mfma_f32_16x16x32_bf16 a[0:3], a[164:167], v[84:87], a[0:3]
    ds_read_b64_tr_b16 v[152:153], v39 offset:0
    ds_read_b64_tr_b16 v[154:155], v39 offset:2048
    v_mfma_f32_16x16x32_bf16 a[4:7], a[168:171], v[84:87], 0
    s_mul_i32 s56, s73, 55296
    v_add_u32 v46, s56, v45
    v_mfma_f32_16x16x32_bf16 a[4:7], a[184:187], v[88:91], a[4:7]
    ds_read_b64_tr_b16 v[204:205], v36 offset:16384
    ds_read_b64_tr_b16 v[206:207], v36 offset:18432
    v_mfma_f32_16x16x32_bf16 a[4:7], a[200:203], v[92:95], a[4:7]
    ds_read_b64_tr_b16 v[208:209], v37 offset:16384
    ds_read_b64_tr_b16 v[210:211], v37 offset:18432
    v_mfma_f32_16x16x32_bf16 a[8:11], a[204:207], v[92:95], 0
    buffer_load_dwordx4 a[104:107], v46, s[40:43], s4 offen sc1
    v_mfma_f32_16x16x32_bf16 a[8:11], a[188:191], v[88:91], a[8:11]
    ds_read_b64_tr_b16 v[212:213], v38 offset:16384
    ds_read_b64_tr_b16 v[214:215], v38 offset:18432
    v_mfma_f32_16x16x32_bf16 a[8:11], a[172:175], v[84:87], a[8:11]
    ds_read_b64_tr_b16 v[216:217], v39 offset:16384
    ds_read_b64_tr_b16 v[218:219], v39 offset:18432
    buffer_load_dwordx4 a[108:111], v46, s[40:43], s5 offen sc1
    s_waitcnt vmcnt(9)
    v_mfma_f32_16x16x32_bf16 v[108:111], a[208:211], v[96:99], v[108:111]
    buffer_load_dwordx4 a[112:115], v46, s[40:43], s6 offen sc1
    v_mfma_f32_16x16x32_bf16 v[108:111], a[224:227], v[100:103], v[108:111]
    ds_read_b64_tr_b16 v[188:189], v40 offset:0
    ds_read_b64_tr_b16 v[190:191], v40 offset:2048
    v_mfma_f32_16x16x32_bf16 v[108:111], a[240:243], v[104:107], v[108:111]
    ds_read_b64_tr_b16 v[192:193], v41 offset:0
    ds_read_b64_tr_b16 v[194:195], v41 offset:2048
    v_mfma_f32_16x16x32_bf16 v[108:111], v[220:223], a[72:75], v[108:111]
    buffer_load_dwordx4 a[116:119], v46, s[40:43], s7 offen sc1
    v_mfma_f32_16x16x32_bf16 a[0:3], v[224:227], a[72:75], a[0:3]
    ds_read_b64_tr_b16 v[196:197], v42 offset:0
    ds_read_b64_tr_b16 v[198:199], v42 offset:2048
    v_mfma_f32_16x16x32_bf16 a[0:3], a[244:247], v[104:107], a[0:3]
    ds_read_b64_tr_b16 v[200:201], v43 offset:0
    ds_read_b64_tr_b16 v[202:203], v43 offset:2048
    v_mfma_f32_16x16x32_bf16 a[0:3], a[228:231], v[100:103], a[0:3]
    buffer_load_dwordx4 a[120:123], v46, s[40:43], s8 offen sc1
    v_mfma_f32_16x16x32_bf16 a[0:3], a[212:215], v[96:99], a[0:3]
    v_mfma_f32_16x16x32_bf16 a[4:7], a[216:219], v[96:99], a[4:7]
    v_mfma_f32_16x16x32_bf16 a[4:7], a[232:235], v[100:103], a[4:7]
    v_mfma_f32_16x16x32_bf16 a[4:7], a[248:251], v[104:107], a[4:7]
    v_mfma_f32_16x16x32_bf16 a[4:7], v[228:231], a[72:75], a[4:7]
    v_mfma_f32_16x16x32_bf16 a[8:11], v[232:235], a[72:75], a[8:11]
    v_mfma_f32_16x16x32_bf16 a[8:11], a[252:255], v[104:107], a[8:11]
    v_mfma_f32_16x16x32_bf16 a[8:11], a[236:239], v[100:103], a[8:11]
    v_mfma_f32_16x16x32_bf16 a[8:11], a[220:223], v[96:99], a[8:11]
    s_waitcnt vmcnt(9)
    v_mfma_f32_16x16x32_bf16 v[108:111], v[236:239], a[76:79], v[108:111]
    buffer_load_dwordx4 a[124:127], v46, s[40:43], s9 offen sc1
    v_mfma_f32_16x16x32_bf16 v[108:111], a[144:147], a[80:83], v[108:111]
    v_mfma_f32_16x16x32_bf16 v[108:111], v[172:175], a[84:87], v[108:111]
    v_mfma_f32_16x16x32_bf16 a[0:3], v[176:179], a[84:87], a[0:3]
    buffer_load_dwordx4 a[128:131], v46, s[40:43], s10 offen sc1
    v_mfma_f32_16x16x32_bf16 a[0:3], a[148:151], a[80:83], a[0:3]
    v_mfma_f32_16x16x32_bf16 a[0:3], v[240:243], a[76:79], a[0:3]
    v_mfma_f32_16x16x32_bf16 a[4:7], v[244:247], a[76:79], a[4:7]
    buffer_load_dwordx4 a[132:135], v46, s[40:43], s11 offen sc1
    v_mfma_f32_16x16x32_bf16 a[4:7], a[152:155], a[80:83], a[4:7]
    v_mfma_f32_16x16x32_bf16 a[4:7], v[180:183], a[84:87], a[4:7]
    v_mfma_f32_16x16x32_bf16 a[8:11], v[184:187], a[84:87], a[8:11]
    buffer_load_dwordx4 a[136:139], v46, s[40:43], s12 offen sc1
    v_mfma_f32_16x16x32_bf16 a[8:11], a[156:159], a[80:83], a[8:11]
    v_mfma_f32_16x16x32_bf16 a[8:11], v[248:251], a[76:79], a[8:11]
    s_waitcnt vmcnt(9) lgkmcnt(0)
    v_mfma_f32_16x16x32_bf16 v[108:111], v[156:159], a[88:91], v[108:111]
    buffer_load_dwordx4 a[140:143], v46, s[40:43], s13 offen sc1
    v_mfma_f32_16x16x32_bf16 v[108:111], v[140:143], a[92:95], v[108:111]
    v_mfma_f32_16x16x32_bf16 v[108:111], v[204:207], a[96:99], v[108:111]
    v_mfma_f32_16x16x32_bf16 v[108:111], v[188:191], a[100:103], v[108:111]
    buffer_load_dwordx4 v[52:55], v46, s[40:43], s14 offen sc1
    v_mfma_f32_16x16x32_bf16 a[0:3], v[192:195], a[100:103], a[0:3]
    v_mfma_f32_16x16x32_bf16 a[0:3], v[208:211], a[96:99], a[0:3]
    v_mfma_f32_16x16x32_bf16 a[0:3], v[144:147], a[92:95], a[0:3]
    buffer_load_dwordx4 v[56:59], v46, s[40:43], s15 offen sc1
    v_mfma_f32_16x16x32_bf16 a[0:3], v[160:163], a[88:91], a[0:3]
    v_mfma_f32_16x16x32_bf16 a[4:7], v[164:167], a[88:91], a[4:7]
    v_mfma_f32_16x16x32_bf16 a[4:7], v[148:151], a[92:95], a[4:7]
    v_mfma_f32_16x16x32_bf16 a[4:7], v[212:215], a[96:99], a[4:7]
    v_mfma_f32_16x16x32_bf16 a[4:7], v[196:199], a[100:103], a[4:7]
    v_mfma_f32_16x16x32_bf16 a[8:11], v[200:203], a[100:103], a[8:11]
    v_mfma_f32_16x16x32_bf16 a[8:11], v[216:219], a[96:99], a[8:11]
    v_mfma_f32_16x16x32_bf16 a[8:11], v[152:155], a[92:95], a[8:11]
    v_mfma_f32_16x16x32_bf16 a[8:11], v[168:171], a[88:91], a[8:11]
    s_barrier
    v_xor_b32 v32, 0, v50
    v_xor_b32 v33, 64, v50
    v_xor_b32 v34, 128, v50
    v_xor_b32 v35, 192, v50
    v_add_u32 v36, 65536, v32
    v_add_u32 v37, 65536, v33
    v_add_u32 v38, 65536, v34
    v_add_u32 v39, 65536, v35
    v_xor_b32 v40, 16, v253
    v_add_u32 v41, 65536, v253
    v_add_u32 v42, 65536, v40
    s_waitcnt vmcnt(9)
    v_mfma_f32_16x16x32_bf16 v[112:115], a[160:163], a[104:107], 0
    buffer_load_dwordx4 v[60:63], v46, s[40:43], s16 offen sc1
    v_mfma_f32_16x16x32_bf16 v[112:115], a[176:179], a[108:111], v[112:115]
    s_mov_b32 s80, s78
    s_mul_i32 s55, s73, 20480
    v_mfma_f32_16x16x32_bf16 v[112:115], a[192:195], a[112:115], v[112:115]
    s_cmp_lt_u32 s48, 2
    s_cselect_b32 s80, s80, s55
    s_mul_i32 s81, s74, 20480
    v_mfma_f32_16x16x32_bf16 a[12:15], a[196:199], a[112:115], 0
    ds_write_b128 v32, v[108:111] offset:0
    v_mfma_f32_16x16x32_bf16 a[12:15], a[180:183], a[108:111], a[12:15]
    s_mul_i32 s55, s75, 20480
    s_cmp_lt_u32 s48, 2
    s_cselect_b32 s81, s81, s55
    v_mfma_f32_16x16x32_bf16 a[12:15], a[164:167], a[104:107], a[12:15]
    ds_write_b128 v33, a[0:3] offset:0
    v_mfma_f32_16x16x32_bf16 a[16:19], a[168:171], a[104:107], 0
    buffer_load_dwordx4 v[64:67], v46, s[40:43], s17 offen sc1
    v_mfma_f32_16x16x32_bf16 a[16:19], a[184:187], a[108:111], a[16:19]
    ds_write_b128 v34, a[4:7] offset:0
    v_mfma_f32_16x16x32_bf16 a[16:19], a[200:203], a[112:115], a[16:19]
    s_mul_i32 s82, s76, 20480
    s_mul_i32 s55, s77, 20480
    v_mfma_f32_16x16x32_bf16 a[20:23], a[204:207], a[112:115], 0
    ds_write_b128 v35, a[8:11] offset:0
    v_mfma_f32_16x16x32_bf16 a[20:23], a[188:191], a[108:111], a[20:23]
    s_cmp_lt_u32 s48, 2
    s_cselect_b32 s82, s82, s55
    v_mfma_f32_16x16x32_bf16 a[20:23], a[172:175], a[104:107], a[20:23]
    s_mul_i32 s56, s74, 55296
    v_add_u32 v46, s56, v45
    buffer_load_dwordx4 v[68:71], v46, s[40:43], s4 offen sc1
    buffer_load_dwordx4 v[72:75], v46, s[40:43], s5 offen sc1
    s_waitcnt vmcnt(9)
    v_mfma_f32_16x16x32_bf16 v[112:115], a[208:211], a[116:119], v[112:115]
    buffer_load_dwordx4 v[76:79], v46, s[40:43], s6 offen sc1
    v_mfma_f32_16x16x32_bf16 v[112:115], a[224:227], a[120:123], v[112:115]
    v_mfma_f32_16x16x32_bf16 v[112:115], a[240:243], a[124:127], v[112:115]
    v_mfma_f32_16x16x32_bf16 v[112:115], v[220:223], a[128:131], v[112:115]
    buffer_load_dwordx4 v[80:83], v46, s[40:43], s7 offen sc1
    v_mfma_f32_16x16x32_bf16 a[12:15], v[224:227], a[128:131], a[12:15]
    v_mfma_f32_16x16x32_bf16 a[12:15], a[244:247], a[124:127], a[12:15]
    v_mfma_f32_16x16x32_bf16 a[12:15], a[228:231], a[120:123], a[12:15]
    buffer_load_dwordx4 v[84:87], v46, s[40:43], s8 offen sc1
    v_mfma_f32_16x16x32_bf16 a[12:15], a[212:215], a[116:119], a[12:15]
    v_mfma_f32_16x16x32_bf16 a[16:19], a[216:219], a[116:119], a[16:19]
    v_mfma_f32_16x16x32_bf16 a[16:19], a[232:235], a[120:123], a[16:19]
    v_mfma_f32_16x16x32_bf16 a[16:19], a[248:251], a[124:127], a[16:19]
    v_mfma_f32_16x16x32_bf16 a[16:19], v[228:231], a[128:131], a[16:19]
    v_mfma_f32_16x16x32_bf16 a[20:23], v[232:235], a[128:131], a[20:23]
    v_mfma_f32_16x16x32_bf16 a[20:23], a[252:255], a[124:127], a[20:23]
    v_mfma_f32_16x16x32_bf16 a[20:23], a[236:239], a[120:123], a[20:23]
    v_mfma_f32_16x16x32_bf16 a[20:23], a[220:223], a[116:119], a[20:23]
    s_waitcnt vmcnt(9)
    v_mfma_f32_16x16x32_bf16 v[112:115], v[236:239], a[132:135], v[112:115]
    buffer_load_dwordx4 v[88:91], v46, s[40:43], s9 offen sc1
    v_mfma_f32_16x16x32_bf16 v[112:115], a[144:147], a[136:139], v[112:115]
    v_mfma_f32_16x16x32_bf16 v[112:115], v[172:175], a[140:143], v[112:115]
    v_mfma_f32_16x16x32_bf16 a[12:15], v[176:179], a[140:143], a[12:15]
    buffer_load_dwordx4 v[92:95], v46, s[40:43], s10 offen sc1
    v_mfma_f32_16x16x32_bf16 a[12:15], a[148:151], a[136:139], a[12:15]
    v_mfma_f32_16x16x32_bf16 a[12:15], v[240:243], a[132:135], a[12:15]
    v_mfma_f32_16x16x32_bf16 a[16:19], v[244:247], a[132:135], a[16:19]
    buffer_load_dwordx4 v[96:99], v46, s[40:43], s11 offen sc1
    v_mfma_f32_16x16x32_bf16 a[16:19], a[152:155], a[136:139], a[16:19]
    v_mfma_f32_16x16x32_bf16 a[16:19], v[180:183], a[140:143], a[16:19]
    v_mfma_f32_16x16x32_bf16 a[20:23], v[184:187], a[140:143], a[20:23]
    buffer_load_dwordx4 v[100:103], v46, s[40:43], s12 offen sc1
    v_mfma_f32_16x16x32_bf16 a[20:23], a[156:159], a[136:139], a[20:23]
    v_mfma_f32_16x16x32_bf16 a[20:23], v[248:251], a[132:135], a[20:23]
    s_waitcnt vmcnt(9)
    v_mfma_f32_16x16x32_bf16 v[112:115], v[156:159], v[52:55], v[112:115]
    buffer_load_dwordx4 v[104:107], v46, s[40:43], s13 offen sc1
    v_mfma_f32_16x16x32_bf16 v[112:115], v[140:143], v[56:59], v[112:115]
    v_mfma_f32_16x16x32_bf16 v[112:115], v[204:207], v[60:63], v[112:115]
    v_mfma_f32_16x16x32_bf16 v[112:115], v[188:191], v[64:67], v[112:115]
    buffer_load_dwordx4 a[72:75], v46, s[40:43], s14 offen sc1
    v_mfma_f32_16x16x32_bf16 a[12:15], v[192:195], v[64:67], a[12:15]
    v_mfma_f32_16x16x32_bf16 a[12:15], v[208:211], v[60:63], a[12:15]
    v_mfma_f32_16x16x32_bf16 a[12:15], v[144:147], v[56:59], a[12:15]
    buffer_load_dwordx4 a[76:79], v46, s[40:43], s15 offen sc1
    v_mfma_f32_16x16x32_bf16 a[12:15], v[160:163], v[52:55], a[12:15]
    v_mfma_f32_16x16x32_bf16 a[16:19], v[164:167], v[52:55], a[16:19]
    v_mfma_f32_16x16x32_bf16 a[16:19], v[148:151], v[56:59], a[16:19]
    v_mfma_f32_16x16x32_bf16 a[16:19], v[212:215], v[60:63], a[16:19]
    v_mfma_f32_16x16x32_bf16 a[16:19], v[196:199], v[64:67], a[16:19]
    v_mfma_f32_16x16x32_bf16 a[20:23], v[200:203], v[64:67], a[20:23]
    v_mfma_f32_16x16x32_bf16 a[20:23], v[216:219], v[60:63], a[20:23]
    v_mfma_f32_16x16x32_bf16 a[20:23], v[152:155], v[56:59], a[20:23]
    v_mfma_f32_16x16x32_bf16 a[20:23], v[168:171], v[52:55], a[20:23]
    s_waitcnt vmcnt(9)
    v_mfma_f32_16x16x32_bf16 v[116:119], a[160:163], v[68:71], 0
    buffer_load_dwordx4 a[80:83], v46, s[40:43], s16 offen sc1
    v_mfma_f32_16x16x32_bf16 v[116:119], a[176:179], v[72:75], v[116:119]
    v_mfma_f32_16x16x32_bf16 v[116:119], a[192:195], v[76:79], v[116:119]
    v_mfma_f32_16x16x32_bf16 a[24:27], a[196:199], v[76:79], 0
    ds_write_b128 v32, v[112:115] offset:16384
    v_mfma_f32_16x16x32_bf16 a[24:27], a[180:183], v[72:75], a[24:27]
    v_mfma_f32_16x16x32_bf16 a[24:27], a[164:167], v[68:71], a[24:27]
    ds_write_b128 v33, a[12:15] offset:16384
    v_mfma_f32_16x16x32_bf16 a[28:31], a[168:171], v[68:71], 0
    buffer_load_dwordx4 a[84:87], v46, s[40:43], s17 offen sc1
    v_mfma_f32_16x16x32_bf16 a[28:31], a[184:187], v[72:75], a[28:31]
    ds_write_b128 v34, a[16:19] offset:16384
    v_mfma_f32_16x16x32_bf16 a[28:31], a[200:203], v[76:79], a[28:31]
    v_mfma_f32_16x16x32_bf16 a[32:35], a[204:207], v[76:79], 0
    ds_write_b128 v35, a[20:23] offset:16384
    v_mfma_f32_16x16x32_bf16 a[32:35], a[188:191], v[72:75], a[32:35]
    v_mfma_f32_16x16x32_bf16 a[32:35], a[172:175], v[68:71], a[32:35]
    s_mul_i32 s56, s75, 55296
    v_add_u32 v46, s56, v45
    buffer_load_dwordx4 a[88:91], v46, s[40:43], s4 offen sc1
    buffer_load_dwordx4 a[92:95], v46, s[40:43], s5 offen sc1
    s_waitcnt vmcnt(9)
    v_mfma_f32_16x16x32_bf16 v[116:119], a[208:211], v[80:83], v[116:119]
    buffer_load_dwordx4 a[96:99], v46, s[40:43], s6 offen sc1
    v_mfma_f32_16x16x32_bf16 v[116:119], a[224:227], v[84:87], v[116:119]
    v_mfma_f32_16x16x32_bf16 v[116:119], a[240:243], v[88:91], v[116:119]
    v_mfma_f32_16x16x32_bf16 v[116:119], v[220:223], v[92:95], v[116:119]
    buffer_load_dwordx4 a[100:103], v46, s[40:43], s7 offen sc1
    v_mfma_f32_16x16x32_bf16 a[24:27], v[224:227], v[92:95], a[24:27]
    v_mfma_f32_16x16x32_bf16 a[24:27], a[244:247], v[88:91], a[24:27]
    v_mfma_f32_16x16x32_bf16 a[24:27], a[228:231], v[84:87], a[24:27]
    buffer_load_dwordx4 a[104:107], v46, s[40:43], s8 offen sc1
    v_mfma_f32_16x16x32_bf16 a[24:27], a[212:215], v[80:83], a[24:27]
    v_mfma_f32_16x16x32_bf16 a[28:31], a[216:219], v[80:83], a[28:31]
    v_mfma_f32_16x16x32_bf16 a[28:31], a[232:235], v[84:87], a[28:31]
    v_mfma_f32_16x16x32_bf16 a[28:31], a[248:251], v[88:91], a[28:31]
    v_mfma_f32_16x16x32_bf16 a[28:31], v[228:231], v[92:95], a[28:31]
    v_mfma_f32_16x16x32_bf16 a[32:35], v[232:235], v[92:95], a[32:35]
    v_mfma_f32_16x16x32_bf16 a[32:35], a[252:255], v[88:91], a[32:35]
    v_mfma_f32_16x16x32_bf16 a[32:35], a[236:239], v[84:87], a[32:35]
    v_mfma_f32_16x16x32_bf16 a[32:35], a[220:223], v[80:83], a[32:35]
    s_waitcnt vmcnt(9)
    v_mfma_f32_16x16x32_bf16 v[116:119], v[236:239], v[96:99], v[116:119]
    buffer_load_dwordx4 a[108:111], v46, s[40:43], s9 offen sc1
    v_mfma_f32_16x16x32_bf16 v[116:119], a[144:147], v[100:103], v[116:119]
    v_mfma_f32_16x16x32_bf16 v[116:119], v[172:175], v[104:107], v[116:119]
    v_mfma_f32_16x16x32_bf16 a[24:27], v[176:179], v[104:107], a[24:27]
    buffer_load_dwordx4 a[112:115], v46, s[40:43], s10 offen sc1
    v_mfma_f32_16x16x32_bf16 a[24:27], a[148:151], v[100:103], a[24:27]
    v_mfma_f32_16x16x32_bf16 a[24:27], v[240:243], v[96:99], a[24:27]
    v_mfma_f32_16x16x32_bf16 a[28:31], v[244:247], v[96:99], a[28:31]
    buffer_load_dwordx4 a[116:119], v46, s[40:43], s11 offen sc1
    v_mfma_f32_16x16x32_bf16 a[28:31], a[152:155], v[100:103], a[28:31]
    v_mfma_f32_16x16x32_bf16 a[28:31], v[180:183], v[104:107], a[28:31]
    v_mfma_f32_16x16x32_bf16 a[32:35], v[184:187], v[104:107], a[32:35]
    buffer_load_dwordx4 a[120:123], v46, s[40:43], s12 offen sc1
    v_mfma_f32_16x16x32_bf16 a[32:35], a[156:159], v[100:103], a[32:35]
    v_mfma_f32_16x16x32_bf16 a[32:35], v[248:251], v[96:99], a[32:35]
    s_waitcnt vmcnt(9)
    v_mfma_f32_16x16x32_bf16 v[116:119], v[156:159], a[72:75], v[116:119]
    buffer_load_dwordx4 a[124:127], v46, s[40:43], s13 offen sc1
    v_mfma_f32_16x16x32_bf16 v[116:119], v[140:143], a[76:79], v[116:119]
    v_mfma_f32_16x16x32_bf16 v[116:119], v[204:207], a[80:83], v[116:119]
    v_mfma_f32_16x16x32_bf16 v[116:119], v[188:191], a[84:87], v[116:119]
    buffer_load_dwordx4 a[128:131], v46, s[40:43], s14 offen sc1
    v_mfma_f32_16x16x32_bf16 a[24:27], v[192:195], a[84:87], a[24:27]
    v_mfma_f32_16x16x32_bf16 a[24:27], v[208:211], a[80:83], a[24:27]
    v_mfma_f32_16x16x32_bf16 a[24:27], v[144:147], a[76:79], a[24:27]
    buffer_load_dwordx4 a[132:135], v46, s[40:43], s15 offen sc1
    v_mfma_f32_16x16x32_bf16 a[24:27], v[160:163], a[72:75], a[24:27]
    v_mfma_f32_16x16x32_bf16 a[28:31], v[164:167], a[72:75], a[28:31]
    v_mfma_f32_16x16x32_bf16 a[28:31], v[148:151], a[76:79], a[28:31]
    v_mfma_f32_16x16x32_bf16 a[28:31], v[212:215], a[80:83], a[28:31]
    v_mfma_f32_16x16x32_bf16 a[28:31], v[196:199], a[84:87], a[28:31]
    v_mfma_f32_16x16x32_bf16 a[32:35], v[200:203], a[84:87], a[32:35]
    v_mfma_f32_16x16x32_bf16 a[32:35], v[216:219], a[80:83], a[32:35]
    v_mfma_f32_16x16x32_bf16 a[32:35], v[152:155], a[76:79], a[32:35]
    v_mfma_f32_16x16x32_bf16 a[32:35], v[168:171], a[72:75], a[32:35]
    s_waitcnt vmcnt(9)
    v_mfma_f32_16x16x32_bf16 v[120:123], a[160:163], a[88:91], 0
    buffer_load_dwordx4 a[136:139], v46, s[40:43], s16 offen sc1
    v_mfma_f32_16x16x32_bf16 v[120:123], a[176:179], a[92:95], v[120:123]
    v_mfma_f32_16x16x32_bf16 v[120:123], a[192:195], a[96:99], v[120:123]
    v_mfma_f32_16x16x32_bf16 a[36:39], a[196:199], a[96:99], 0
    ds_write_b128 v32, v[116:119] offset:32768
    v_mfma_f32_16x16x32_bf16 a[36:39], a[180:183], a[92:95], a[36:39]
    v_mfma_f32_16x16x32_bf16 a[36:39], a[164:167], a[88:91], a[36:39]
    ds_write_b128 v33, a[24:27] offset:32768
    v_mfma_f32_16x16x32_bf16 a[40:43], a[168:171], a[88:91], 0
    buffer_load_dwordx4 a[140:143], v46, s[40:43], s17 offen sc1
    v_mfma_f32_16x16x32_bf16 a[40:43], a[184:187], a[92:95], a[40:43]
    ds_write_b128 v34, a[28:31] offset:32768
    v_mfma_f32_16x16x32_bf16 a[40:43], a[200:203], a[96:99], a[40:43]
    v_mfma_f32_16x16x32_bf16 a[44:47], a[204:207], a[96:99], 0
    ds_write_b128 v35, a[32:35] offset:32768
    v_mfma_f32_16x16x32_bf16 a[44:47], a[188:191], a[92:95], a[44:47]
    v_mfma_f32_16x16x32_bf16 a[44:47], a[172:175], a[88:91], a[44:47]
    s_mul_i32 s56, s76, 55296
    v_add_u32 v46, s56, v45
    buffer_load_dwordx4 v[52:55], v46, s[40:43], s4 offen sc1
    buffer_load_dwordx4 v[56:59], v46, s[40:43], s5 offen sc1
    s_waitcnt vmcnt(9)
    v_mfma_f32_16x16x32_bf16 v[120:123], a[208:211], a[100:103], v[120:123]
    buffer_load_dwordx4 v[60:63], v46, s[40:43], s6 offen sc1
    v_mfma_f32_16x16x32_bf16 v[120:123], a[224:227], a[104:107], v[120:123]
    v_mfma_f32_16x16x32_bf16 v[120:123], a[240:243], a[108:111], v[120:123]
    v_mfma_f32_16x16x32_bf16 v[120:123], v[220:223], a[112:115], v[120:123]
    buffer_load_dwordx4 v[64:67], v46, s[40:43], s7 offen sc1
    v_mfma_f32_16x16x32_bf16 a[36:39], v[224:227], a[112:115], a[36:39]
    v_mfma_f32_16x16x32_bf16 a[36:39], a[244:247], a[108:111], a[36:39]
    v_mfma_f32_16x16x32_bf16 a[36:39], a[228:231], a[104:107], a[36:39]
    buffer_load_dwordx4 v[68:71], v46, s[40:43], s8 offen sc1
    v_mfma_f32_16x16x32_bf16 a[36:39], a[212:215], a[100:103], a[36:39]
    v_mfma_f32_16x16x32_bf16 a[40:43], a[216:219], a[100:103], a[40:43]
    v_mfma_f32_16x16x32_bf16 a[40:43], a[232:235], a[104:107], a[40:43]
    v_mfma_f32_16x16x32_bf16 a[40:43], a[248:251], a[108:111], a[40:43]
    v_mfma_f32_16x16x32_bf16 a[40:43], v[228:231], a[112:115], a[40:43]
    v_mfma_f32_16x16x32_bf16 a[44:47], v[232:235], a[112:115], a[44:47]
    v_mfma_f32_16x16x32_bf16 a[44:47], a[252:255], a[108:111], a[44:47]
    v_mfma_f32_16x16x32_bf16 a[44:47], a[236:239], a[104:107], a[44:47]
    v_mfma_f32_16x16x32_bf16 a[44:47], a[220:223], a[100:103], a[44:47]
    s_waitcnt vmcnt(9)
    v_mfma_f32_16x16x32_bf16 v[120:123], v[236:239], a[116:119], v[120:123]
    buffer_load_dwordx4 v[72:75], v46, s[40:43], s9 offen sc1
    v_mfma_f32_16x16x32_bf16 v[120:123], a[144:147], a[120:123], v[120:123]
    v_mfma_f32_16x16x32_bf16 v[120:123], v[172:175], a[124:127], v[120:123]
    v_mfma_f32_16x16x32_bf16 a[36:39], v[176:179], a[124:127], a[36:39]
    buffer_load_dwordx4 v[76:79], v46, s[40:43], s10 offen sc1
    v_mfma_f32_16x16x32_bf16 a[36:39], a[148:151], a[120:123], a[36:39]
    v_mfma_f32_16x16x32_bf16 a[36:39], v[240:243], a[116:119], a[36:39]
    v_mfma_f32_16x16x32_bf16 a[40:43], v[244:247], a[116:119], a[40:43]
    buffer_load_dwordx4 v[80:83], v46, s[40:43], s11 offen sc1
    v_mfma_f32_16x16x32_bf16 a[40:43], a[152:155], a[120:123], a[40:43]
    v_mfma_f32_16x16x32_bf16 a[40:43], v[180:183], a[124:127], a[40:43]
    v_mfma_f32_16x16x32_bf16 a[44:47], v[184:187], a[124:127], a[44:47]
    buffer_load_dwordx4 v[84:87], v46, s[40:43], s12 offen sc1
    v_mfma_f32_16x16x32_bf16 a[44:47], a[156:159], a[120:123], a[44:47]
    v_mfma_f32_16x16x32_bf16 a[44:47], v[248:251], a[116:119], a[44:47]
    s_waitcnt vmcnt(9)
    v_mfma_f32_16x16x32_bf16 v[120:123], v[156:159], a[128:131], v[120:123]
    buffer_load_dwordx4 v[88:91], v46, s[40:43], s13 offen sc1
    v_mfma_f32_16x16x32_bf16 v[120:123], v[140:143], a[132:135], v[120:123]
    v_mfma_f32_16x16x32_bf16 v[120:123], v[204:207], a[136:139], v[120:123]
    v_mfma_f32_16x16x32_bf16 v[120:123], v[188:191], a[140:143], v[120:123]
    buffer_load_dwordx4 v[92:95], v46, s[40:43], s14 offen sc1
    v_mfma_f32_16x16x32_bf16 a[36:39], v[192:195], a[140:143], a[36:39]
    v_mfma_f32_16x16x32_bf16 a[36:39], v[208:211], a[136:139], a[36:39]
    v_mfma_f32_16x16x32_bf16 a[36:39], v[144:147], a[132:135], a[36:39]
    buffer_load_dwordx4 v[96:99], v46, s[40:43], s15 offen sc1
    v_mfma_f32_16x16x32_bf16 a[36:39], v[160:163], a[128:131], a[36:39]
    v_mfma_f32_16x16x32_bf16 a[40:43], v[164:167], a[128:131], a[40:43]
    v_mfma_f32_16x16x32_bf16 a[40:43], v[148:151], a[132:135], a[40:43]
    v_mfma_f32_16x16x32_bf16 a[40:43], v[212:215], a[136:139], a[40:43]
    v_mfma_f32_16x16x32_bf16 a[40:43], v[196:199], a[140:143], a[40:43]
    v_mfma_f32_16x16x32_bf16 a[44:47], v[200:203], a[140:143], a[44:47]
    v_mfma_f32_16x16x32_bf16 a[44:47], v[216:219], a[136:139], a[44:47]
    v_mfma_f32_16x16x32_bf16 a[44:47], v[152:155], a[132:135], a[44:47]
    v_mfma_f32_16x16x32_bf16 a[44:47], v[168:171], a[128:131], a[44:47]
    s_waitcnt vmcnt(9)
    v_mfma_f32_16x16x32_bf16 v[124:127], a[160:163], v[52:55], 0
    buffer_load_dwordx4 v[100:103], v46, s[40:43], s16 offen sc1
    v_mfma_f32_16x16x32_bf16 v[124:127], a[176:179], v[56:59], v[124:127]
    v_mfma_f32_16x16x32_bf16 v[124:127], a[192:195], v[60:63], v[124:127]
    v_mfma_f32_16x16x32_bf16 a[48:51], a[196:199], v[60:63], 0
    ds_write_b128 v32, v[120:123] offset:49152
    v_mfma_f32_16x16x32_bf16 a[48:51], a[180:183], v[56:59], a[48:51]
    v_mfma_f32_16x16x32_bf16 a[48:51], a[164:167], v[52:55], a[48:51]
    ds_write_b128 v33, a[36:39] offset:49152
    v_mfma_f32_16x16x32_bf16 a[52:55], a[168:171], v[52:55], 0
    buffer_load_dwordx4 v[104:107], v46, s[40:43], s17 offen sc1
    v_mfma_f32_16x16x32_bf16 a[52:55], a[184:187], v[56:59], a[52:55]
    ds_write_b128 v34, a[40:43] offset:49152
    v_mfma_f32_16x16x32_bf16 a[52:55], a[200:203], v[60:63], a[52:55]
    v_mfma_f32_16x16x32_bf16 a[56:59], a[204:207], v[60:63], 0
    ds_write_b128 v35, a[44:47] offset:49152
    v_mfma_f32_16x16x32_bf16 a[56:59], a[188:191], v[56:59], a[56:59]
    v_mfma_f32_16x16x32_bf16 a[56:59], a[172:175], v[52:55], a[56:59]
    s_mul_i32 s56, s77, 55296
    v_add_u32 v46, s56, v45
    buffer_load_dwordx4 a[72:75], v46, s[40:43], s4 offen sc1
    buffer_load_dwordx4 a[76:79], v46, s[40:43], s5 offen sc1
    s_waitcnt vmcnt(9)
    v_mfma_f32_16x16x32_bf16 v[124:127], a[208:211], v[64:67], v[124:127]
    buffer_load_dwordx4 a[80:83], v46, s[40:43], s6 offen sc1
    v_mfma_f32_16x16x32_bf16 v[124:127], a[224:227], v[68:71], v[124:127]
    v_mfma_f32_16x16x32_bf16 v[124:127], a[240:243], v[72:75], v[124:127]
    v_mfma_f32_16x16x32_bf16 v[124:127], v[220:223], v[76:79], v[124:127]
    buffer_load_dwordx4 a[84:87], v46, s[40:43], s7 offen sc1
    v_mfma_f32_16x16x32_bf16 a[48:51], v[224:227], v[76:79], a[48:51]
    v_mfma_f32_16x16x32_bf16 a[48:51], a[244:247], v[72:75], a[48:51]
    v_mfma_f32_16x16x32_bf16 a[48:51], a[228:231], v[68:71], a[48:51]
    buffer_load_dwordx4 a[88:91], v46, s[40:43], s8 offen sc1
    v_mfma_f32_16x16x32_bf16 a[48:51], a[212:215], v[64:67], a[48:51]
    v_mfma_f32_16x16x32_bf16 a[52:55], a[216:219], v[64:67], a[52:55]
    v_mfma_f32_16x16x32_bf16 a[52:55], a[232:235], v[68:71], a[52:55]
    v_mfma_f32_16x16x32_bf16 a[52:55], a[248:251], v[72:75], a[52:55]
    v_mfma_f32_16x16x32_bf16 a[52:55], v[228:231], v[76:79], a[52:55]
    v_mfma_f32_16x16x32_bf16 a[56:59], v[232:235], v[76:79], a[56:59]
    v_mfma_f32_16x16x32_bf16 a[56:59], a[252:255], v[72:75], a[56:59]
    v_mfma_f32_16x16x32_bf16 a[56:59], a[236:239], v[68:71], a[56:59]
    v_mfma_f32_16x16x32_bf16 a[56:59], a[220:223], v[64:67], a[56:59]
    s_waitcnt vmcnt(9)
    v_mfma_f32_16x16x32_bf16 v[124:127], v[236:239], v[80:83], v[124:127]
    buffer_load_dwordx4 a[92:95], v46, s[40:43], s9 offen sc1
    v_mfma_f32_16x16x32_bf16 v[124:127], a[144:147], v[84:87], v[124:127]
    v_mfma_f32_16x16x32_bf16 v[124:127], v[172:175], v[88:91], v[124:127]
    v_mfma_f32_16x16x32_bf16 a[48:51], v[176:179], v[88:91], a[48:51]
    buffer_load_dwordx4 a[96:99], v46, s[40:43], s10 offen sc1
    v_mfma_f32_16x16x32_bf16 a[48:51], a[148:151], v[84:87], a[48:51]
    v_mfma_f32_16x16x32_bf16 a[48:51], v[240:243], v[80:83], a[48:51]
    v_mfma_f32_16x16x32_bf16 a[52:55], v[244:247], v[80:83], a[52:55]
    buffer_load_dwordx4 a[100:103], v46, s[40:43], s11 offen sc1
    v_mfma_f32_16x16x32_bf16 a[52:55], a[152:155], v[84:87], a[52:55]
    v_mfma_f32_16x16x32_bf16 a[52:55], v[180:183], v[88:91], a[52:55]
    v_mfma_f32_16x16x32_bf16 a[56:59], v[184:187], v[88:91], a[56:59]
    buffer_load_dwordx4 a[104:107], v46, s[40:43], s12 offen sc1
    v_mfma_f32_16x16x32_bf16 a[56:59], a[156:159], v[84:87], a[56:59]
    v_mfma_f32_16x16x32_bf16 a[56:59], v[248:251], v[80:83], a[56:59]
    s_waitcnt vmcnt(9)
    v_mfma_f32_16x16x32_bf16 v[124:127], v[156:159], v[92:95], v[124:127]
    buffer_load_dwordx4 a[108:111], v46, s[40:43], s13 offen sc1
    v_mfma_f32_16x16x32_bf16 v[124:127], v[140:143], v[96:99], v[124:127]
    v_mfma_f32_16x16x32_bf16 v[124:127], v[204:207], v[100:103], v[124:127]
    v_mfma_f32_16x16x32_bf16 v[124:127], v[188:191], v[104:107], v[124:127]
    buffer_load_dwordx4 a[112:115], v46, s[40:43], s14 offen sc1
    v_mfma_f32_16x16x32_bf16 a[48:51], v[192:195], v[104:107], a[48:51]
    v_mfma_f32_16x16x32_bf16 a[48:51], v[208:211], v[100:103], a[48:51]
    v_mfma_f32_16x16x32_bf16 a[48:51], v[144:147], v[96:99], a[48:51]
    buffer_load_dwordx4 a[116:119], v46, s[40:43], s15 offen sc1
    v_mfma_f32_16x16x32_bf16 a[48:51], v[160:163], v[92:95], a[48:51]
    v_mfma_f32_16x16x32_bf16 a[52:55], v[164:167], v[92:95], a[52:55]
    v_mfma_f32_16x16x32_bf16 a[52:55], v[148:151], v[96:99], a[52:55]
    buffer_load_dwordx4 a[120:123], v46, s[40:43], s16 offen sc1
    v_mfma_f32_16x16x32_bf16 a[52:55], v[212:215], v[100:103], a[52:55]
    v_mfma_f32_16x16x32_bf16 a[52:55], v[196:199], v[104:107], a[52:55]
    v_mfma_f32_16x16x32_bf16 a[56:59], v[200:203], v[104:107], a[56:59]
    v_mfma_f32_16x16x32_bf16 a[56:59], v[216:219], v[100:103], a[56:59]
    v_mfma_f32_16x16x32_bf16 a[56:59], v[152:155], v[96:99], a[56:59]
    v_mfma_f32_16x16x32_bf16 a[56:59], v[168:171], v[92:95], a[56:59]
    s_waitcnt vmcnt(9)
    v_mfma_f32_16x16x32_bf16 v[128:131], a[160:163], a[72:75], 0
    buffer_load_dwordx4 a[124:127], v46, s[40:43], s17 offen sc1
    v_mfma_f32_16x16x32_bf16 v[128:131], a[176:179], a[76:79], v[128:131]
    v_mfma_f32_16x16x32_bf16 v[128:131], a[192:195], a[80:83], v[128:131]
    v_mfma_f32_16x16x32_bf16 v[128:131], a[208:211], a[84:87], v[128:131]
    ds_write_b128 v36, v[124:127] offset:0
    v_mfma_f32_16x16x32_bf16 a[60:63], a[212:215], a[84:87], 0
    v_mfma_f32_16x16x32_bf16 a[60:63], a[196:199], a[80:83], a[60:63]
    ds_write_b128 v37, a[48:51] offset:0
    v_mfma_f32_16x16x32_bf16 a[60:63], a[180:183], a[76:79], a[60:63]
    v_mfma_f32_16x16x32_bf16 a[60:63], a[164:167], a[72:75], a[60:63]
    ds_write_b128 v38, a[52:55] offset:0
    v_mfma_f32_16x16x32_bf16 a[64:67], a[168:171], a[72:75], 0
    v_mfma_f32_16x16x32_bf16 a[64:67], a[184:187], a[76:79], a[64:67]
    ds_write_b128 v39, a[56:59] offset:0
    v_mfma_f32_16x16x32_bf16 a[64:67], a[200:203], a[80:83], a[64:67]
    v_mfma_f32_16x16x32_bf16 a[64:67], a[216:219], a[84:87], a[64:67]
    v_mfma_f32_16x16x32_bf16 a[68:71], a[220:223], a[84:87], 0
    v_mfma_f32_16x16x32_bf16 a[68:71], a[204:207], a[80:83], a[68:71]
    v_mfma_f32_16x16x32_bf16 a[68:71], a[188:191], a[76:79], a[68:71]
    v_mfma_f32_16x16x32_bf16 a[68:71], a[172:175], a[72:75], a[68:71]
    s_waitcnt lgkmcnt(0)
    s_barrier
    s_waitcnt vmcnt(6)
    v_mfma_f32_16x16x32_bf16 v[128:131], a[224:227], a[88:91], v[128:131]
    ds_read_b128 v[52:55], v253 offset:0
    v_mfma_f32_16x16x32_bf16 v[128:131], a[240:243], a[92:95], v[128:131]
    ds_read_b128 v[56:59], v40 offset:0
    v_mfma_f32_16x16x32_bf16 v[128:131], v[220:223], a[96:99], v[128:131]
    ds_read_b128 v[60:63], v253 offset:4096
    v_mfma_f32_16x16x32_bf16 v[128:131], v[236:239], a[100:103], v[128:131]
    ds_read_b128 v[64:67], v40 offset:4096
    v_mfma_f32_16x16x32_bf16 a[60:63], v[240:243], a[100:103], a[60:63]
    ds_read_b128 v[68:71], v253 offset:8192
    v_mfma_f32_16x16x32_bf16 a[60:63], v[224:227], a[96:99], a[60:63]
    ds_read_b128 v[72:75], v40 offset:8192
    v_mfma_f32_16x16x32_bf16 a[60:63], a[244:247], a[92:95], a[60:63]
    ds_read_b128 v[76:79], v253 offset:12288
    v_mfma_f32_16x16x32_bf16 a[60:63], a[228:231], a[88:91], a[60:63]
    ds_read_b128 v[80:83], v40 offset:12288
    v_mfma_f32_16x16x32_bf16 a[64:67], a[232:235], a[88:91], a[64:67]
    ds_read_b128 v[84:87], v253 offset:32768
    s_waitcnt lgkmcnt(5)
    v_mfma_f32_16x16x32_bf16 a[64:67], a[248:251], a[92:95], a[64:67]
    ds_read_b128 v[88:91], v40 offset:32768
    v_add_f32 v52, v52, v60
    v_mfma_f32_16x16x32_bf16 a[64:67], v[228:231], a[96:99], a[64:67]
    ds_read_b128 v[92:95], v253 offset:36864
    v_add_f32 v53, v53, v61
    v_mfma_f32_16x16x32_bf16 a[64:67], v[244:247], a[100:103], a[64:67]
    ds_read_b128 v[96:99], v40 offset:36864
    v_add_f32 v54, v54, v62
    v_mfma_f32_16x16x32_bf16 a[68:71], v[248:251], a[100:103], a[68:71]
    ds_read_b128 v[100:103], v253 offset:40960
    v_add_f32 v55, v55, v63
    v_mfma_f32_16x16x32_bf16 a[68:71], v[232:235], a[96:99], a[68:71]
    ds_read_b128 v[104:107], v40 offset:40960
    v_add_f32 v56, v56, v64
    v_mfma_f32_16x16x32_bf16 a[68:71], a[252:255], a[92:95], a[68:71]
    ds_read_b128 v[8:11], v253 offset:45056
    v_add_f32 v57, v57, v65
    v_mfma_f32_16x16x32_bf16 a[68:71], a[236:239], a[88:91], a[68:71]
    ds_read_b128 v[12:15], v40 offset:45056
    v_add_f32 v58, v58, v66
    s_waitcnt vmcnt(3)
    v_mfma_f32_16x16x32_bf16 v[128:131], a[144:147], a[104:107], v[128:131]
    v_add_f32 v59, v59, v67
    s_waitcnt lgkmcnt(8)
    v_mfma_f32_16x16x32_bf16 v[128:131], v[172:175], a[108:111], v[128:131]
    v_add_f32 v68, v68, v76
    v_add_f32 v69, v69, v77
    v_mfma_f32_16x16x32_bf16 v[128:131], v[156:159], a[112:115], v[128:131]
    v_add_f32 v70, v70, v78
    v_add_f32 v71, v71, v79
    v_mfma_f32_16x16x32_bf16 a[60:63], v[160:163], a[112:115], a[60:63]
    v_add_f32 v72, v72, v80
    v_add_f32 v73, v73, v81
    v_mfma_f32_16x16x32_bf16 a[60:63], v[176:179], a[108:111], a[60:63]
    v_add_f32 v74, v74, v82
    v_add_f32 v75, v75, v83
    v_mfma_f32_16x16x32_bf16 a[60:63], a[148:151], a[104:107], a[60:63]
    v_add_f32 v52, v52, v68
    v_mfma_f32_16x16x32_bf16 a[64:67], a[152:155], a[104:107], a[64:67]
    v_add_f32 v53, v53, v69
    v_add_f32 v54, v54, v70
    v_mfma_f32_16x16x32_bf16 a[64:67], v[180:183], a[108:111], a[64:67]
    v_add_f32 v55, v55, v71
    v_add_f32 v56, v56, v72
    v_mfma_f32_16x16x32_bf16 a[64:67], v[164:167], a[112:115], a[64:67]
    v_add_f32 v57, v57, v73
    v_add_f32 v58, v58, v74
    v_mfma_f32_16x16x32_bf16 a[68:71], v[168:171], a[112:115], a[68:71]
    v_add_f32 v59, v59, v75
    v_cvt_pk_bf16_f32 v60, v52, v53
    v_mfma_f32_16x16x32_bf16 a[68:71], v[184:187], a[108:111], a[68:71]
    v_cvt_pk_bf16_f32 v61, v54, v55
    v_cvt_pk_bf16_f32 v62, v56, v57
    v_mfma_f32_16x16x32_bf16 a[68:71], a[156:159], a[104:107], a[68:71]
    v_cvt_pk_bf16_f32 v63, v58, v59
    s_waitcnt lgkmcnt(4)
    s_waitcnt vmcnt(1)
    v_mfma_f32_16x16x32_bf16 v[128:131], v[140:143], a[116:119], v[128:131]
    v_add_f32 v84, v84, v92
    v_add_f32 v85, v85, v93
    v_mfma_f32_16x16x32_bf16 v[128:131], v[204:207], a[120:123], v[128:131]
    v_add_f32 v86, v86, v94
    v_add_f32 v87, v87, v95
    v_mfma_f32_16x16x32_bf16 a[60:63], v[208:211], a[120:123], a[60:63]
    v_add_f32 v88, v88, v96
    v_add_f32 v89, v89, v97
    v_mfma_f32_16x16x32_bf16 a[60:63], v[144:147], a[116:119], a[60:63]
    v_add_f32 v90, v90, v98
    v_add_f32 v91, v91, v99
    v_mfma_f32_16x16x32_bf16 a[64:67], v[148:151], a[116:119], a[64:67]
    s_waitcnt lgkmcnt(0)
    v_add_f32 v100, v100, v8
    v_mfma_f32_16x16x32_bf16 a[64:67], v[212:215], a[120:123], a[64:67]
    v_add_f32 v101, v101, v9
    v_add_f32 v102, v102, v10
    v_mfma_f32_16x16x32_bf16 a[68:71], v[216:219], a[120:123], a[68:71]
    v_add_f32 v103, v103, v11
    v_add_f32 v104, v104, v12
    v_mfma_f32_16x16x32_bf16 a[68:71], v[152:155], a[116:119], a[68:71]
    v_add_f32 v105, v105, v13
    v_add_f32 v106, v106, v14
    s_waitcnt vmcnt(0)
    v_mfma_f32_16x16x32_bf16 a[60:63], v[192:195], a[124:127], a[60:63]
    v_add_f32 v107, v107, v15
    v_mfma_f32_16x16x32_bf16 a[64:67], v[196:199], a[124:127], a[64:67]
    v_add_f32 v84, v84, v100
    v_add_f32 v85, v85, v101
    v_mfma_f32_16x16x32_bf16 a[68:71], v[200:203], a[124:127], a[68:71]
    v_add_f32 v86, v86, v102
    v_add_f32 v87, v87, v103
    v_mfma_f32_16x16x32_bf16 v[128:131], v[188:191], a[124:127], v[128:131]
    v_add_f32 v88, v88, v104
    v_add_f32 v89, v89, v105
    v_add_f32 v90, v90, v106
    v_add_f32 v91, v91, v107
    v_cvt_pk_bf16_f32 v92, v84, v85
    v_cvt_pk_bf16_f32 v93, v86, v87
    v_cvt_pk_bf16_f32 v94, v88, v89
    ds_write_b128 v37, a[60:63] offset:16384
    ds_write_b128 v38, a[64:67] offset:16384
    ds_write_b128 v39, a[68:71] offset:16384
    ds_write_b128 v36, v[128:131] offset:16384
    v_cvt_pk_bf16_f32 v95, v90, v91
    buffer_store_dwordx4 v[60:63], v51, s[36:39], s80 offen sc1
    buffer_store_dwordx4 v[92:95], v51, s[36:39], s81 offen sc1
    s_waitcnt lgkmcnt(0)
    s_barrier
    ds_read_b128 v[204:207], v41 offset:0
    ds_read_b128 v[208:211], v42 offset:0
    ds_read_b128 v[212:215], v41 offset:4096
    ds_read_b128 v[216:219], v42 offset:4096
    ds_read_b128 v[220:223], v41 offset:8192
    ds_read_b128 v[224:227], v42 offset:8192
    ds_read_b128 v[228:231], v41 offset:12288
    ds_read_b128 v[232:235], v42 offset:12288
    s_waitcnt lgkmcnt(4)
    v_pk_add_f32 v[204:205], v[204:205], v[212:213]
    v_pk_add_f32 v[206:207], v[206:207], v[214:215]
    v_pk_add_f32 v[208:209], v[208:209], v[216:217]
    v_pk_add_f32 v[210:211], v[210:211], v[218:219]
    s_waitcnt lgkmcnt(0)
    v_pk_add_f32 v[220:221], v[220:221], v[228:229]
    v_pk_add_f32 v[222:223], v[222:223], v[230:231]
    v_pk_add_f32 v[224:225], v[224:225], v[232:233]
    v_pk_add_f32 v[226:227], v[226:227], v[234:235]
    v_pk_add_f32 v[204:205], v[204:205], v[220:221]
    v_pk_add_f32 v[206:207], v[206:207], v[222:223]
    v_pk_add_f32 v[208:209], v[208:209], v[224:225]
    v_pk_add_f32 v[210:211], v[210:211], v[226:227]
    v_cvt_pk_bf16_f32 v212, v204, v205
    v_cvt_pk_bf16_f32 v213, v206, v207
    v_cvt_pk_bf16_f32 v214, v208, v209
    v_cvt_pk_bf16_f32 v215, v210, v211
    buffer_store_dwordx4 v[212:215], v51, s[36:39], s82 offen sc1
    s_endpgm
L_go_c1s:
    s_waitcnt lgkmcnt(0)
    s_mov_b32 s90, 0
L_go_c1w:
    s_sleep 2
    buffer_load_dword v1, v9, s[44:47], 0 offen sc1
    s_waitcnt vmcnt(0)
    v_readfirstlane_b32 s52, v1
    s_add_u32 s90, s90, 1
    s_cmp_gt_u32 s90, 0x80000
    s_cbranch_scc1 L_go_c1
    s_cmp_eq_u32 s52, 0
    s_cbranch_scc1 L_go_c1w
    s_branch L_go_c1
L_nu_c1_0s:
    s_waitcnt lgkmcnt(0)
    s_mov_b32 s90, 0
L_nu_c1_0w:
    s_mov_b64 exec, 0xffffff
    buffer_load_dwordx4 v[4:7], v47, s[40:43], 0 offen sc1
    s_mov_b64 exec, -1
    s_waitcnt vmcnt(0) lgkmcnt(0)
    v_min_u32 v4, v4, v5
    v_min3_u32 v4, v4, v6, v7
    v_cmp_gt_u32 vcc, v4, v48
    s_nop 0
    s_or_b64 s[58:59], s[58:59], vcc
    s_and_b32 s52, s58, 0xffffff
    s_cmp_eq_u32 s52, 0xffffff
    s_cbranch_scc1 L_nu_c1_0
    s_sleep 4
    s_add_u32 s90, s90, 1
    s_cmp_gt_u32 s90, 0x80000
    s_cbranch_scc0 L_nu_c1_0w
    s_branch L_nu_c1_0
L_codeend_c1:
L_cls2:
    s_bfe_u32 s80, s67, 0x40000
    s_lshl_b32 s80, s80, 7
    s_mul_i32 s51, s80, 1728
    s_add_u32 m0, s49, 0
    s_nop 0
    buffer_load_dwordx4 v17, s[24:27], s51 offen lds
    s_add_u32 m0, s49, 4096
    s_nop 0
    buffer_load_dwordx4 v17, s[28:31], s51 offen lds
    s_add_u32 m0, s49, 8192
    s_nop 0
    buffer_load_dwordx4 v18, s[24:27], s51 offen lds
    s_add_u32 m0, s49, 12288
    s_nop 0
    buffer_load_dwordx4 v18, s[28:31], s51 offen lds
    s_add_u32 m0, s49, 16384
    s_nop 0
    buffer_load_dwordx4 v10, s[20:23], s80 offen lds
    s_mul_i32 s51, s80, 1728
    s_add_u32 s51, s51, 128
    s_add_u32 m0, s49, 20480
    s_nop 0
    buffer_load_dwordx4 v17, s[24:27], s51 offen lds
    s_add_u32 m0, s49, 24576
    s_nop 0
    buffer_load_dwordx4 v17, s[28:31], s51 offen lds
    s_add_u32 m0, s49, 28672
    s_nop 0
    buffer_load_dwordx4 v18, s[24:27], s51 offen lds
    s_add_u32 m0, s49, 32768
    s_nop 0
    buffer_load_dwordx4 v18, s[28:31], s51 offen lds
    s_mul_i32 s51, s80, 1728
    s_add_u32 s51, s51, 256
    s_add_u32 m0, s49, 36864
    s_nop 0
    buffer_load_dwordx4 v17, s[24:27], s51 offen lds
    s_add_u32 m0, s49, 40960
    s_nop 0
    buffer_load_dwordx4 v17, s[28:31], s51 offen lds
    s_add_u32 m0, s49, 45056
    s_nop 0
    buffer_load_dwordx4 v18, s[24:27], s51 offen lds
    s_add_u32 m0, s49, 49152
    s_nop 0
    buffer_load_dwordx4 v18, s[28:31], s51 offen lds
    s_add_u32 s92, s18, L_code_c2-L_pc
    s_addc_u32 s93, s19, 0
    s_mov_b32 s94, L_codeend_c2-L_code_c2
    s_mov_b32 s95, 0x20000
    buffer_load_dword v254, v49, s[92:95], 0 offen
    s_barrier
    s_mov_b64 s[32:33], s[10:11]
    s_mov_b64 s[36:37], s[12:13]
    s_mov_b64 s[44:45], s[14:15]
    s_mov_b64 s[40:41], s[16:17]
    v_xor_b32 v33, 32, v32
    v_xor_b32 v34, 64, v32
    v_xor_b32 v35, 96, v32
    v_add_u32 v36, 65536, v32
    v_add_u32 v37, 65536, v33
    v_add_u32 v38, 65536, v34
    v_add_u32 v39, 65536, v35
    v_add_u32 v40, 131072, v32
    v_add_u32 v41, 131072, v33
    v_add_u32 v42, 131072, v34
    v_add_u32 v43, 131072, v35
    v_add_u32 v19, s70, v19
    v_add_u32 v20, s70, v20
    v_add_u32 v21, 20480, v19
    v_add_u32 v22, 20480, v20
    s_lshr_b32 s52, s48, 1
    s_mul_i32 s52, s52, 53248
    s_add_u32 s52, s52, s49
    s_add_u32 s52, s52, s68
    v_lshlrev_b32 v100, 4, v0
    v_add_u32 v44, s52, v100
    s_mul_i32 s52, s48, 14336
    v_add_u32 v45, s52, v100
    s_cmp_eq_u32 s48, 3
    s_cselect_b32 s53, 5, 6
    s_movk_i32 s56, 14336
    s_cselect_b32 s56, 12288, s56
    s_and_b32 s91, s71, 0xff
    s_lshl_b32 s91, s91, 10
    s_cmp_ge_u32 s91, s56
    s_cselect_b32 s4, 0x2000000, s91
    s_add_u32 s91, s91, 1024
    s_cmp_eq_u32 s91, 14336
    s_cselect_b32 s91, 0, s91
    s_cmp_ge_u32 s91, s56
    s_cselect_b32 s5, 0x2000000, s91
    s_add_u32 s91, s91, 1024
    s_cmp_eq_u32 s91, 14336
    s_cselect_b32 s91, 0, s91
    s_cmp_ge_u32 s91, s56
    s_cselect_b32 s6, 0x2000000, s91
    s_add_u32 s91, s91, 1024
    s_cmp_eq_u32 s91, 14336
    s_cselect_b32 s91, 0, s91
    s_cmp_ge_u32 s91, s56
    s_cselect_b32 s7, 0x2000000, s91
    s_add_u32 s91, s91, 1024
    s_cmp_eq_u32 s91, 14336
    s_cselect_b32 s91, 0, s91
    s_cmp_ge_u32 s91, s56
    s_cselect_b32 s8, 0x2000000, s91
    s_add_u32 s91, s91, 1024
    s_cmp_eq_u32 s91, 14336
    s_cselect_b32 s91, 0, s91
    s_cmp_ge_u32 s91, s56
    s_cselect_b32 s9, 0x2000000, s91
    s_add_u32 s91, s91, 1024
    s_cmp_eq_u32 s91, 14336
    s_cselect_b32 s91, 0, s91
    s_cmp_ge_u32 s91, s56
    s_cselect_b32 s10, 0x2000000, s91
    s_add_u32 s91, s91, 1024
    s_cmp_eq_u32 s91, 14336
    s_cselect_b32 s91, 0, s91
    s_cmp_ge_u32 s91, s56
    s_cselect_b32 s11, 0x2000000, s91
    s_add_u32 s91, s91, 1024
    s_cmp_eq_u32 s91, 14336
    s_cselect_b32 s91, 0, s91
    s_cmp_ge_u32 s91, s56
    s_cselect_b32 s12, 0x2000000, s91
    s_add_u32 s91, s91, 1024
    s_cmp_eq_u32 s91, 14336
    s_cselect_b32 s91, 0, s91
    s_cmp_ge_u32 s91, s56
    s_cselect_b32 s13, 0x2000000, s91
    s_add_u32 s91, s91, 1024
    s_cmp_eq_u32 s91, 14336
    s_cselect_b32 s91, 0, s91
    s_cmp_ge_u32 s91, s56
    s_cselect_b32 s14, 0x2000000, s91
    s_add_u32 s91, s91, 1024
    s_cmp_eq_u32 s91, 14336
    s_cselect_b32 s91, 0, s91
    s_cmp_ge_u32 s91, s56
    s_cselect_b32 s15, 0x2000000, s91
    s_add_u32 s91, s91, 1024
    s_cmp_eq_u32 s91, 14336
    s_cselect_b32 s91, 0, s91
    s_cmp_ge_u32 s91, s56
    s_cselect_b32 s16, 0x2000000, s91
    s_add_u32 s91, s91, 1024
    s_cmp_eq_u32 s91, 14336
    s_cselect_b32 s91, 0, s91
    s_cmp_ge_u32 s91, s56
    s_cselect_b32 s17, 0x2000000, s91
    s_lshl_b32 s52, s48, 2
    v_add_u32 v100, s52, v5
    v_xor_b32 v100, v100, v4
    v_lshlrev_b32 v100, 4, v100
    v_lshl_add_u32 v100, v4, 8, v100
    v_add_u32 v50, s50, v100
    s_and_b32 s52, s48, 1
    s_lshl_b32 s52, s52, 3
    v_add_u32 v100, s52, v2
    v_lshlrev_b32 v102, 1, v3
    v_xor_b32 v102, v102, v100
    v_lshlrev_b32 v102, 4, v102
    v_lshl_add_u32 v102, v100, 8, v102
    s_lshr_b32 s52, s48, 1
    s_lshl_b32 s52, s52, 14
    v_add_u32 v253, s52, v102
    v_mul_u32_u24 v100, 1280, v100
    v_lshl_add_u32 v100, v3, 4, v100
    v_add_u32 v51, s70, v100
    v_lshl_add_u32 v102, v2, 3, 8
    v_lshrrev_b32 v100, v102, s71
    v_and_b32 v100, 0x7f, v100
    v_lshrrev_b32 v100, 1, v100
    v_mul_u32_u24 v102, 37, v100
    v_lshrrev_b32 v102, 8, v102
    v_mul_u32_u24 v48, 7, v102
    v_sub_u32 v48, v100, v48
    v_mul_u32_u24 v102, 27, v102
    v_min_u32 v100, s53, v3
    s_mul_i32 s52, s48, 7
    v_add3_u32 v100, v100, v102, s52
    v_lshlrev_b32 v100, 7, v100
    v_add_u32 v47, 8388608, v100
    s_add_u32 s69, s69, 8388608
    s_lshl_b32 s52, s48, 2
    s_add_u32 s69, s69, s52
L_code_c2:
    s_bfe_u32 s81, s67, 0x40004
    s_lshl_b32 s81, s81, 7
    s_mul_i32 s51, s81, 1728
    s_add_u32 m0, s49, 53248
    s_nop 0
    buffer_load_dwordx4 v17, s[24:27], s51 offen lds
    s_add_u32 m0, s49, 57344
    s_nop 0
    buffer_load_dwordx4 v17, s[28:31], s51 offen lds
    s_add_u32 m0, s49, 61440
    s_nop 0
    buffer_load_dwordx4 v18, s[24:27], s51 offen lds
    s_add_u32 m0, s49, 65536
    s_nop 0
    buffer_load_dwordx4 v18, s[28:31], s51 offen lds
    s_add_u32 m0, s49, 69632
    s_nop 0
    buffer_load_dwordx4 v10, s[20:23], s81 offen lds
    s_mul_i32 s51, s81, 1728
    s_add_u32 s51, s51, 128
    s_add_u32 m0, s49, 73728
    s_nop 0
    buffer_load_dwordx4 v17, s[24:27], s51 offen lds
    s_add_u32 m0, s49, 77824
    s_nop 0
    buffer_load_dwordx4 v17, s[28:31], s51 offen lds
    s_add_u32 m0, s49, 81920
    s_nop 0
    buffer_load_dwordx4 v18, s[24:27], s51 offen lds
    s_add_u32 m0, s49, 86016
    s_nop 0
    buffer_load_dwordx4 v18, s[28:31], s51 offen lds
    s_waitcnt vmcnt(10)
    s_barrier
    ds_read_b64_tr_b16 a[0:1], v29 offset:0
    ds_read_b64_tr_b16 a[2:3], v29 offset:512
    ds_read_b128 v[52:55], v23 offset:16384
    ds_read_b64_tr_b16 a[16:17], v29 offset:8192
    ds_read_b64_tr_b16 a[18:19], v29 offset:8704
    ds_read_b128 v[56:59], v24 offset:16384
    ds_read_b64_tr_b16 a[20:21], v29 offset:12288
    ds_read_b64_tr_b16 a[22:23], v29 offset:12800
    ds_read_b64_tr_b16 a[4:5], v29 offset:4096
    ds_read_b64_tr_b16 a[6:7], v29 offset:4608
    ds_read_b64_tr_b16 a[8:9], v104 offset:0
    ds_read_b64_tr_b16 a[10:11], v104 offset:512
    ds_read_b64_tr_b16 a[24:25], v104 offset:8192
    ds_read_b64_tr_b16 a[26:27], v104 offset:8704
    ds_read_b64_tr_b16 a[28:29], v104 offset:12288
    s_waitcnt lgkmcnt(12)
    v_mfma_f32_16x16x32_bf16 v[204:207], a[0:3], v[52:55], 0
    s_mul_i32 s51, s81, 1728
    s_add_u32 s51, s51, 256
    s_add_u32 m0, s49, 90112
    ds_read_b64_tr_b16 a[30:31], v104 offset:12800
    ds_read_b64_tr_b16 a[12:13], v104 offset:4096
    ds_read_b64_tr_b16 a[14:15], v104 offset:4608
    s_waitcnt lgkmcnt(12)
    v_mfma_f32_16x16x32_bf16 v[204:207], a[16:19], v[56:59], v[204:207]
    buffer_load_dwordx4 v17, s[24:27], s51 offen lds
    s_add_u32 m0, s49, 94208
    ds_read_b64_tr_b16 a[32:33], v29 offset:20480
    ds_read_b64_tr_b16 a[34:35], v29 offset:20992
    ds_read_b128 v[60:63], v23 offset:16384
    s_waitcnt lgkmcnt(13)
    v_mfma_f32_16x16x32_bf16 v[208:211], a[20:23], v[56:59], 0
    buffer_load_dwordx4 v17, s[28:31], s51 offen lds
    s_add_u32 m0, s49, 98304
    ds_read_b64_tr_b16 a[48:49], v29 offset:28672
    ds_read_b64_tr_b16 a[50:51], v29 offset:29184
    ds_read_b128 v[64:67], v24 offset:16384
    s_waitcnt lgkmcnt(14)
    v_mfma_f32_16x16x32_bf16 v[208:211], a[4:7], v[52:55], v[208:211]
    buffer_load_dwordx4 v18, s[24:27], s51 offen lds
    s_add_u32 m0, s49, 102400
    ds_read_b64_tr_b16 a[52:53], v29 offset:32768
    ds_read_b64_tr_b16 a[54:55], v29 offset:33280
    ds_read_b64_tr_b16 a[36:37], v29 offset:24576
    s_waitcnt lgkmcnt(15)
    v_mfma_f32_16x16x32_bf16 v[212:215], a[8:11], v[52:55], 0
    buffer_load_dwordx4 v18, s[28:31], s51 offen lds
    s_bfe_u32 s82, s67, 0x40008
    s_lshl_b32 s82, s82, 7
    s_mul_i32 s51, s82, 1728
    s_add_u32 m0, s49, 106496
    ds_read_b64_tr_b16 a[38:39], v29 offset:25088
    ds_read_b64_tr_b16 a[40:41], v104 offset:20480
    ds_read_b64_tr_b16 a[42:43], v104 offset:20992
    s_waitcnt lgkmcnt(15)
    v_mfma_f32_16x16x32_bf16 v[212:215], a[24:27], v[56:59], v[212:215]
    buffer_load_dwordx4 v17, s[24:27], s51 offen lds
    s_add_u32 m0, s49, 110592
    ds_read_b64_tr_b16 a[56:57], v104 offset:28672
    ds_read_b64_tr_b16 a[58:59], v104 offset:29184
    ds_read_b64_tr_b16 a[60:61], v104 offset:32768
    s_waitcnt lgkmcnt(15)
    v_mfma_f32_16x16x32_bf16 v[216:219], a[28:31], v[56:59], 0
    buffer_load_dwordx4 v17, s[28:31], s51 offen lds
    s_add_u32 m0, s49, 114688
    ds_read_b64_tr_b16 a[62:63], v104 offset:33280
    ds_read_b64_tr_b16 a[44:45], v104 offset:24576
    ds_read_b64_tr_b16 a[46:47], v104 offset:25088
    v_mfma_f32_16x16x32_bf16 v[216:219], a[12:15], v[52:55], v[216:219]
    buffer_load_dwordx4 v18, s[24:27], s51 offen lds
    s_add_u32 m0, s49, 118784
    ds_read_b64_tr_b16 a[64:65], v29 offset:36864
    ds_read_b64_tr_b16 a[66:67], v29 offset:37376
    ds_read_b128 v[68:71], v23 offset:16384
    s_waitcnt lgkmcnt(15)
    v_mfma_f32_16x16x32_bf16 v[188:191], a[32:35], v[60:63], 0
    buffer_load_dwordx4 v18, s[28:31], s51 offen lds
    s_add_u32 m0, s49, 122880
    ds_read_b64_tr_b16 a[80:81], v29 offset:45056
    ds_read_b64_tr_b16 a[82:83], v29 offset:45568
    ds_read_b128 v[72:75], v24 offset:16384
    v_mfma_f32_16x16x32_bf16 v[188:191], a[48:51], v[64:67], v[188:191]
    buffer_load_dwordx4 v10, s[20:23], s82 offen lds
    s_mul_i32 s51, s82, 1728
    s_add_u32 s51, s51, 128
    s_add_u32 m0, s49, 126976
    ds_read_b64_tr_b16 a[84:85], v29 offset:49152
    ds_read_b64_tr_b16 a[86:87], v29 offset:49664
    ds_read_b64_tr_b16 a[68:69], v29 offset:40960
    s_waitcnt lgkmcnt(15)
    v_mfma_f32_16x16x32_bf16 v[192:195], a[52:55], v[64:67], 0
    buffer_load_dwordx4 v17, s[24:27], s51 offen lds
    s_add_u32 m0, s49, 131072
    ds_read_b64_tr_b16 a[70:71], v29 offset:41472
    ds_read_b64_tr_b16 a[72:73], v104 offset:36864
    ds_read_b64_tr_b16 a[74:75], v104 offset:37376
    v_mfma_f32_16x16x32_bf16 v[192:195], a[36:39], v[60:63], v[192:195]
    buffer_load_dwordx4 v17, s[28:31], s51 offen lds
    s_add_u32 m0, s49, 135168
    ds_read_b64_tr_b16 a[88:89], v104 offset:45056
    ds_read_b64_tr_b16 a[90:91], v104 offset:45568
    ds_read_b64_tr_b16 a[92:93], v104 offset:49152
    v_mfma_f32_16x16x32_bf16 v[196:199], a[40:43], v[60:63], 0
    buffer_load_dwordx4 v18, s[24:27], s51 offen lds
    s_add_u32 m0, s49, 139264
    ds_read_b64_tr_b16 a[94:95], v104 offset:49664
    ds_read_b64_tr_b16 a[76:77], v104 offset:40960
    ds_read_b64_tr_b16 a[78:79], v104 offset:41472
    s_waitcnt lgkmcnt(15)
    v_mfma_f32_16x16x32_bf16 v[196:199], a[56:59], v[64:67], v[196:199]
    buffer_load_dwordx4 v18, s[28:31], s51 offen lds
    s_mul_i32 s51, s82, 1728
    s_add_u32 s51, s51, 256
    s_add_u32 m0, s49, 143360
    v_mfma_f32_16x16x32_bf16 v[200:203], a[60:63], v[64:67], 0
    buffer_load_dwordx4 v17, s[24:27], s51 offen lds
    s_add_u32 m0, s49, 147456
    v_mfma_f32_16x16x32_bf16 v[200:203], a[44:47], v[60:63], v[200:203]
    buffer_load_dwordx4 v17, s[28:31], s51 offen lds
    s_add_u32 m0, s49, 151552
    v_mfma_f32_16x16x32_bf16 v[172:175], a[64:67], v[68:71], 0
    buffer_load_dwordx4 v18, s[24:27], s51 offen lds
    s_waitcnt vmcnt(12) lgkmcnt(0)
    s_barrier
    ds_read_b64_tr_b16 a[96:97], v29 offset:53248
    ds_read_b64_tr_b16 a[98:99], v29 offset:53760
    v_mfma_f32_16x16x32_bf16 v[172:175], a[80:83], v[72:75], v[172:175]
    s_add_u32 m0, s49, 155648
    ds_read_b128 v[76:79], v25 offset:4096
    ds_read_b64_tr_b16 a[112:113], v29 offset:61440
    ds_read_b64_tr_b16 a[114:115], v29 offset:61952
    v_mfma_f32_16x16x32_bf16 v[176:179], a[84:87], v[72:75], 0
    buffer_load_dwordx4 v18, s[28:31], s51 offen lds
    s_bfe_u32 s83, s67, 0x4000c
    s_lshl_b32 s83, s83, 7
    s_mul_i32 s51, s83, 1728
    s_add_u32 m0, s49, 159744
    ds_read_b128 v[80:83], v26 offset:4096
    ds_read_b64_tr_b16 a[116:117], v30 offset:0
    ds_read_b64_tr_b16 a[118:119], v30 offset:512
    v_mfma_f32_16x16x32_bf16 v[176:179], a[68:71], v[68:71], v[176:179]
    buffer_load_dwordx4 v17, s[24:27], s51 offen lds
    s_add_u32 m0, s49, 0
    ds_read_b64_tr_b16 a[100:101], v29 offset:57344
    ds_read_b64_tr_b16 a[102:103], v29 offset:57856
    ds_read_b64_tr_b16 a[104:105], v104 offset:53248
    v_mfma_f32_16x16x32_bf16 v[180:183], a[72:75], v[68:71], 0
    buffer_load_dwordx4 v17, s[28:31], s51 offen lds
    s_add_u32 m0, s49, 4096
    ds_read_b64_tr_b16 a[106:107], v104 offset:53760
    ds_read_b64_tr_b16 a[120:121], v104 offset:61440
    ds_read_b64_tr_b16 a[122:123], v104 offset:61952
    v_mfma_f32_16x16x32_bf16 v[180:183], a[88:91], v[72:75], v[180:183]
    buffer_load_dwordx4 v18, s[24:27], s51 offen lds
    s_add_u32 m0, s49, 8192
    ds_read_b64_tr_b16 a[124:125], v105 offset:0
    ds_read_b64_tr_b16 a[126:127], v105 offset:512
    ds_read_b64_tr_b16 a[108:109], v104 offset:57344
    v_mfma_f32_16x16x32_bf16 v[184:187], a[92:95], v[72:75], 0
    buffer_load_dwordx4 v18, s[28:31], s51 offen lds
    s_add_u32 m0, s49, 12288
    ds_read_b64_tr_b16 a[110:111], v104 offset:57856
    ds_read_b64_tr_b16 a[0:1], v30 offset:8192
    ds_read_b64_tr_b16 a[2:3], v30 offset:8704
    v_mfma_f32_16x16x32_bf16 v[184:187], a[76:79], v[68:71], v[184:187]
    buffer_load_dwordx4 v10, s[20:23], s83 offen lds
    s_mul_i32 s51, s83, 1728
    s_add_u32 s51, s51, 128
    s_add_u32 m0, s49, 32768
    ds_read_b128 v[84:87], v25 offset:4096
    ds_read_b64_tr_b16 a[16:17], v30 offset:16384
    ds_read_b64_tr_b16 a[18:19], v30 offset:16896
    s_waitcnt lgkmcnt(15)
    v_mfma_f32_16x16x32_bf16 v[204:207], a[96:99], v[76:79], v[204:207]
    buffer_load_dwordx4 v17, s[24:27], s51 offen lds
    s_add_u32 m0, s49, 36864
    ds_read_b128 v[88:91], v26 offset:4096
    ds_read_b64_tr_b16 a[20:21], v30 offset:20480
    ds_read_b64_tr_b16 a[22:23], v30 offset:20992
    v_mfma_f32_16x16x32_bf16 v[204:207], a[112:115], v[80:83], v[204:207]
    buffer_load_dwordx4 v17, s[28:31], s51 offen lds
    s_add_u32 m0, s49, 40960
    ds_read_b64_tr_b16 a[4:5], v30 offset:12288
    ds_read_b64_tr_b16 a[6:7], v30 offset:12800
    ds_read_b64_tr_b16 a[8:9], v105 offset:8192
    v_mfma_f32_16x16x32_bf16 v[208:211], a[116:119], v[80:83], v[208:211]
    buffer_load_dwordx4 v18, s[24:27], s51 offen lds
    s_add_u32 m0, s49, 45056
    ds_read_b64_tr_b16 a[10:11], v105 offset:8704
    ds_read_b64_tr_b16 a[24:25], v105 offset:16384
    ds_read_b64_tr_b16 a[26:27], v105 offset:16896
    s_waitcnt lgkmcnt(15)
    v_mfma_f32_16x16x32_bf16 v[208:211], a[100:103], v[76:79], v[208:211]
    buffer_load_dwordx4 v18, s[28:31], s51 offen lds
    s_mul_i32 s51, s83, 1728
    s_add_u32 s51, s51, 256
    s_add_u32 m0, s49, 16384
    ds_read_b64_tr_b16 a[28:29], v105 offset:20480
    ds_read_b64_tr_b16 a[30:31], v105 offset:20992
    ds_read_b64_tr_b16 a[12:13], v105 offset:12288
    v_mfma_f32_16x16x32_bf16 v[212:215], a[104:107], v[76:79], v[212:215]
    buffer_load_dwordx4 v17, s[24:27], s51 offen lds
    s_add_u32 m0, s49, 20480
    ds_read_b64_tr_b16 a[14:15], v105 offset:12800
    ds_read_b64_tr_b16 a[32:33], v30 offset:24576
    ds_read_b64_tr_b16 a[34:35], v30 offset:25088
    v_mfma_f32_16x16x32_bf16 v[212:215], a[120:123], v[80:83], v[212:215]
    buffer_load_dwordx4 v17, s[28:31], s51 offen lds
    s_add_u32 m0, s49, 24576
    ds_read_b128 v[92:95], v25 offset:4096
    ds_read_b64_tr_b16 a[48:49], v30 offset:32768
    ds_read_b64_tr_b16 a[50:51], v30 offset:33280
    v_mfma_f32_16x16x32_bf16 v[216:219], a[124:127], v[80:83], v[216:219]
    buffer_load_dwordx4 v18, s[24:27], s51 offen lds
    ds_read_b128 v[96:99], v26 offset:4096
    ds_read_b64_tr_b16 a[52:53], v30 offset:36864
    ds_read_b64_tr_b16 a[54:55], v30 offset:37376
    s_waitcnt lgkmcnt(15)
    v_mfma_f32_16x16x32_bf16 v[216:219], a[108:111], v[76:79], v[216:219]
    ds_read_b64_tr_b16 a[36:37], v30 offset:28672
    ds_read_b64_tr_b16 a[38:39], v30 offset:29184
    ds_read_b64_tr_b16 a[40:41], v105 offset:24576
    v_mfma_f32_16x16x32_bf16 v[188:191], a[0:3], v[84:87], v[188:191]
    ds_read_b64_tr_b16 a[42:43], v105 offset:25088
    ds_read_b64_tr_b16 a[56:57], v105 offset:32768
    ds_read_b64_tr_b16 a[58:59], v105 offset:33280
    v_mfma_f32_16x16x32_bf16 v[188:191], a[16:19], v[88:91], v[188:191]
    ds_read_b64_tr_b16 a[60:61], v105 offset:36864
    ds_read_b64_tr_b16 a[62:63], v105 offset:37376
    ds_read_b64_tr_b16 a[44:45], v105 offset:28672
    v_mfma_f32_16x16x32_bf16 v[192:195], a[20:23], v[88:91], v[192:195]
    ds_read_b64_tr_b16 a[46:47], v105 offset:29184
    v_mfma_f32_16x16x32_bf16 v[192:195], a[4:7], v[84:87], v[192:195]
    s_waitcnt lgkmcnt(15)
    v_mfma_f32_16x16x32_bf16 v[196:199], a[8:11], v[84:87], v[196:199]
    v_mfma_f32_16x16x32_bf16 v[196:199], a[24:27], v[88:91], v[196:199]
    v_mfma_f32_16x16x32_bf16 v[200:203], a[28:31], v[88:91], v[200:203]
    v_mfma_f32_16x16x32_bf16 v[200:203], a[12:15], v[84:87], v[200:203]
    s_waitcnt vmcnt(12) lgkmcnt(0)
    s_barrier
    ds_read_b64_tr_b16 a[64:65], v30 offset:40960
    ds_read_b64_tr_b16 a[66:67], v30 offset:41472
    v_mfma_f32_16x16x32_bf16 v[172:175], a[32:35], v[92:95], v[172:175]
    s_add_u32 m0, s49, 28672
    ds_read_b128 v[52:55], v25 offset:57344
    ds_read_b64_tr_b16 a[80:81], v30 offset:49152
    ds_read_b64_tr_b16 a[82:83], v30 offset:49664
    v_mfma_f32_16x16x32_bf16 v[172:175], a[48:51], v[96:99], v[172:175]
    buffer_load_dwordx4 v18, s[28:31], s51 offen lds
    s_bfe_u32 s84, s67, 0x40010
    s_lshl_b32 s84, s84, 7
    s_mul_i32 s51, s84, 1728
    s_add_u32 m0, s49, 49152
    ds_read_b128 v[56:59], v26 offset:57344
    ds_read_b64_tr_b16 a[84:85], v30 offset:53248
    ds_read_b64_tr_b16 a[86:87], v30 offset:53760
    v_mfma_f32_16x16x32_bf16 v[176:179], a[52:55], v[96:99], v[176:179]
    buffer_load_dwordx4 v17, s[24:27], s51 offen lds
    s_add_u32 m0, s49, 53248
    ds_read_b64_tr_b16 a[68:69], v30 offset:45056
    ds_read_b64_tr_b16 a[70:71], v30 offset:45568
    ds_read_b64_tr_b16 a[72:73], v105 offset:40960
    v_mfma_f32_16x16x32_bf16 v[176:179], a[36:39], v[92:95], v[176:179]
    buffer_load_dwordx4 v17, s[28:31], s51 offen lds
    s_add_u32 m0, s49, 57344
    ds_read_b64_tr_b16 a[74:75], v105 offset:41472
    ds_read_b64_tr_b16 a[88:89], v105 offset:49152
    ds_read_b64_tr_b16 a[90:91], v105 offset:49664
    v_mfma_f32_16x16x32_bf16 v[180:183], a[40:43], v[92:95], v[180:183]
    buffer_load_dwordx4 v18, s[24:27], s51 offen lds
    s_add_u32 m0, s49, 61440
    ds_read_b64_tr_b16 a[92:93], v105 offset:53248
    ds_read_b64_tr_b16 a[94:95], v105 offset:53760
    ds_read_b64_tr_b16 a[76:77], v105 offset:45056
    v_mfma_f32_16x16x32_bf16 v[180:183], a[56:59], v[96:99], v[180:183]
    buffer_load_dwordx4 v18, s[28:31], s51 offen lds
    s_add_u32 m0, s49, 81920
    ds_read_b64_tr_b16 a[78:79], v105 offset:45568
    ds_read_b64_tr_b16 a[96:97], v30 offset:61440
    ds_read_b64_tr_b16 a[98:99], v30 offset:61952
    v_mfma_f32_16x16x32_bf16 v[184:187], a[60:63], v[96:99], v[184:187]
    buffer_load_dwordx4 v10, s[20:23], s84 offen lds
    s_mul_i32 s51, s84, 1728
    s_add_u32 s51, s51, 128
    s_add_u32 m0, s49, 86016
    ds_read_b128 v[60:63], v25 offset:57344
    ds_read_b64_tr_b16 a[112:113], v31 offset:4096
    ds_read_b64_tr_b16 a[114:115], v31 offset:4608
    v_mfma_f32_16x16x32_bf16 v[184:187], a[44:47], v[92:95], v[184:187]
    buffer_load_dwordx4 v17, s[24:27], s51 offen lds
    s_add_u32 m0, s49, 90112
    ds_read_b128 v[64:67], v26 offset:57344
    ds_read_b64_tr_b16 a[116:117], v31 offset:8192
    ds_read_b64_tr_b16 a[118:119], v31 offset:8704
    s_waitcnt lgkmcnt(15)
    v_mfma_f32_16x16x32_bf16 v[204:207], a[64:67], v[52:55], v[204:207]
    buffer_load_dwordx4 v17, s[28:31], s51 offen lds
    s_add_u32 m0, s49, 94208
    ds_read_b64_tr_b16 a[100:101], v31 offset:0
    ds_read_b64_tr_b16 a[102:103], v31 offset:512
    ds_read_b64_tr_b16 a[104:105], v105 offset:61440
    v_mfma_f32_16x16x32_bf16 v[204:207], a[80:83], v[56:59], v[204:207]
    buffer_load_dwordx4 v18, s[24:27], s51 offen lds
    s_add_u32 m0, s49, 65536
    ds_read_b64_tr_b16 a[106:107], v105 offset:61952
    ds_read_b64_tr_b16 a[120:121], v106 offset:4096
    ds_read_b64_tr_b16 a[122:123], v106 offset:4608
    v_mfma_f32_16x16x32_bf16 v[208:211], a[84:87], v[56:59], v[208:211]
    buffer_load_dwordx4 v18, s[28:31], s51 offen lds
    s_mul_i32 s51, s84, 1728
    s_add_u32 s51, s51, 256
    s_add_u32 m0, s49, 69632
    ds_read_b64_tr_b16 a[124:125], v106 offset:8192
    ds_read_b64_tr_b16 a[126:127], v106 offset:8704
    ds_read_b64_tr_b16 a[108:109], v106 offset:0
    v_mfma_f32_16x16x32_bf16 v[208:211], a[68:71], v[52:55], v[208:211]
    buffer_load_dwordx4 v17, s[24:27], s51 offen lds
    s_add_u32 m0, s49, 73728
    ds_read_b64_tr_b16 a[110:111], v106 offset:512
    ds_read_b64_tr_b16 a[0:1], v31 offset:12288
    ds_read_b64_tr_b16 a[2:3], v31 offset:12800
    s_waitcnt lgkmcnt(15)
    v_mfma_f32_16x16x32_bf16 v[212:215], a[72:75], v[52:55], v[212:215]
    buffer_load_dwordx4 v17, s[28:31], s51 offen lds
    s_add_u32 m0, s49, 77824
    ds_read_b128 v[68:71], v25 offset:57344
    ds_read_b64_tr_b16 a[16:17], v31 offset:20480
    ds_read_b64_tr_b16 a[18:19], v31 offset:20992
    v_mfma_f32_16x16x32_bf16 v[212:215], a[88:91], v[56:59], v[212:215]
    buffer_load_dwordx4 v18, s[24:27], s51 offen lds
    ds_read_b128 v[72:75], v26 offset:57344
    ds_read_b64_tr_b16 a[20:21], v31 offset:24576
    ds_read_b64_tr_b16 a[22:23], v31 offset:25088
    v_mfma_f32_16x16x32_bf16 v[216:219], a[92:95], v[56:59], v[216:219]
    ds_read_b64_tr_b16 a[4:5], v31 offset:16384
    ds_read_b64_tr_b16 a[6:7], v31 offset:16896
    ds_read_b64_tr_b16 a[8:9], v106 offset:12288
    v_mfma_f32_16x16x32_bf16 v[216:219], a[76:79], v[52:55], v[216:219]
    ds_read_b64_tr_b16 a[10:11], v106 offset:12800
    ds_read_b64_tr_b16 a[24:25], v106 offset:20480
    ds_read_b64_tr_b16 a[26:27], v106 offset:20992
    v_mfma_f32_16x16x32_bf16 v[188:191], a[96:99], v[60:63], v[188:191]
    ds_read_b64_tr_b16 a[28:29], v106 offset:24576
    ds_read_b64_tr_b16 a[30:31], v106 offset:25088
    ds_read_b64_tr_b16 a[12:13], v106 offset:16384
    s_waitcnt lgkmcnt(15)
    v_mfma_f32_16x16x32_bf16 v[188:191], a[112:115], v[64:67], v[188:191]
    ds_read_b64_tr_b16 a[14:15], v106 offset:16896
    v_mfma_f32_16x16x32_bf16 v[192:195], a[116:119], v[64:67], v[192:195]
    v_mfma_f32_16x16x32_bf16 v[192:195], a[100:103], v[60:63], v[192:195]
    v_mfma_f32_16x16x32_bf16 v[196:199], a[104:107], v[60:63], v[196:199]
    v_mfma_f32_16x16x32_bf16 v[196:199], a[120:123], v[64:67], v[196:199]
    v_mfma_f32_16x16x32_bf16 v[200:203], a[124:127], v[64:67], v[200:203]
    s_waitcnt vmcnt(12) lgkmcnt(0)
    s_barrier
    ds_read_b64_tr_b16 a[32:33], v31 offset:28672
    ds_read_b64_tr_b16 a[34:35], v31 offset:29184
    v_mfma_f32_16x16x32_bf16 v[200:203], a[108:111], v[60:63], v[200:203]
    s_add_u32 m0, s49, 98304
    ds_read_b128 v[76:79], v23 offset:12288
    ds_read_b64_tr_b16 a[48:49], v29 offset:4096
    ds_read_b64_tr_b16 a[50:51], v29 offset:4608
    v_mfma_f32_16x16x32_bf16 v[172:175], a[0:3], v[68:71], v[172:175]
    buffer_load_dwordx4 v18, s[28:31], s51 offen lds
    s_bfe_u32 s85, s67, 0x40014
    s_lshl_b32 s85, s85, 7
    s_mul_i32 s51, s85, 1728
    s_add_u32 m0, s49, 102400
    ds_read_b128 v[80:83], v24 offset:12288
    ds_read_b64_tr_b16 a[52:53], v29 offset:8192
    ds_read_b64_tr_b16 a[54:55], v29 offset:8704
    v_mfma_f32_16x16x32_bf16 v[172:175], a[16:19], v[72:75], v[172:175]
    buffer_load_dwordx4 v17, s[24:27], s51 offen lds
    s_add_u32 m0, s49, 106496
    ds_read_b64_tr_b16 a[36:37], v29 offset:0
    ds_read_b64_tr_b16 a[38:39], v29 offset:512
    ds_read_b64_tr_b16 a[40:41], v106 offset:28672
    v_mfma_f32_16x16x32_bf16 v[176:179], a[20:23], v[72:75], v[176:179]
    buffer_load_dwordx4 v17, s[28:31], s51 offen lds
    s_add_u32 m0, s49, 110592
    ds_read_b64_tr_b16 a[42:43], v106 offset:29184
    ds_read_b64_tr_b16 a[56:57], v104 offset:4096
    ds_read_b64_tr_b16 a[58:59], v104 offset:4608
    v_mfma_f32_16x16x32_bf16 v[176:179], a[4:7], v[68:71], v[176:179]
    buffer_load_dwordx4 v18, s[24:27], s51 offen lds
    s_add_u32 m0, s49, 131072
    ds_read_b64_tr_b16 a[60:61], v104 offset:8192
    ds_read_b64_tr_b16 a[62:63], v104 offset:8704
    ds_read_b64_tr_b16 a[44:45], v104 offset:0
    v_mfma_f32_16x16x32_bf16 v[180:183], a[8:11], v[68:71], v[180:183]
    buffer_load_dwordx4 v18, s[28:31], s51 offen lds
    s_add_u32 m0, s49, 135168
    ds_read_b64_tr_b16 a[46:47], v104 offset:512
    ds_read_b64_tr_b16 a[64:65], v29 offset:32768
    ds_read_b64_tr_b16 a[66:67], v29 offset:33280
    v_mfma_f32_16x16x32_bf16 v[180:183], a[24:27], v[72:75], v[180:183]
    buffer_load_dwordx4 v10, s[20:23], s85 offen lds
    s_mul_i32 s51, s85, 1728
    s_add_u32 s51, s51, 128
    s_add_u32 m0, s49, 139264
    ds_read_b128 v[84:87], v23 offset:12288
    ds_read_b64_tr_b16 a[80:81], v29 offset:40960
    ds_read_b64_tr_b16 a[82:83], v29 offset:41472
    v_mfma_f32_16x16x32_bf16 v[184:187], a[28:31], v[72:75], v[184:187]
    buffer_load_dwordx4 v17, s[24:27], s51 offen lds
    s_add_u32 m0, s49, 143360
    ds_read_b128 v[88:91], v24 offset:12288
    ds_read_b64_tr_b16 a[84:85], v29 offset:45056
    ds_read_b64_tr_b16 a[86:87], v29 offset:45568
    v_mfma_f32_16x16x32_bf16 v[184:187], a[12:15], v[68:71], v[184:187]
    buffer_load_dwordx4 v17, s[28:31], s51 offen lds
    s_add_u32 m0, s49, 114688
    ds_read_b64_tr_b16 a[68:69], v29 offset:36864
    ds_read_b64_tr_b16 a[70:71], v29 offset:37376
    ds_read_b64_tr_b16 a[72:73], v104 offset:32768
    s_waitcnt lgkmcnt(15)
    v_mfma_f32_16x16x32_bf16 v[204:207], a[32:35], v[76:79], v[204:207]
    buffer_load_dwordx4 v18, s[24:27], s51 offen lds
    s_add_u32 m0, s49, 118784
    ds_read_b64_tr_b16 a[74:75], v104 offset:33280
    ds_read_b64_tr_b16 a[88:89], v104 offset:40960
    ds_read_b64_tr_b16 a[90:91], v104 offset:41472
    v_mfma_f32_16x16x32_bf16 v[204:207], a[48:51], v[80:83], v[204:207]
    buffer_load_dwordx4 v18, s[28:31], s51 offen lds
    s_mul_i32 s51, s85, 1728
    s_add_u32 s51, s51, 256
    s_add_u32 m0, s49, 122880
    ds_read_b64_tr_b16 a[92:93], v104 offset:45056
    ds_read_b64_tr_b16 a[94:95], v104 offset:45568
    ds_read_b64_tr_b16 a[76:77], v104 offset:36864
    v_mfma_f32_16x16x32_bf16 v[208:211], a[52:55], v[80:83], v[208:211]
    buffer_load_dwordx4 v17, s[24:27], s51 offen lds
    s_add_u32 m0, s49, 126976
    ds_read_b64_tr_b16 a[78:79], v104 offset:37376
    ds_read_b64_tr_b16 a[96:97], v29 offset:16384
    ds_read_b64_tr_b16 a[98:99], v29 offset:16896
    v_mfma_f32_16x16x32_bf16 v[208:211], a[36:39], v[76:79], v[208:211]
    buffer_load_dwordx4 v17, s[28:31], s51 offen lds
    ds_read_b128 v[92:95], v23 offset:12288
    ds_read_b64_tr_b16 a[112:113], v29 offset:24576
    ds_read_b64_tr_b16 a[114:115], v29 offset:25088
    v_mfma_f32_16x16x32_bf16 v[212:215], a[40:43], v[76:79], v[212:215]
    ds_read_b128 v[96:99], v24 offset:12288
    ds_read_b64_tr_b16 a[116:117], v29 offset:28672
    ds_read_b64_tr_b16 a[118:119], v29 offset:29184
    v_mfma_f32_16x16x32_bf16 v[212:215], a[56:59], v[80:83], v[212:215]
    ds_read_b64_tr_b16 a[100:101], v29 offset:20480
    ds_read_b64_tr_b16 a[102:103], v29 offset:20992
    ds_read_b64_tr_b16 a[104:105], v104 offset:16384
    s_waitcnt lgkmcnt(15)
    v_mfma_f32_16x16x32_bf16 v[216:219], a[60:63], v[80:83], v[216:219]
    ds_read_b64_tr_b16 a[106:107], v104 offset:16896
    ds_read_b64_tr_b16 a[120:121], v104 offset:24576
    ds_read_b64_tr_b16 a[122:123], v104 offset:25088
    v_mfma_f32_16x16x32_bf16 v[216:219], a[44:47], v[76:79], v[216:219]
    ds_read_b64_tr_b16 a[124:125], v104 offset:28672
    ds_read_b64_tr_b16 a[126:127], v104 offset:29184
    ds_read_b64_tr_b16 a[108:109], v104 offset:20480
    v_mfma_f32_16x16x32_bf16 v[188:191], a[64:67], v[84:87], v[188:191]
    ds_read_b64_tr_b16 a[110:111], v104 offset:20992
    v_mfma_f32_16x16x32_bf16 v[188:191], a[80:83], v[88:91], v[188:191]
    v_mfma_f32_16x16x32_bf16 v[192:195], a[84:87], v[88:91], v[192:195]
    v_mfma_f32_16x16x32_bf16 v[192:195], a[68:71], v[84:87], v[192:195]
    v_mfma_f32_16x16x32_bf16 v[196:199], a[72:75], v[84:87], v[196:199]
    v_mfma_f32_16x16x32_bf16 v[196:199], a[88:91], v[88:91], v[196:199]
    s_waitcnt vmcnt(11) lgkmcnt(0)
    s_barrier
    ds_read_b64_tr_b16 a[0:1], v29 offset:49152
    ds_read_b64_tr_b16 a[2:3], v29 offset:49664
    v_mfma_f32_16x16x32_bf16 v[200:203], a[92:95], v[88:91], v[200:203]
    s_add_u32 m0, s49, 147456
    ds_read_b128 v[52:55], v25 offset:16384
    ds_read_b64_tr_b16 a[16:17], v29 offset:57344
    ds_read_b64_tr_b16 a[18:19], v29 offset:57856
    v_mfma_f32_16x16x32_bf16 v[200:203], a[76:79], v[84:87], v[200:203]
    buffer_load_dwordx4 v18, s[24:27], s51 offen lds
    s_add_u32 m0, s49, 151552
    ds_read_b128 v[56:59], v26 offset:16384
    ds_read_b64_tr_b16 a[20:21], v29 offset:61440
    ds_read_b64_tr_b16 a[22:23], v29 offset:61952
    v_mfma_f32_16x16x32_bf16 v[172:175], a[96:99], v[92:95], v[172:175]
    buffer_load_dwordx4 v18, s[28:31], s51 offen lds
    s_bfe_u32 s86, s67, 0x40018
    s_lshl_b32 s86, s86, 7
    s_mul_i32 s51, s86, 1728
    s_add_u32 m0, s49, 155648
    ds_read_b64_tr_b16 a[4:5], v29 offset:53248
    ds_read_b64_tr_b16 a[6:7], v29 offset:53760
    ds_read_b64_tr_b16 a[8:9], v104 offset:49152
    v_mfma_f32_16x16x32_bf16 v[172:175], a[112:115], v[96:99], v[172:175]
    buffer_load_dwordx4 v17, s[24:27], s51 offen lds
    s_add_u32 m0, s49, 159744
    ds_read_b64_tr_b16 a[10:11], v104 offset:49664
    ds_read_b64_tr_b16 a[24:25], v104 offset:57344
    ds_read_b64_tr_b16 a[26:27], v104 offset:57856
    v_mfma_f32_16x16x32_bf16 v[176:179], a[116:119], v[96:99], v[176:179]
    buffer_load_dwordx4 v17, s[28:31], s51 offen lds
    s_add_u32 m0, s49, 32768
    ds_read_b64_tr_b16 a[28:29], v104 offset:61440
    ds_read_b64_tr_b16 a[30:31], v104 offset:61952
    ds_read_b64_tr_b16 a[12:13], v104 offset:53248
    v_mfma_f32_16x16x32_bf16 v[176:179], a[100:103], v[92:95], v[176:179]
    buffer_load_dwordx4 v18, s[24:27], s51 offen lds
    s_add_u32 m0, s49, 36864
    ds_read_b64_tr_b16 a[14:15], v104 offset:53760
    ds_read_b64_tr_b16 a[32:33], v30 offset:20480
    ds_read_b64_tr_b16 a[34:35], v30 offset:20992
    v_mfma_f32_16x16x32_bf16 v[180:183], a[104:107], v[92:95], v[180:183]
    buffer_load_dwordx4 v18, s[28:31], s51 offen lds
    s_add_u32 m0, s49, 40960
    ds_read_b128 v[60:63], v25 offset:16384
    ds_read_b64_tr_b16 a[48:49], v30 offset:28672
    ds_read_b64_tr_b16 a[50:51], v30 offset:29184
    v_mfma_f32_16x16x32_bf16 v[180:183], a[120:123], v[96:99], v[180:183]
    buffer_load_dwordx4 v10, s[20:23], s86 offen lds
    s_mul_i32 s51, s86, 1728
    s_add_u32 s51, s51, 128
    s_add_u32 m0, s49, 45056
    ds_read_b128 v[64:67], v26 offset:16384
    ds_read_b64_tr_b16 a[52:53], v30 offset:0
    ds_read_b64_tr_b16 a[54:55], v30 offset:512
    v_mfma_f32_16x16x32_bf16 v[184:187], a[124:127], v[96:99], v[184:187]
    buffer_load_dwordx4 v17, s[24:27], s51 offen lds
    s_add_u32 m0, s49, 16384
    ds_read_b64_tr_b16 a[36:37], v30 offset:24576
    ds_read_b64_tr_b16 a[38:39], v30 offset:25088
    ds_read_b64_tr_b16 a[40:41], v105 offset:20480
    v_mfma_f32_16x16x32_bf16 v[184:187], a[108:111], v[92:95], v[184:187]
    buffer_load_dwordx4 v17, s[28:31], s51 offen lds
    s_add_u32 m0, s49, 20480
    ds_read_b64_tr_b16 a[42:43], v105 offset:20992
    ds_read_b64_tr_b16 a[56:57], v105 offset:28672
    ds_read_b64_tr_b16 a[58:59], v105 offset:29184
    s_waitcnt lgkmcnt(15)
    v_mfma_f32_16x16x32_bf16 v[204:207], a[0:3], v[52:55], v[204:207]
    buffer_load_dwordx4 v18, s[24:27], s51 offen lds
    s_add_u32 m0, s49, 24576
    ds_read_b64_tr_b16 a[60:61], v105 offset:0
    ds_read_b64_tr_b16 a[62:63], v105 offset:512
    ds_read_b64_tr_b16 a[44:45], v105 offset:24576
    v_mfma_f32_16x16x32_bf16 v[204:207], a[16:19], v[56:59], v[204:207]
    buffer_load_dwordx4 v18, s[28:31], s51 offen lds
    s_mul_i32 s51, s86, 1728
    s_add_u32 s51, s51, 256
    s_add_u32 m0, s49, 28672
    ds_read_b64_tr_b16 a[46:47], v105 offset:25088
    ds_read_b64_tr_b16 a[64:65], v30 offset:4096
    ds_read_b64_tr_b16 a[66:67], v30 offset:4608
    v_mfma_f32_16x16x32_bf16 v[208:211], a[20:23], v[56:59], v[208:211]
    buffer_load_dwordx4 v17, s[24:27], s51 offen lds
    s_add_u32 m0, s49, 0
    ds_read_b128 v[68:71], v25 offset:16384
    ds_read_b64_tr_b16 a[80:81], v30 offset:12288
    ds_read_b64_tr_b16 a[82:83], v30 offset:12800
    v_mfma_f32_16x16x32_bf16 v[208:211], a[4:7], v[52:55], v[208:211]
    buffer_load_dwordx4 v17, s[28:31], s51 offen lds
    s_add_u32 m0, s49, 4096
    ds_read_b128 v[72:75], v26 offset:16384
    ds_read_b64_tr_b16 a[84:85], v30 offset:32768
    ds_read_b64_tr_b16 a[86:87], v30 offset:33280
    v_mfma_f32_16x16x32_bf16 v[212:215], a[8:11], v[52:55], v[212:215]
    buffer_load_dwordx4 v18, s[24:27], s51 offen lds
    ds_read_b64_tr_b16 a[68:69], v30 offset:8192
    ds_read_b64_tr_b16 a[70:71], v30 offset:8704
    ds_read_b64_tr_b16 a[72:73], v105 offset:4096
    v_mfma_f32_16x16x32_bf16 v[212:215], a[24:27], v[56:59], v[212:215]
    ds_read_b64_tr_b16 a[74:75], v105 offset:4608
    ds_read_b64_tr_b16 a[88:89], v105 offset:12288
    ds_read_b64_tr_b16 a[90:91], v105 offset:12800
    v_mfma_f32_16x16x32_bf16 v[216:219], a[28:31], v[56:59], v[216:219]
    ds_read_b64_tr_b16 a[92:93], v105 offset:32768
    ds_read_b64_tr_b16 a[94:95], v105 offset:33280
    ds_read_b64_tr_b16 a[76:77], v105 offset:8192
    s_waitcnt lgkmcnt(15)
    v_mfma_f32_16x16x32_bf16 v[216:219], a[12:15], v[52:55], v[216:219]
    ds_read_b64_tr_b16 a[78:79], v105 offset:8704
    v_mfma_f32_16x16x32_bf16 v[188:191], a[32:35], v[60:63], v[188:191]
    v_mfma_f32_16x16x32_bf16 v[188:191], a[48:51], v[64:67], v[188:191]
    v_mfma_f32_16x16x32_bf16 v[192:195], a[52:55], v[64:67], v[192:195]
    v_mfma_f32_16x16x32_bf16 v[192:195], a[36:39], v[60:63], v[192:195]
    v_mfma_f32_16x16x32_bf16 v[196:199], a[40:43], v[60:63], v[196:199]
    s_waitcnt vmcnt(12) lgkmcnt(0)
    s_barrier
    ds_read_b64_tr_b16 a[96:97], v30 offset:36864
    ds_read_b64_tr_b16 a[98:99], v30 offset:37376
    v_mfma_f32_16x16x32_bf16 v[196:199], a[56:59], v[64:67], v[196:199]
    s_add_u32 m0, s49, 8192
    ds_read_b128 v[76:79], v27 offset:4096
    ds_read_b64_tr_b16 a[112:113], v30 offset:45056
    ds_read_b64_tr_b16 a[114:115], v30 offset:45568
    v_mfma_f32_16x16x32_bf16 v[200:203], a[60:63], v[64:67], v[200:203]
    buffer_load_dwordx4 v18, s[28:31], s51 offen lds
    s_bfe_u32 s87, s67, 0x4001c
    s_lshl_b32 s87, s87, 7
    s_mul_i32 s51, s87, 1728
    s_add_u32 m0, s49, 12288
    ds_read_b128 v[80:83], v28 offset:4096
    ds_read_b64_tr_b16 a[116:117], v31 offset:0
    ds_read_b64_tr_b16 a[118:119], v31 offset:512
    v_mfma_f32_16x16x32_bf16 v[200:203], a[44:47], v[60:63], v[200:203]
    buffer_load_dwordx4 v17, s[24:27], s51 offen lds
    s_add_u32 m0, s49, 49152
    ds_read_b64_tr_b16 a[100:101], v30 offset:40960
    ds_read_b64_tr_b16 a[102:103], v30 offset:41472
    ds_read_b64_tr_b16 a[104:105], v105 offset:36864
    v_mfma_f32_16x16x32_bf16 v[172:175], a[64:67], v[68:71], v[172:175]
    buffer_load_dwordx4 v17, s[28:31], s51 offen lds
    s_add_u32 m0, s49, 53248
    ds_read_b64_tr_b16 a[106:107], v105 offset:37376
    ds_read_b64_tr_b16 a[120:121], v105 offset:45056
    ds_read_b64_tr_b16 a[122:123], v105 offset:45568
    v_mfma_f32_16x16x32_bf16 v[172:175], a[80:83], v[72:75], v[172:175]
    buffer_load_dwordx4 v18, s[24:27], s51 offen lds
    s_add_u32 m0, s49, 57344
    ds_read_b64_tr_b16 a[124:125], v106 offset:0
    ds_read_b64_tr_b16 a[126:127], v106 offset:512
    ds_read_b64_tr_b16 a[108:109], v105 offset:40960
    v_mfma_f32_16x16x32_bf16 v[176:179], a[84:87], v[72:75], v[176:179]
    buffer_load_dwordx4 v18, s[28:31], s51 offen lds
    s_add_u32 m0, s49, 61440
    ds_read_b64_tr_b16 a[110:111], v105 offset:41472
    ds_read_b64_tr_b16 a[0:1], v31 offset:8192
    ds_read_b64_tr_b16 a[2:3], v31 offset:8704
    v_mfma_f32_16x16x32_bf16 v[176:179], a[68:71], v[68:71], v[176:179]
    buffer_load_dwordx4 v10, s[20:23], s87 offen lds
    s_mul_i32 s51, s87, 1728
    s_add_u32 s51, s51, 128
    s_add_u32 m0, s49, 65536
    ds_read_b128 v[84:87], v27 offset:4096
    ds_read_b64_tr_b16 a[16:17], v30 offset:49152
    ds_read_b64_tr_b16 a[18:19], v30 offset:49664
    v_mfma_f32_16x16x32_bf16 v[180:183], a[72:75], v[68:71], v[180:183]
    buffer_load_dwordx4 v17, s[24:27], s51 offen lds
    s_add_u32 m0, s49, 69632
    ds_read_b128 v[88:91], v28 offset:4096
    ds_read_b64_tr_b16 a[20:21], v30 offset:53248
    ds_read_b64_tr_b16 a[22:23], v30 offset:53760
    v_mfma_f32_16x16x32_bf16 v[180:183], a[88:91], v[72:75], v[180:183]
    buffer_load_dwordx4 v17, s[28:31], s51 offen lds
    s_add_u32 m0, s49, 73728
    ds_read_b64_tr_b16 a[4:5], v31 offset:12288
    ds_read_b64_tr_b16 a[6:7], v31 offset:12800
    ds_read_b64_tr_b16 a[8:9], v106 offset:8192
    v_mfma_f32_16x16x32_bf16 v[184:187], a[92:95], v[72:75], v[184:187]
    buffer_load_dwordx4 v18, s[24:27], s51 offen lds
    s_add_u32 m0, s49, 77824
    ds_read_b64_tr_b16 a[10:11], v106 offset:8704
    ds_read_b64_tr_b16 a[24:25], v105 offset:49152
    ds_read_b64_tr_b16 a[26:27], v105 offset:49664
    v_mfma_f32_16x16x32_bf16 v[184:187], a[76:79], v[68:71], v[184:187]
    buffer_load_dwordx4 v18, s[28:31], s51 offen lds
    s_mul_i32 s51, s87, 1728
    s_add_u32 s51, s51, 256
    s_add_u32 m0, s49, 81920
    ds_read_b64_tr_b16 a[28:29], v105 offset:53248
    ds_read_b64_tr_b16 a[30:31], v105 offset:53760
    ds_read_b64_tr_b16 a[12:13], v106 offset:12288
    s_waitcnt lgkmcnt(15)
    v_mfma_f32_16x16x32_bf16 v[204:207], a[96:99], v[76:79], v[204:207]
    buffer_load_dwordx4 v17, s[24:27], s51 offen lds
    s_add_u32 m0, s49, 86016
    ds_read_b64_tr_b16 a[14:15], v106 offset:12800
    ds_read_b64_tr_b16 a[32:33], v30 offset:57344
    ds_read_b64_tr_b16 a[34:35], v30 offset:57856
    v_mfma_f32_16x16x32_bf16 v[204:207], a[112:115], v[80:83], v[204:207]
    buffer_load_dwordx4 v17, s[28:31], s51 offen lds
    s_add_u32 m0, s49, 90112
    ds_read_b128 v[92:95], v27 offset:4096
    ds_read_b64_tr_b16 a[48:49], v31 offset:16384
    ds_read_b64_tr_b16 a[50:51], v31 offset:16896
    v_mfma_f32_16x16x32_bf16 v[208:211], a[116:119], v[80:83], v[208:211]
    buffer_load_dwordx4 v18, s[24:27], s51 offen lds
    ds_read_b128 v[96:99], v28 offset:4096
    ds_read_b64_tr_b16 a[52:53], v31 offset:20480
    ds_read_b64_tr_b16 a[54:55], v31 offset:20992
    v_mfma_f32_16x16x32_bf16 v[208:211], a[100:103], v[76:79], v[208:211]
    ds_read_b64_tr_b16 a[36:37], v30 offset:61440
    ds_read_b64_tr_b16 a[38:39], v30 offset:61952
    ds_read_b64_tr_b16 a[40:41], v105 offset:57344
    v_mfma_f32_16x16x32_bf16 v[212:215], a[104:107], v[76:79], v[212:215]
    ds_read_b64_tr_b16 a[42:43], v105 offset:57856
    ds_read_b64_tr_b16 a[56:57], v106 offset:16384
    ds_read_b64_tr_b16 a[58:59], v106 offset:16896
    v_mfma_f32_16x16x32_bf16 v[212:215], a[120:123], v[80:83], v[212:215]
    ds_read_b64_tr_b16 a[60:61], v106 offset:20480
    ds_read_b64_tr_b16 a[62:63], v106 offset:20992
    ds_read_b64_tr_b16 a[44:45], v105 offset:61440
    v_mfma_f32_16x16x32_bf16 v[216:219], a[124:127], v[80:83], v[216:219]
    ds_read_b64_tr_b16 a[46:47], v105 offset:61952
    v_mfma_f32_16x16x32_bf16 v[216:219], a[108:111], v[76:79], v[216:219]
    s_waitcnt lgkmcnt(15)
    v_mfma_f32_16x16x32_bf16 v[188:191], a[0:3], v[84:87], v[188:191]
    v_mfma_f32_16x16x32_bf16 v[188:191], a[16:19], v[88:91], v[188:191]
    v_mfma_f32_16x16x32_bf16 v[192:195], a[20:23], v[88:91], v[192:195]
    v_mfma_f32_16x16x32_bf16 v[192:195], a[4:7], v[84:87], v[192:195]
    s_waitcnt vmcnt(12) lgkmcnt(0)
    s_barrier
    ds_read_b64_tr_b16 a[64:65], v31 offset:24576
    ds_read_b64_tr_b16 a[66:67], v31 offset:25088
    v_mfma_f32_16x16x32_bf16 v[196:199], a[8:11], v[84:87], v[196:199]
    s_add_u32 m0, s49, 94208
    ds_read_b128 v[52:55], v23 offset:40960
    ds_read_b64_tr_b16 a[80:81], v29 offset:32768
    ds_read_b64_tr_b16 a[82:83], v29 offset:33280
    v_mfma_f32_16x16x32_bf16 v[196:199], a[24:27], v[88:91], v[196:199]
    buffer_load_dwordx4 v18, s[28:31], s51 offen lds
    s_bfe_u32 s88, s79, 0x40000
    s_lshl_b32 s88, s88, 7
    s_mul_i32 s51, s88, 1728
    s_add_u32 m0, s49, 98304
    ds_read_b128 v[56:59], v24 offset:40960
    ds_read_b64_tr_b16 a[84:85], v29 offset:36864
    ds_read_b64_tr_b16 a[86:87], v29 offset:37376
    v_mfma_f32_16x16x32_bf16 v[200:203], a[28:31], v[88:91], v[200:203]
    buffer_load_dwordx4 v17, s[24:27], s51 offen lds
    s_add_u32 m0, s49, 102400
    ds_read_b64_tr_b16 a[68:69], v31 offset:28672
    ds_read_b64_tr_b16 a[70:71], v31 offset:29184
    ds_read_b64_tr_b16 a[72:73], v106 offset:24576
    v_mfma_f32_16x16x32_bf16 v[200:203], a[12:15], v[84:87], v[200:203]
    buffer_load_dwordx4 v17, s[28:31], s51 offen lds
    s_add_u32 m0, s49, 106496
    ds_read_b64_tr_b16 a[74:75], v106 offset:25088
    ds_read_b64_tr_b16 a[88:89], v104 offset:32768
    ds_read_b64_tr_b16 a[90:91], v104 offset:33280
    v_mfma_f32_16x16x32_bf16 v[172:175], a[32:35], v[92:95], v[172:175]
    buffer_load_dwordx4 v18, s[24:27], s51 offen lds
    s_add_u32 m0, s49, 110592
    ds_read_b64_tr_b16 a[92:93], v104 offset:36864
    ds_read_b64_tr_b16 a[94:95], v104 offset:37376
    ds_read_b64_tr_b16 a[76:77], v106 offset:28672
    v_mfma_f32_16x16x32_bf16 v[172:175], a[48:51], v[96:99], v[172:175]
    buffer_load_dwordx4 v18, s[28:31], s51 offen lds
    s_add_u32 m0, s49, 114688
    ds_read_b64_tr_b16 a[78:79], v106 offset:29184
    ds_read_b64_tr_b16 a[96:97], v29 offset:45056
    ds_read_b64_tr_b16 a[98:99], v29 offset:45568
    v_mfma_f32_16x16x32_bf16 v[176:179], a[52:55], v[96:99], v[176:179]
    buffer_load_dwordx4 v10, s[20:23], s88 offen lds
    s_mul_i32 s51, s88, 1728
    s_add_u32 s51, s51, 128
    s_add_u32 m0, s49, 118784
    ds_read_b128 v[60:63], v23 offset:40960
    ds_read_b64_tr_b16 a[112:113], v29 offset:20480
    ds_read_b64_tr_b16 a[114:115], v29 offset:20992
    v_mfma_f32_16x16x32_bf16 v[176:179], a[36:39], v[92:95], v[176:179]
    buffer_load_dwordx4 v17, s[24:27], s51 offen lds
    s_add_u32 m0, s49, 122880
    ds_read_b128 v[64:67], v24 offset:40960
    ds_read_b64_tr_b16 a[116:117], v29 offset:24576
    ds_read_b64_tr_b16 a[118:119], v29 offset:25088
    v_mfma_f32_16x16x32_bf16 v[180:183], a[40:43], v[92:95], v[180:183]
    buffer_load_dwordx4 v17, s[28:31], s51 offen lds
    s_add_u32 m0, s49, 126976
    ds_read_b64_tr_b16 a[100:101], v29 offset:16384
    ds_read_b64_tr_b16 a[102:103], v29 offset:16896
    ds_read_b64_tr_b16 a[104:105], v104 offset:45056
    v_mfma_f32_16x16x32_bf16 v[180:183], a[56:59], v[96:99], v[180:183]
    buffer_load_dwordx4 v18, s[24:27], s51 offen lds
    s_add_u32 m0, s49, 131072
    ds_read_b64_tr_b16 a[106:107], v104 offset:45568
    ds_read_b64_tr_b16 a[120:121], v104 offset:20480
    ds_read_b64_tr_b16 a[122:123], v104 offset:20992
    v_mfma_f32_16x16x32_bf16 v[184:187], a[60:63], v[96:99], v[184:187]
    buffer_load_dwordx4 v18, s[28:31], s51 offen lds
    s_mul_i32 s51, s88, 1728
    s_add_u32 s51, s51, 256
    s_add_u32 m0, s49, 135168
    ds_read_b64_tr_b16 a[124:125], v104 offset:24576
    ds_read_b64_tr_b16 a[126:127], v104 offset:25088
    ds_read_b64_tr_b16 a[108:109], v104 offset:16384
    v_mfma_f32_16x16x32_bf16 v[184:187], a[44:47], v[92:95], v[184:187]
    buffer_load_dwordx4 v17, s[24:27], s51 offen lds
    s_add_u32 m0, s49, 139264
    ds_read_b64_tr_b16 a[110:111], v104 offset:16896
    s_waitcnt lgkmcnt(15)
    v_mfma_f32_16x16x32_bf16 v[204:207], a[64:67], v[52:55], v[204:207]
    buffer_load_dwordx4 v17, s[28:31], s51 offen lds
    s_add_u32 m0, s49, 143360
    ds_read_b64_tr_b16 a[0:1], v29 offset:28672
    ds_read_b64_tr_b16 a[2:3], v29 offset:29184
    ds_read_b128 v[68:71], v23 offset:40960
    v_mfma_f32_16x16x32_bf16 v[204:207], a[80:83], v[56:59], v[204:207]
    buffer_load_dwordx4 v18, s[24:27], s51 offen lds
    ds_read_b64_tr_b16 a[16:17], v29 offset:4096
    ds_read_b64_tr_b16 a[18:19], v29 offset:4608
    ds_read_b128 v[72:75], v24 offset:40960
    v_mfma_f32_16x16x32_bf16 v[208:211], a[84:87], v[56:59], v[208:211]
    ds_read_b64_tr_b16 a[20:21], v29 offset:8192
    ds_read_b64_tr_b16 a[22:23], v29 offset:8704
    ds_read_b64_tr_b16 a[4:5], v29 offset:0
    v_mfma_f32_16x16x32_bf16 v[208:211], a[68:71], v[52:55], v[208:211]
    ds_read_b64_tr_b16 a[6:7], v29 offset:512
    ds_read_b64_tr_b16 a[8:9], v104 offset:28672
    ds_read_b64_tr_b16 a[10:11], v104 offset:29184
    v_mfma_f32_16x16x32_bf16 v[212:215], a[72:75], v[52:55], v[212:215]
    ds_read_b64_tr_b16 a[24:25], v104 offset:4096
    ds_read_b64_tr_b16 a[26:27], v104 offset:4608
    ds_read_b64_tr_b16 a[28:29], v104 offset:8192
    v_mfma_f32_16x16x32_bf16 v[212:215], a[88:91], v[56:59], v[212:215]
    ds_read_b64_tr_b16 a[30:31], v104 offset:8704
    ds_read_b64_tr_b16 a[12:13], v104 offset:0
    ds_read_b64_tr_b16 a[14:15], v104 offset:512
    v_mfma_f32_16x16x32_bf16 v[216:219], a[92:95], v[56:59], v[216:219]
    v_mfma_f32_16x16x32_bf16 v[216:219], a[76:79], v[52:55], v[216:219]
    v_mfma_f32_16x16x32_bf16 v[188:191], a[96:99], v[60:63], v[188:191]
    s_waitcnt lgkmcnt(15)
    v_mfma_f32_16x16x32_bf16 v[188:191], a[112:115], v[64:67], v[188:191]
    v_mfma_f32_16x16x32_bf16 v[192:195], a[116:119], v[64:67], v[192:195]
    s_waitcnt vmcnt(12) lgkmcnt(0)
    s_barrier
    buffer_load_dword v8, v9, s[44:47], s49 offen sc1
    ds_read_b64_tr_b16 a[32:33], v29 offset:12288
    ds_read_b64_tr_b16 a[34:35], v29 offset:12800
    v_mfma_f32_16x16x32_bf16 v[192:195], a[100:103], v[60:63], v[192:195]
    s_add_u32 m0, s49, 147456
    ds_read_b128 v[76:79], v23 offset:61440
    ds_read_b64_tr_b16 a[48:49], v29 offset:53248
    ds_read_b64_tr_b16 a[50:51], v29 offset:53760
    v_mfma_f32_16x16x32_bf16 v[196:199], a[104:107], v[60:63], v[196:199]
    buffer_load_dwordx4 v18, s[28:31], s51 offen lds
    s_bfe_u32 s89, s79, 0x40004
    s_lshl_b32 s89, s89, 7
    s_mul_i32 s51, s89, 1728
    s_add_u32 m0, s49, 151552
    ds_read_b128 v[80:83], v24 offset:61440
    ds_read_b64_tr_b16 a[52:53], v29 offset:57344
    ds_read_b64_tr_b16 a[54:55], v29 offset:57856
    v_mfma_f32_16x16x32_bf16 v[196:199], a[120:123], v[64:67], v[196:199]
    buffer_load_dwordx4 v17, s[24:27], s51 offen lds
    s_add_u32 m0, s49, 155648
    ds_read_b64_tr_b16 a[36:37], v29 offset:49152
    ds_read_b64_tr_b16 a[38:39], v29 offset:49664
    ds_read_b64_tr_b16 a[40:41], v104 offset:12288
    v_mfma_f32_16x16x32_bf16 v[200:203], a[124:127], v[64:67], v[200:203]
    buffer_load_dwordx4 v17, s[28:31], s51 offen lds
    s_add_u32 m0, s49, 159744
    ds_read_b64_tr_b16 a[42:43], v104 offset:12800
    ds_read_b64_tr_b16 a[56:57], v104 offset:53248
    ds_read_b64_tr_b16 a[58:59], v104 offset:53760
    v_mfma_f32_16x16x32_bf16 v[200:203], a[108:111], v[60:63], v[200:203]
    buffer_load_dwordx4 v18, s[24:27], s51 offen lds
    s_add_u32 m0, s49, 16384
    ds_read_b64_tr_b16 a[60:61], v104 offset:57344
    ds_read_b64_tr_b16 a[62:63], v104 offset:57856
    ds_read_b64_tr_b16 a[44:45], v104 offset:49152
    v_mfma_f32_16x16x32_bf16 v[172:175], a[0:3], v[68:71], v[172:175]
    buffer_load_dwordx4 v18, s[28:31], s51 offen lds
    s_add_u32 m0, s49, 20480
    ds_read_b64_tr_b16 a[46:47], v104 offset:49664
    ds_read_b64_tr_b16 a[64:65], v30 offset:0
    ds_read_b64_tr_b16 a[66:67], v30 offset:512
    v_mfma_f32_16x16x32_bf16 v[172:175], a[16:19], v[72:75], v[172:175]
    buffer_load_dwordx4 v10, s[20:23], s89 offen lds
    s_mul_i32 s51, s89, 1728
    s_add_u32 s51, s51, 128
    s_add_u32 m0, s49, 24576
    ds_read_b128 v[84:87], v23 offset:61440
    ds_read_b64_tr_b16 a[80:81], v30 offset:8192
    ds_read_b64_tr_b16 a[82:83], v30 offset:8704
    v_mfma_f32_16x16x32_bf16 v[176:179], a[20:23], v[72:75], v[176:179]
    buffer_load_dwordx4 v17, s[24:27], s51 offen lds
    s_add_u32 m0, s49, 28672
    ds_read_b128 v[88:91], v24 offset:61440
    ds_read_b64_tr_b16 a[84:85], v30 offset:12288
    ds_read_b64_tr_b16 a[86:87], v30 offset:12800
    v_mfma_f32_16x16x32_bf16 v[176:179], a[4:7], v[68:71], v[176:179]
    buffer_load_dwordx4 v17, s[28:31], s51 offen lds
    s_add_u32 m0, s49, 32768
    ds_read_b64_tr_b16 a[68:69], v30 offset:4096
    ds_read_b64_tr_b16 a[70:71], v30 offset:4608
    ds_read_b64_tr_b16 a[72:73], v105 offset:0
    v_mfma_f32_16x16x32_bf16 v[180:183], a[8:11], v[68:71], v[180:183]
    buffer_load_dwordx4 v18, s[24:27], s51 offen lds
    s_add_u32 m0, s49, 36864
    ds_read_b64_tr_b16 a[74:75], v105 offset:512
    ds_read_b64_tr_b16 a[88:89], v105 offset:8192
    ds_read_b64_tr_b16 a[90:91], v105 offset:8704
    v_mfma_f32_16x16x32_bf16 v[180:183], a[24:27], v[72:75], v[180:183]
    buffer_load_dwordx4 v18, s[28:31], s51 offen lds
    s_mul_i32 s51, s89, 1728
    s_add_u32 s51, s51, 256
    s_add_u32 m0, s49, 40960
    ds_read_b64_tr_b16 a[92:93], v105 offset:12288
    ds_read_b64_tr_b16 a[94:95], v105 offset:12800
    ds_read_b64_tr_b16 a[76:77], v105 offset:4096
    v_mfma_f32_16x16x32_bf16 v[184:187], a[28:31], v[72:75], v[184:187]
    buffer_load_dwordx4 v17, s[24:27], s51 offen lds
    s_add_u32 m0, s49, 45056
    ds_read_b64_tr_b16 a[78:79], v105 offset:4608
    v_mfma_f32_16x16x32_bf16 v[184:187], a[12:15], v[68:71], v[184:187]
    buffer_load_dwordx4 v17, s[28:31], s51 offen lds
    s_waitcnt lgkmcnt(15)
    v_mfma_f32_16x16x32_bf16 v[204:207], a[32:35], v[76:79], v[204:207]
    ds_read_b64_tr_b16 a[96:97], v30 offset:16384
    ds_read_b64_tr_b16 a[98:99], v30 offset:16896
    ds_read_b128 v[92:95], v23 offset:61440
    v_mfma_f32_16x16x32_bf16 v[204:207], a[48:51], v[80:83], v[204:207]
    ds_read_b64_tr_b16 a[112:113], v30 offset:24576
    ds_read_b64_tr_b16 a[114:115], v30 offset:25088
    ds_read_b128 v[96:99], v24 offset:61440
    v_mfma_f32_16x16x32_bf16 v[208:211], a[52:55], v[80:83], v[208:211]
    ds_read_b64_tr_b16 a[116:117], v30 offset:28672
    ds_read_b64_tr_b16 a[118:119], v30 offset:29184
    ds_read_b64_tr_b16 a[100:101], v30 offset:20480
    v_mfma_f32_16x16x32_bf16 v[208:211], a[36:39], v[76:79], v[208:211]
    ds_read_b64_tr_b16 a[102:103], v30 offset:20992
    ds_read_b64_tr_b16 a[104:105], v105 offset:16384
    ds_read_b64_tr_b16 a[106:107], v105 offset:16896
    v_mfma_f32_16x16x32_bf16 v[212:215], a[40:43], v[76:79], v[212:215]
    ds_read_b64_tr_b16 a[120:121], v105 offset:24576
    ds_read_b64_tr_b16 a[122:123], v105 offset:25088
    ds_read_b64_tr_b16 a[124:125], v105 offset:28672
    v_mfma_f32_16x16x32_bf16 v[212:215], a[56:59], v[80:83], v[212:215]
    ds_read_b64_tr_b16 a[126:127], v105 offset:29184
    ds_read_b64_tr_b16 a[108:109], v105 offset:20480
    ds_read_b64_tr_b16 a[110:111], v105 offset:20992
    v_mfma_f32_16x16x32_bf16 v[216:219], a[60:63], v[80:83], v[216:219]
    v_mfma_f32_16x16x32_bf16 v[216:219], a[44:47], v[76:79], v[216:219]
    v_mfma_f32_16x16x32_bf16 v[188:191], a[64:67], v[84:87], v[188:191]
    s_waitcnt lgkmcnt(15)
    v_mfma_f32_16x16x32_bf16 v[188:191], a[80:83], v[88:91], v[188:191]
    v_mfma_f32_16x16x32_bf16 v[192:195], a[84:87], v[88:91], v[192:195]
    s_waitcnt vmcnt(11) lgkmcnt(0)
    s_barrier
    ds_read_b64_tr_b16 a[0:1], v30 offset:32768
    ds_read_b64_tr_b16 a[2:3], v30 offset:33280
    v_mfma_f32_16x16x32_bf16 v[192:195], a[68:71], v[84:87], v[192:195]
    s_add_u32 m0, s49, 0
    ds_read_b128 v[52:55], v25 offset:49152
    ds_read_b64_tr_b16 a[16:17], v30 offset:40960
    ds_read_b64_tr_b16 a[18:19], v30 offset:41472
    v_mfma_f32_16x16x32_bf16 v[196:199], a[72:75], v[84:87], v[196:199]
    buffer_load_dwordx4 v18, s[24:27], s51 offen lds
    s_add_u32 m0, s49, 4096
    ds_read_b128 v[56:59], v26 offset:49152
    ds_read_b64_tr_b16 a[20:21], v30 offset:45056
    ds_read_b64_tr_b16 a[22:23], v30 offset:45568
    v_mfma_f32_16x16x32_bf16 v[196:199], a[88:91], v[88:91], v[196:199]
    buffer_load_dwordx4 v18, s[28:31], s51 offen lds
    s_mul_i32 s55, s4, 40
    s_add_u32 m0, s50, 65536
    ds_read_b64_tr_b16 a[4:5], v30 offset:36864
    ds_read_b64_tr_b16 a[6:7], v30 offset:37376
    ds_read_b64_tr_b16 a[8:9], v105 offset:32768
    v_mfma_f32_16x16x32_bf16 v[200:203], a[92:95], v[88:91], v[200:203]
    buffer_load_dwordx4 v19, s[32:35], s55 offen lds
    s_add_u32 m0, s50, 66560
    ds_read_b64_tr_b16 a[10:11], v105 offset:33280
    ds_read_b64_tr_b16 a[24:25], v105 offset:40960
    ds_read_b64_tr_b16 a[26:27], v105 offset:41472
    v_mfma_f32_16x16x32_bf16 v[200:203], a[76:79], v[84:87], v[200:203]
    buffer_load_dwordx4 v20, s[32:35], s55 offen lds
    s_add_u32 m0, s50, 67584
    ds_read_b64_tr_b16 a[28:29], v105 offset:45056
    ds_read_b64_tr_b16 a[30:31], v105 offset:45568
    ds_read_b64_tr_b16 a[12:13], v105 offset:36864
    v_mfma_f32_16x16x32_bf16 v[172:175], a[96:99], v[92:95], v[172:175]
    buffer_load_dwordx4 v21, s[32:35], s55 offen lds
    s_add_u32 m0, s50, 68608
    ds_read_b64_tr_b16 a[14:15], v105 offset:37376
    ds_read_b64_tr_b16 a[32:33], v30 offset:53248
    ds_read_b64_tr_b16 a[34:35], v30 offset:53760
    v_mfma_f32_16x16x32_bf16 v[172:175], a[112:115], v[96:99], v[172:175]
    buffer_load_dwordx4 v22, s[32:35], s55 offen lds
    s_mul_i32 s55, s5, 40
    s_add_u32 m0, s50, 81920
    ds_read_b128 v[60:63], v25 offset:49152
    ds_read_b64_tr_b16 a[48:49], v30 offset:61440
    ds_read_b64_tr_b16 a[50:51], v30 offset:61952
    v_mfma_f32_16x16x32_bf16 v[176:179], a[116:119], v[96:99], v[176:179]
    buffer_load_dwordx4 v19, s[32:35], s55 offen lds
    s_add_u32 m0, s50, 82944
    ds_read_b128 v[64:67], v26 offset:49152
    ds_read_b64_tr_b16 a[52:53], v31 offset:0
    ds_read_b64_tr_b16 a[54:55], v31 offset:512
    v_mfma_f32_16x16x32_bf16 v[176:179], a[100:103], v[92:95], v[176:179]
    buffer_load_dwordx4 v20, s[32:35], s55 offen lds
    s_add_u32 m0, s50, 83968
    ds_read_b64_tr_b16 a[36:37], v30 offset:57344
    ds_read_b64_tr_b16 a[38:39], v30 offset:57856
    ds_read_b64_tr_b16 a[40:41], v105 offset:53248
    v_mfma_f32_16x16x32_bf16 v[180:183], a[104:107], v[92:95], v[180:183]
    buffer_load_dwordx4 v21, s[32:35], s55 offen lds
    s_add_u32 m0, s50, 84992
    ds_read_b64_tr_b16 a[42:43], v105 offset:53760
    ds_read_b64_tr_b16 a[56:57], v105 offset:61440
    ds_read_b64_tr_b16 a[58:59], v105 offset:61952
    v_mfma_f32_16x16x32_bf16 v[180:183], a[120:123], v[96:99], v[180:183]
    buffer_load_dwordx4 v22, s[32:35], s55 offen lds
    s_mul_i32 s55, s6, 40
    s_add_u32 m0, s50, 49152
    ds_read_b64_tr_b16 a[60:61], v106 offset:0
    ds_read_b64_tr_b16 a[62:63], v106 offset:512
    ds_read_b64_tr_b16 a[44:45], v105 offset:57344
    v_mfma_f32_16x16x32_bf16 v[184:187], a[124:127], v[96:99], v[184:187]
    buffer_load_dwordx4 v19, s[32:35], s55 offen lds
    s_add_u32 m0, s50, 50176
    ds_read_b64_tr_b16 a[46:47], v105 offset:57856
    v_mfma_f32_16x16x32_bf16 v[184:187], a[108:111], v[92:95], v[184:187]
    buffer_load_dwordx4 v20, s[32:35], s55 offen lds
    s_add_u32 m0, s50, 51200
    s_waitcnt lgkmcnt(15)
    v_mfma_f32_16x16x32_bf16 v[204:207], a[0:3], v[52:55], v[204:207]
    buffer_load_dwordx4 v21, s[32:35], s55 offen lds
    s_add_u32 m0, s50, 52224
    ds_read_b64_tr_b16 a[64:65], v31 offset:4096
    ds_read_b64_tr_b16 a[66:67], v31 offset:4608
    ds_read_b128 v[68:71], v25 offset:49152
    v_mfma_f32_16x16x32_bf16 v[204:207], a[16:19], v[56:59], v[204:207]
    buffer_load_dwordx4 v22, s[32:35], s55 offen lds
    ds_read_b64_tr_b16 a[80:81], v31 offset:12288
    ds_read_b64_tr_b16 a[82:83], v31 offset:12800
    ds_read_b128 v[72:75], v26 offset:49152
    v_mfma_f32_16x16x32_bf16 v[208:211], a[20:23], v[56:59], v[208:211]
    ds_read_b64_tr_b16 a[84:85], v31 offset:16384
    ds_read_b64_tr_b16 a[86:87], v31 offset:16896
    ds_read_b64_tr_b16 a[68:69], v31 offset:8192
    v_mfma_f32_16x16x32_bf16 v[208:211], a[4:7], v[52:55], v[208:211]
    ds_read_b64_tr_b16 a[70:71], v31 offset:8704
    ds_read_b64_tr_b16 a[72:73], v106 offset:4096
    ds_read_b64_tr_b16 a[74:75], v106 offset:4608
    v_mfma_f32_16x16x32_bf16 v[212:215], a[8:11], v[52:55], v[212:215]
    ds_read_b64_tr_b16 a[88:89], v106 offset:12288
    ds_read_b64_tr_b16 a[90:91], v106 offset:12800
    ds_read_b64_tr_b16 a[92:93], v106 offset:16384
    v_mfma_f32_16x16x32_bf16 v[212:215], a[24:27], v[56:59], v[212:215]
    ds_read_b64_tr_b16 a[94:95], v106 offset:16896
    ds_read_b64_tr_b16 a[76:77], v106 offset:8192
    ds_read_b64_tr_b16 a[78:79], v106 offset:8704
    v_mfma_f32_16x16x32_bf16 v[216:219], a[28:31], v[56:59], v[216:219]
    v_mfma_f32_16x16x32_bf16 v[216:219], a[12:15], v[52:55], v[216:219]
    v_mfma_f32_16x16x32_bf16 v[188:191], a[32:35], v[60:63], v[188:191]
    s_waitcnt lgkmcnt(15)
    v_mfma_f32_16x16x32_bf16 v[188:191], a[48:51], v[64:67], v[188:191]
    v_mfma_f32_16x16x32_bf16 v[192:195], a[52:55], v[64:67], v[192:195]
    v_readfirstlane_b32 s52, v8
    s_nop 0
    s_or_b32 s52, s52, s48
    s_cmp_eq_u32 s52, 0
    s_cbranch_scc1 L_go_c2s
L_go_c2:
    s_waitcnt vmcnt(12) lgkmcnt(0)
    s_barrier
    ds_read_b64_tr_b16 a[96:97], v31 offset:20480
    ds_read_b64_tr_b16 a[98:99], v31 offset:20992
    v_mfma_f32_16x16x32_bf16 v[192:195], a[36:39], v[60:63], v[192:195]
    s_mul_i32 s55, s7, 40
    s_add_u32 m0, s50, 98304
    ds_read_b128 v[76:79], v23 offset:20480
    ds_read_b64_tr_b16 a[112:113], v31 offset:28672
    ds_read_b64_tr_b16 a[114:115], v31 offset:29184
    v_mfma_f32_16x16x32_bf16 v[196:199], a[40:43], v[60:63], v[196:199]
    buffer_load_dwordx4 v19, s[32:35], s55 offen lds
    s_add_u32 m0, s50, 99328
    ds_read_b128 v[80:83], v24 offset:20480
    ds_read_b64_tr_b16 a[116:117], v29 offset:16384
    ds_read_b64_tr_b16 a[118:119], v29 offset:16896
    v_mfma_f32_16x16x32_bf16 v[196:199], a[56:59], v[64:67], v[196:199]
    buffer_load_dwordx4 v20, s[32:35], s55 offen lds
    s_add_u32 m0, s50, 100352
    ds_read_b64_tr_b16 a[100:101], v31 offset:24576
    ds_read_b64_tr_b16 a[102:103], v31 offset:25088
    ds_read_b64_tr_b16 a[104:105], v106 offset:20480
    v_mfma_f32_16x16x32_bf16 v[200:203], a[60:63], v[64:67], v[200:203]
    buffer_load_dwordx4 v21, s[32:35], s55 offen lds
    s_add_u32 m0, s50, 101376
    ds_read_b64_tr_b16 a[106:107], v106 offset:20992
    ds_read_b64_tr_b16 a[120:121], v106 offset:28672
    ds_read_b64_tr_b16 a[122:123], v106 offset:29184
    v_mfma_f32_16x16x32_bf16 v[200:203], a[44:47], v[60:63], v[200:203]
    buffer_load_dwordx4 v22, s[32:35], s55 offen lds
    s_mul_i32 s55, s8, 40
    s_add_u32 m0, s50, 131072
    ds_read_b64_tr_b16 a[124:125], v104 offset:16384
    ds_read_b64_tr_b16 a[126:127], v104 offset:16896
    ds_read_b64_tr_b16 a[108:109], v106 offset:24576
    v_mfma_f32_16x16x32_bf16 v[172:175], a[64:67], v[68:71], v[172:175]
    buffer_load_dwordx4 v19, s[32:35], s55 offen lds
    s_add_u32 m0, s50, 132096
    ds_read_b64_tr_b16 a[110:111], v106 offset:25088
    ds_read_b64_tr_b16 a[0:1], v29 offset:24576
    ds_read_b64_tr_b16 a[2:3], v29 offset:25088
    v_mfma_f32_16x16x32_bf16 v[172:175], a[80:83], v[72:75], v[172:175]
    buffer_load_dwordx4 v20, s[32:35], s55 offen lds
    s_add_u32 m0, s50, 133120
    ds_read_b128 v[84:87], v23 offset:20480
    ds_read_b64_tr_b16 a[16:17], v29 offset:32768
    ds_read_b64_tr_b16 a[18:19], v29 offset:33280
    v_mfma_f32_16x16x32_bf16 v[176:179], a[84:87], v[72:75], v[176:179]
    buffer_load_dwordx4 v21, s[32:35], s55 offen lds
    s_add_u32 m0, s50, 134144
    ds_read_b128 v[88:91], v24 offset:20480
    ds_read_b64_tr_b16 a[20:21], v29 offset:36864
    ds_read_b64_tr_b16 a[22:23], v29 offset:37376
    v_mfma_f32_16x16x32_bf16 v[176:179], a[68:71], v[68:71], v[176:179]
    buffer_load_dwordx4 v22, s[32:35], s55 offen lds
    s_mul_i32 s55, s9, 40
    s_add_u32 m0, s50, 114688
    ds_read_b64_tr_b16 a[4:5], v29 offset:28672
    ds_read_b64_tr_b16 a[6:7], v29 offset:29184
    ds_read_b64_tr_b16 a[8:9], v104 offset:24576
    v_mfma_f32_16x16x32_bf16 v[180:183], a[72:75], v[68:71], v[180:183]
    buffer_load_dwordx4 v19, s[32:35], s55 offen lds
    s_add_u32 m0, s50, 115712
    ds_read_b64_tr_b16 a[10:11], v104 offset:25088
    ds_read_b64_tr_b16 a[24:25], v104 offset:32768
    ds_read_b64_tr_b16 a[26:27], v104 offset:33280
    v_mfma_f32_16x16x32_bf16 v[180:183], a[88:91], v[72:75], v[180:183]
    buffer_load_dwordx4 v20, s[32:35], s55 offen lds
    s_add_u32 m0, s50, 116736
    ds_read_b64_tr_b16 a[28:29], v104 offset:36864
    ds_read_b64_tr_b16 a[30:31], v104 offset:37376
    ds_read_b64_tr_b16 a[12:13], v104 offset:28672
    v_mfma_f32_16x16x32_bf16 v[184:187], a[92:95], v[72:75], v[184:187]
    buffer_load_dwordx4 v21, s[32:35], s55 offen lds
    s_add_u32 m0, s50, 117760
    ds_read_b64_tr_b16 a[14:15], v104 offset:29184
    v_mfma_f32_16x16x32_bf16 v[184:187], a[76:79], v[68:71], v[184:187]
    buffer_load_dwordx4 v22, s[32:35], s55 offen lds
    s_waitcnt lgkmcnt(15)
    v_mfma_f32_16x16x32_bf16 v[204:207], a[96:99], v[76:79], v[204:207]
    ds_read_b64_tr_b16 a[32:33], v29 offset:40960
    ds_read_b64_tr_b16 a[34:35], v29 offset:41472
    ds_read_b128 v[92:95], v23 offset:20480
    v_mfma_f32_16x16x32_bf16 v[204:207], a[112:115], v[80:83], v[204:207]
    ds_read_b64_tr_b16 a[48:49], v29 offset:0
    ds_read_b64_tr_b16 a[50:51], v29 offset:512
    ds_read_b128 v[96:99], v24 offset:20480
    v_mfma_f32_16x16x32_bf16 v[208:211], a[116:119], v[80:83], v[208:211]
    ds_read_b64_tr_b16 a[52:53], v29 offset:4096
    ds_read_b64_tr_b16 a[54:55], v29 offset:4608
    ds_read_b64_tr_b16 a[36:37], v29 offset:45056
    v_mfma_f32_16x16x32_bf16 v[208:211], a[100:103], v[76:79], v[208:211]
    ds_read_b64_tr_b16 a[38:39], v29 offset:45568
    ds_read_b64_tr_b16 a[40:41], v104 offset:40960
    ds_read_b64_tr_b16 a[42:43], v104 offset:41472
    v_mfma_f32_16x16x32_bf16 v[212:215], a[104:107], v[76:79], v[212:215]
    ds_read_b64_tr_b16 a[56:57], v104 offset:0
    ds_read_b64_tr_b16 a[58:59], v104 offset:512
    ds_read_b64_tr_b16 a[60:61], v104 offset:4096
    v_mfma_f32_16x16x32_bf16 v[212:215], a[120:123], v[80:83], v[212:215]
    ds_read_b64_tr_b16 a[62:63], v104 offset:4608
    ds_read_b64_tr_b16 a[44:45], v104 offset:45056
    ds_read_b64_tr_b16 a[46:47], v104 offset:45568
    v_mfma_f32_16x16x32_bf16 v[216:219], a[124:127], v[80:83], v[216:219]
    v_mfma_f32_16x16x32_bf16 v[216:219], a[108:111], v[76:79], v[216:219]
    v_mfma_f32_16x16x32_bf16 v[188:191], a[0:3], v[84:87], v[188:191]
    s_waitcnt lgkmcnt(15)
    v_mfma_f32_16x16x32_bf16 v[188:191], a[16:19], v[88:91], v[188:191]
    v_mfma_f32_16x16x32_bf16 v[192:195], a[20:23], v[88:91], v[192:195]
    v_mfma_f32_16x16x32_bf16 v[192:195], a[4:7], v[84:87], v[192:195]
    v_mfma_f32_16x16x32_bf16 v[196:199], a[8:11], v[84:87], v[196:199]
    v_mfma_f32_16x16x32_bf16 v[196:199], a[24:27], v[88:91], v[196:199]
    v_mfma_f32_16x16x32_bf16 v[200:203], a[28:31], v[88:91], v[200:203]
    v_mfma_f32_16x16x32_bf16 v[200:203], a[12:15], v[84:87], v[200:203]
    v_mfma_f32_16x16x32_bf16 v[172:175], a[32:35], v[92:95], v[172:175]
    s_waitcnt lgkmcnt(12)
    v_mfma_f32_16x16x32_bf16 v[172:175], a[48:51], v[96:99], v[172:175]
    s_waitcnt lgkmcnt(10)
    v_mfma_f32_16x16x32_bf16 v[176:179], a[52:55], v[96:99], v[176:179]
    s_waitcnt lgkmcnt(8)
    v_mfma_f32_16x16x32_bf16 v[176:179], a[36:39], v[92:95], v[176:179]
    s_waitcnt lgkmcnt(6)
    v_mfma_f32_16x16x32_bf16 v[180:183], a[40:43], v[92:95], v[180:183]
    s_waitcnt lgkmcnt(4)
    v_mfma_f32_16x16x32_bf16 v[180:183], a[56:59], v[96:99], v[180:183]
    s_waitcnt lgkmcnt(2)
    v_mfma_f32_16x16x32_bf16 v[184:187], a[60:63], v[96:99], v[184:187]
    s_waitcnt lgkmcnt(0)
    v_mfma_f32_16x16x32_bf16 v[184:187], a[44:47], v[92:95], v[184:187]
    s_barrier
    s_nop 7
    v_pk_mul_f32 v[100:101], v[204:205], v[204:205]
    s_mul_i32 s55, s10, 40
    s_add_u32 m0, s50, 147456
    v_pk_mul_f32 v[102:103], v[206:207], v[206:207]
    buffer_load_dwordx4 v19, s[32:35], s55 offen lds
    v_pk_mul_f32 v[104:105], v[212:213], v[212:213]
    s_waitcnt vmcnt(21)
    v_pk_mul_f32 v[106:107], v[214:215], v[214:215]
    ds_read_b64_tr_b16 a[160:161], v36 offset:0
    v_pk_fma_f32 v[100:101], v[100:101], s[62:63], s[62:63] op_sel:[0,0,1] op_sel_hi:[1,0,1]
    ds_read_b64_tr_b16 a[162:163], v36 offset:2048
    v_pk_fma_f32 v[102:103], v[102:103], s[62:63], s[62:63] op_sel:[0,0,1] op_sel_hi:[1,0,1]
    ds_read_b64_tr_b16 a[164:165], v37 offset:0
    v_pk_fma_f32 v[104:105], v[104:105], s[62:63], s[62:63] op_sel:[0,0,1] op_sel_hi:[1,0,1]
    ds_read_b64_tr_b16 a[166:167], v37 offset:2048
    v_pk_fma_f32 v[106:107], v[106:107], s[62:63], s[62:63] op_sel:[0,0,1] op_sel_hi:[1,0,1]
    s_add_u32 m0, s50, 148480
    v_pk_mul_f32 v[100:101], v[100:101], v[204:205]
    buffer_load_dwordx4 v20, s[32:35], s55 offen lds
    v_pk_mul_f32 v[102:103], v[102:103], v[206:207]
    ds_read_b64_tr_b16 a[168:169], v38 offset:0
    v_pk_mul_f32 v[104:105], v[104:105], v[212:213]
    ds_read_b64_tr_b16 a[170:171], v38 offset:2048
    v_pk_mul_f32 v[106:107], v[106:107], v[214:215]
    ds_read_b64_tr_b16 a[172:173], v39 offset:0
    v_exp_f32 v100, v100
    ds_read_b64_tr_b16 a[174:175], v39 offset:2048
    v_exp_f32 v101, v101
    s_add_u32 m0, s50, 149504
    v_exp_f32 v102, v102
    buffer_load_dwordx4 v21, s[32:35], s55 offen lds
    v_exp_f32 v103, v103
    s_waitcnt vmcnt(19)
    v_exp_f32 v104, v104
    ds_read_b64_tr_b16 a[176:177], v36 offset:16384
    v_exp_f32 v105, v105
    ds_read_b64_tr_b16 a[178:179], v36 offset:18432
    v_exp_f32 v106, v106
    s_add_u32 m0, s50, 150528
    v_exp_f32 v107, v107
    buffer_load_dwordx4 v22, s[32:35], s55 offen lds
    v_pk_add_f32 v[100:101], v[100:101], 1.0 op_sel_hi:[1,0]
    ds_read_b64_tr_b16 a[180:181], v37 offset:16384
    v_pk_add_f32 v[102:103], v[102:103], 1.0 op_sel_hi:[1,0]
    ds_read_b64_tr_b16 a[182:183], v37 offset:18432
    v_pk_add_f32 v[104:105], v[104:105], 1.0 op_sel_hi:[1,0]
    ds_read_b64_tr_b16 a[184:185], v38 offset:16384
    v_pk_add_f32 v[106:107], v[106:107], 1.0 op_sel_hi:[1,0]
    ds_read_b64_tr_b16 a[186:187], v38 offset:18432
    v_rcp_f32 v100, v100
    s_mul_i32 s55, s11, 40
    s_add_u32 m0, s50, 32768
    v_rcp_f32 v101, v101
    buffer_load_dwordx4 v19, s[32:35], s55 offen lds
    v_rcp_f32 v102, v102
    ds_read_b64_tr_b16 a[188:189], v39 offset:16384
    v_rcp_f32 v103, v103
    ds_read_b64_tr_b16 a[190:191], v39 offset:18432
    v_rcp_f32 v104, v104
    s_waitcnt vmcnt(17)
    v_rcp_f32 v105, v105
    s_add_u32 m0, s50, 33792
    v_rcp_f32 v106, v106
    buffer_load_dwordx4 v20, s[32:35], s55 offen lds
    v_rcp_f32 v107, v107
    ds_read_b64_tr_b16 a[192:193], v32 offset:49152
    v_pk_mul_f32 v[100:101], v[100:101], v[204:205]
    ds_read_b64_tr_b16 a[194:195], v32 offset:51200
    v_pk_mul_f32 v[102:103], v[102:103], v[206:207]
    ds_read_b64_tr_b16 a[196:197], v33 offset:49152
    v_pk_mul_f32 v[104:105], v[104:105], v[212:213]
    ds_read_b64_tr_b16 a[198:199], v33 offset:51200
    v_pk_mul_f32 v[106:107], v[106:107], v[214:215]
    s_add_u32 m0, s50, 34816
    v_pk_mul_f32 v[100:101], v[100:101], v[208:209]
    buffer_load_dwordx4 v21, s[32:35], s55 offen lds
    v_pk_mul_f32 v[102:103], v[102:103], v[210:211]
    ds_read_b64_tr_b16 a[200:201], v34 offset:49152
    v_pk_mul_f32 v[104:105], v[104:105], v[216:217]
    ds_read_b64_tr_b16 a[202:203], v34 offset:51200
    v_pk_mul_f32 v[106:107], v[106:107], v[218:219]
    ds_read_b64_tr_b16 a[204:205], v35 offset:49152
    v_cvt_pk_bf16_f32 v204, v100, v101
    ds_read_b64_tr_b16 a[206:207], v35 offset:51200
    v_cvt_pk_bf16_f32 v205, v102, v103
    s_waitcnt vmcnt(15)
    v_cvt_pk_bf16_f32 v206, v104, v105
    s_add_u32 m0, s50, 35840
    v_cvt_pk_bf16_f32 v207, v106, v107
    buffer_load_dwordx4 v22, s[32:35], s55 offen lds
    s_mov_b32 s54, 0
    buffer_store_dwordx4 v[204:207], v44, s[40:43], s54 offen sc1
    v_pk_mul_f32 v[100:101], v[188:189], v[188:189]
    ds_read_b64_tr_b16 a[208:209], v36 offset:32768
    v_pk_mul_f32 v[102:103], v[190:191], v[190:191]
    ds_read_b64_tr_b16 a[210:211], v36 offset:34816
    v_pk_mul_f32 v[104:105], v[196:197], v[196:197]
    s_mul_i32 s55, s12, 40
    s_add_u32 m0, s50, 0
    v_pk_mul_f32 v[106:107], v[198:199], v[198:199]
    buffer_load_dwordx4 v19, s[32:35], s55 offen lds
    v_pk_fma_f32 v[100:101], v[100:101], s[62:63], s[62:63] op_sel:[0,0,1] op_sel_hi:[1,0,1]
    ds_read_b64_tr_b16 a[212:213], v37 offset:32768
    v_pk_fma_f32 v[102:103], v[102:103], s[62:63], s[62:63] op_sel:[0,0,1] op_sel_hi:[1,0,1]
    ds_read_b64_tr_b16 a[214:215], v37 offset:34816
    v_pk_fma_f32 v[104:105], v[104:105], s[62:63], s[62:63] op_sel:[0,0,1] op_sel_hi:[1,0,1]
    ds_read_b64_tr_b16 a[216:217], v38 offset:32768
    v_pk_fma_f32 v[106:107], v[106:107], s[62:63], s[62:63] op_sel:[0,0,1] op_sel_hi:[1,0,1]
    ds_read_b64_tr_b16 a[218:219], v38 offset:34816
    v_pk_mul_f32 v[100:101], v[100:101], v[188:189]
    ds_read_b64_tr_b16 a[220:221], v39 offset:32768
    v_pk_mul_f32 v[102:103], v[102:103], v[190:191]
    s_add_u32 m0, s50, 1024
    v_pk_mul_f32 v[104:105], v[104:105], v[196:197]
    buffer_load_dwordx4 v20, s[32:35], s55 offen lds
    v_pk_mul_f32 v[106:107], v[106:107], v[198:199]
    ds_read_b64_tr_b16 a[222:223], v39 offset:34816
    v_exp_f32 v100, v100
    s_waitcnt vmcnt(15)
    v_exp_f32 v101, v101
    ds_read_b64_tr_b16 a[224:225], v40 offset:0
    v_exp_f32 v102, v102
    s_add_u32 m0, s50, 2048
    v_exp_f32 v103, v103
    buffer_load_dwordx4 v21, s[32:35], s55 offen lds
    v_exp_f32 v104, v104
    ds_read_b64_tr_b16 a[226:227], v40 offset:2048
    v_exp_f32 v105, v105
    ds_read_b64_tr_b16 a[228:229], v41 offset:0
    v_exp_f32 v106, v106
    ds_read_b64_tr_b16 a[230:231], v41 offset:2048
    v_exp_f32 v107, v107
    s_add_u32 m0, s50, 3072
    v_pk_add_f32 v[100:101], v[100:101], 1.0 op_sel_hi:[1,0]
    buffer_load_dwordx4 v22, s[32:35], s55 offen lds
    v_pk_add_f32 v[102:103], v[102:103], 1.0 op_sel_hi:[1,0]
    ds_read_b64_tr_b16 a[232:233], v42 offset:0
    v_pk_add_f32 v[104:105], v[104:105], 1.0 op_sel_hi:[1,0]
    ds_read_b64_tr_b16 a[234:235], v42 offset:2048
    v_pk_add_f32 v[106:107], v[106:107], 1.0 op_sel_hi:[1,0]
    ds_read_b64_tr_b16 a[236:237], v43 offset:0
    v_rcp_f32 v100, v100
    ds_read_b64_tr_b16 a[238:239], v43 offset:2048
    v_rcp_f32 v101, v101
    s_mul_i32 s55, s13, 40
    s_add_u32 m0, s50, 16384
    v_rcp_f32 v102, v102
    buffer_load_dwordx4 v19, s[32:35], s55 offen lds
    v_rcp_f32 v103, v103
    s_waitcnt vmcnt(14)
    v_rcp_f32 v104, v104
    ds_read_b64_tr_b16 a[240:241], v36 offset:49152
    v_rcp_f32 v105, v105
    ds_read_b64_tr_b16 a[242:243], v36 offset:51200
    v_rcp_f32 v106, v106
    s_add_u32 m0, s50, 17408
    v_rcp_f32 v107, v107
    buffer_load_dwordx4 v20, s[32:35], s55 offen lds
    v_pk_mul_f32 v[100:101], v[100:101], v[188:189]
    ds_read_b64_tr_b16 a[244:245], v37 offset:49152
    v_pk_mul_f32 v[102:103], v[102:103], v[190:191]
    ds_read_b64_tr_b16 a[246:247], v37 offset:51200
    v_pk_mul_f32 v[104:105], v[104:105], v[196:197]
    ds_read_b64_tr_b16 a[248:249], v38 offset:49152
    v_pk_mul_f32 v[106:107], v[106:107], v[198:199]
    ds_read_b64_tr_b16 a[250:251], v38 offset:51200
    v_pk_mul_f32 v[100:101], v[100:101], v[192:193]
    ds_read_b64_tr_b16 a[252:253], v39 offset:49152
    v_pk_mul_f32 v[102:103], v[102:103], v[194:195]
    s_add_u32 m0, s50, 18432
    v_pk_mul_f32 v[104:105], v[104:105], v[200:201]
    buffer_load_dwordx4 v21, s[32:35], s55 offen lds
    v_pk_mul_f32 v[106:107], v[106:107], v[202:203]
    ds_read_b64_tr_b16 a[254:255], v39 offset:51200
    v_cvt_pk_bf16_f32 v188, v100, v101
    s_waitcnt vmcnt(12)
    v_cvt_pk_bf16_f32 v189, v102, v103
    ds_read_b64_tr_b16 v[220:221], v40 offset:16384
    v_cvt_pk_bf16_f32 v190, v104, v105
    ds_read_b64_tr_b16 v[222:223], v40 offset:18432
    v_cvt_pk_bf16_f32 v191, v106, v107
    ds_read_b64_tr_b16 v[224:225], v41 offset:16384
    s_mov_b32 s54, 2048
    buffer_store_dwordx4 v[188:191], v44, s[40:43], s54 offen sc1
    v_pk_mul_f32 v[100:101], v[172:173], v[172:173]
    s_add_u32 m0, s50, 19456
    v_pk_mul_f32 v[102:103], v[174:175], v[174:175]
    buffer_load_dwordx4 v22, s[32:35], s55 offen lds
    v_pk_mul_f32 v[104:105], v[180:181], v[180:181]
    ds_read_b64_tr_b16 v[226:227], v41 offset:18432
    v_pk_mul_f32 v[106:107], v[182:183], v[182:183]
    ds_read_b64_tr_b16 v[228:229], v42 offset:16384
    v_pk_fma_f32 v[100:101], v[100:101], s[62:63], s[62:63] op_sel:[0,0,1] op_sel_hi:[1,0,1]
    ds_read_b64_tr_b16 v[230:231], v42 offset:18432
    v_pk_fma_f32 v[102:103], v[102:103], s[62:63], s[62:63] op_sel:[0,0,1] op_sel_hi:[1,0,1]
    ds_read_b64_tr_b16 v[232:233], v43 offset:16384
    v_pk_fma_f32 v[104:105], v[104:105], s[62:63], s[62:63] op_sel:[0,0,1] op_sel_hi:[1,0,1]
    ds_read_b64_tr_b16 v[234:235], v43 offset:18432
    v_pk_fma_f32 v[106:107], v[106:107], s[62:63], s[62:63] op_sel:[0,0,1] op_sel_hi:[1,0,1]
    s_waitcnt vmcnt(10)
    v_pk_mul_f32 v[100:101], v[100:101], v[172:173]
    ds_read_b64_tr_b16 v[236:237], v32 offset:32768
    v_pk_mul_f32 v[102:103], v[102:103], v[174:175]
    ds_read_b64_tr_b16 v[238:239], v32 offset:34816
    v_pk_mul_f32 v[104:105], v[104:105], v[180:181]
    ds_read_b64_tr_b16 v[240:241], v33 offset:32768
    v_pk_mul_f32 v[106:107], v[106:107], v[182:183]
    ds_read_b64_tr_b16 v[242:243], v33 offset:34816
    v_exp_f32 v100, v100
    ds_read_b64_tr_b16 v[244:245], v34 offset:32768
    v_exp_f32 v101, v101
    ds_read_b64_tr_b16 v[246:247], v34 offset:34816
    v_exp_f32 v102, v102
    ds_read_b64_tr_b16 v[248:249], v35 offset:32768
    v_exp_f32 v103, v103
    ds_read_b64_tr_b16 v[250:251], v35 offset:34816
    v_exp_f32 v104, v104
    v_exp_f32 v105, v105
    v_exp_f32 v106, v106
    v_exp_f32 v107, v107
    v_pk_add_f32 v[100:101], v[100:101], 1.0 op_sel_hi:[1,0]
    v_pk_add_f32 v[102:103], v[102:103], 1.0 op_sel_hi:[1,0]
    v_pk_add_f32 v[104:105], v[104:105], 1.0 op_sel_hi:[1,0]
    v_pk_add_f32 v[106:107], v[106:107], 1.0 op_sel_hi:[1,0]
    v_rcp_f32 v100, v100
    v_rcp_f32 v101, v101
    v_rcp_f32 v102, v102
    v_rcp_f32 v103, v103
    v_rcp_f32 v104, v104
    v_rcp_f32 v105, v105
    v_rcp_f32 v106, v106
    v_rcp_f32 v107, v107
    v_pk_mul_f32 v[100:101], v[100:101], v[172:173]
    v_pk_mul_f32 v[102:103], v[102:103], v[174:175]
    v_pk_mul_f32 v[104:105], v[104:105], v[180:181]
    v_pk_mul_f32 v[106:107], v[106:107], v[182:183]
    v_pk_mul_f32 v[100:101], v[100:101], v[176:177]
    v_pk_mul_f32 v[102:103], v[102:103], v[178:179]
    v_pk_mul_f32 v[104:105], v[104:105], v[184:185]
    v_pk_mul_f32 v[106:107], v[106:107], v[186:187]
    v_cvt_pk_bf16_f32 v172, v100, v101
    v_cvt_pk_bf16_f32 v173, v102, v103
    v_cvt_pk_bf16_f32 v174, v104, v105
    v_cvt_pk_bf16_f32 v175, v106, v107
    s_mov_b32 s54, 4096
    buffer_store_dwordx4 v[172:175], v44, s[40:43], s54 offen sc1
    s_waitcnt vmcnt(6)
    ds_read_b64_tr_b16 a[144:145], v32 offset:0
    ds_read_b64_tr_b16 a[146:147], v32 offset:2048
    ds_read_b64_tr_b16 a[148:149], v33 offset:0
    ds_read_b64_tr_b16 a[150:151], v33 offset:2048
    ds_read_b64_tr_b16 a[152:153], v34 offset:0
    ds_read_b64_tr_b16 a[154:155], v34 offset:2048
    ds_read_b64_tr_b16 a[156:157], v35 offset:0
    ds_read_b64_tr_b16 a[158:159], v35 offset:2048
    s_waitcnt vmcnt(1)
    ds_read_b64_tr_b16 v[156:157], v32 offset:16384
    ds_read_b64_tr_b16 v[158:159], v32 offset:18432
    ds_read_b64_tr_b16 v[160:161], v33 offset:16384
    ds_read_b64_tr_b16 v[162:163], v33 offset:18432
    ds_read_b64_tr_b16 v[164:165], v34 offset:16384
    ds_read_b64_tr_b16 v[166:167], v34 offset:18432
    ds_read_b64_tr_b16 v[168:169], v35 offset:16384
    ds_read_b64_tr_b16 v[170:171], v35 offset:18432
    s_waitcnt lgkmcnt(0)
    s_waitcnt vmcnt(0)
    s_mov_b32 s57, 1
    s_atomic_umax s57, s[40:41], s69
    s_atomic_umax s57, s[40:41], s69 offset:128
    s_atomic_umax s57, s[40:41], s69 offset:256
    s_mul_i32 s55, s14, 40
    s_add_u32 m0, s50, 65536
    s_nop 0
    buffer_load_dwordx4 v19, s[32:35], s55 offen lds
    s_add_u32 m0, s50, 66560
    s_nop 0
    buffer_load_dwordx4 v20, s[32:35], s55 offen lds
    s_add_u32 m0, s50, 67584
    s_nop 0
    buffer_load_dwordx4 v21, s[32:35], s55 offen lds
    s_add_u32 m0, s50, 68608
    s_nop 0
    buffer_load_dwordx4 v22, s[32:35], s55 offen lds
    s_mul_i32 s55, s15, 40
    s_add_u32 m0, s50, 81920
    s_nop 0
    buffer_load_dwordx4 v19, s[32:35], s55 offen lds
    s_add_u32 m0, s50, 82944
    s_nop 0
    buffer_load_dwordx4 v20, s[32:35], s55 offen lds
    s_add_u32 m0, s50, 83968
    s_nop 0
    buffer_load_dwordx4 v21, s[32:35], s55 offen lds
    s_mov_b64 s[58:59], 0
    s_mov_b64 exec, 0xffff
    buffer_load_dwordx4 v[4:7], v47, s[40:43], 0 offen sc1
    s_mov_b64 exec, -1
    s_add_u32 m0, s50, 84992
    s_nop 0
    buffer_load_dwordx4 v22, s[32:35], s55 offen lds
    s_mul_i32 s55, s16, 40
    s_add_u32 m0, s50, 49152
    s_nop 0
    buffer_load_dwordx4 v19, s[32:35], s55 offen lds
    s_add_u32 m0, s50, 50176
    s_nop 0
    buffer_load_dwordx4 v20, s[32:35], s55 offen lds
    s_waitcnt vmcnt(10)
    s_add_u32 m0, s50, 51200
    s_nop 0
    buffer_load_dwordx4 v21, s[32:35], s55 offen lds
    s_waitcnt vmcnt(10)
    s_add_u32 m0, s50, 52224
    s_nop 0
    buffer_load_dwordx4 v22, s[32:35], s55 offen lds
    s_waitcnt vmcnt(10)
    s_mul_i32 s55, s17, 40
    s_add_u32 m0, s50, 98304
    s_nop 0
    buffer_load_dwordx4 v19, s[32:35], s55 offen lds
    s_waitcnt vmcnt(10)
    ds_read_b64_tr_b16 v[140:141], v36 offset:0
    ds_read_b64_tr_b16 v[142:143], v36 offset:2048
    ds_read_b64_tr_b16 v[144:145], v37 offset:0
    s_add_u32 m0, s50, 99328
    s_nop 0
    buffer_load_dwordx4 v20, s[32:35], s55 offen lds
    s_waitcnt vmcnt(10)
    ds_read_b64_tr_b16 v[146:147], v37 offset:2048
    ds_read_b64_tr_b16 v[148:149], v38 offset:0
    ds_read_b64_tr_b16 v[150:151], v38 offset:2048
    s_add_u32 m0, s50, 100352
    s_nop 0
    buffer_load_dwordx4 v21, s[32:35], s55 offen lds
    s_waitcnt vmcnt(10)
    ds_read_b64_tr_b16 v[152:153], v39 offset:0
    ds_read_b64_tr_b16 v[154:155], v39 offset:2048
    s_add_u32 m0, s50, 101376
    s_nop 0
    buffer_load_dwordx4 v22, s[32:35], s55 offen lds
    s_waitcnt vmcnt(10)
    s_waitcnt vmcnt(9)
    v_min_u32 v4, v4, v5
    v_min3_u32 v4, v4, v6, v7
    v_cmp_gt_u32 vcc, v4, v48
    s_nop 0
    s_or_b64 s[58:59], s[58:59], vcc
    s_and_b32 s52, s58, 0xffff
    s_cmp_eq_u32 s52, 0xffff
    s_cbranch_scc0 L_nu_c2_0s
L_nu_c2_0:
    s_mul_i32 s56, s72, 55296
    v_add_u32 v46, s56, v45
    buffer_load_dwordx4 a[104:107], v46, s[40:43], s4 offen sc1
    buffer_load_dwordx4 a[108:111], v46, s[40:43], s5 offen sc1
    buffer_load_dwordx4 a[112:115], v46, s[40:43], s6 offen sc1
    buffer_load_dwordx4 a[116:119], v46, s[40:43], s7 offen sc1
    buffer_load_dwordx4 a[120:123], v46, s[40:43], s8 offen sc1
    buffer_load_dwordx4 a[124:127], v46, s[40:43], s9 offen sc1
    buffer_load_dwordx4 a[128:131], v46, s[40:43], s10 offen sc1
    buffer_load_dwordx4 a[132:135], v46, s[40:43], s11 offen sc1
    buffer_load_dwordx4 a[136:139], v46, s[40:43], s12 offen sc1
    buffer_load_dwordx4 a[140:143], v46, s[40:43], s13 offen sc1
    buffer_load_dwordx4 v[52:55], v46, s[40:43], s14 offen sc1
    buffer_load_dwordx4 v[56:59], v46, s[40:43], s15 offen sc1
    s_waitcnt vmcnt(9)
    v_mfma_f32_16x16x32_bf16 v[108:111], a[160:163], a[104:107], 0
    buffer_load_dwordx4 v[60:63], v46, s[40:43], s16 offen sc1
    v_mfma_f32_16x16x32_bf16 v[108:111], a[176:179], a[108:111], v[108:111]
    ds_read_b64_tr_b16 v[204:205], v36 offset:16384
    ds_read_b64_tr_b16 v[206:207], v36 offset:18432
    v_mfma_f32_16x16x32_bf16 v[108:111], a[192:195], a[112:115], v[108:111]
    ds_read_b64_tr_b16 v[208:209], v37 offset:16384
    ds_read_b64_tr_b16 v[210:211], v37 offset:18432
    v_mfma_f32_16x16x32_bf16 a[0:3], a[196:199], a[112:115], 0
    buffer_load_dwordx4 v[64:67], v46, s[40:43], s17 offen sc1
    v_mfma_f32_16x16x32_bf16 a[0:3], a[180:183], a[108:111], a[0:3]
    ds_read_b64_tr_b16 v[212:213], v38 offset:16384
    ds_read_b64_tr_b16 v[214:215], v38 offset:18432
    v_mfma_f32_16x16x32_bf16 a[0:3], a[164:167], a[104:107], a[0:3]
    ds_read_b64_tr_b16 v[216:217], v39 offset:16384
    ds_read_b64_tr_b16 v[218:219], v39 offset:18432
    v_mfma_f32_16x16x32_bf16 a[4:7], a[168:171], a[104:107], 0
    s_mul_i32 s56, s73, 55296
    v_add_u32 v46, s56, v45
    v_mfma_f32_16x16x32_bf16 a[4:7], a[184:187], a[108:111], a[4:7]
    ds_read_b64_tr_b16 v[188:189], v32 offset:49152
    ds_read_b64_tr_b16 v[190:191], v32 offset:51200
    v_mfma_f32_16x16x32_bf16 a[4:7], a[200:203], a[112:115], a[4:7]
    ds_read_b64_tr_b16 v[192:193], v33 offset:49152
    ds_read_b64_tr_b16 v[194:195], v33 offset:51200
    v_mfma_f32_16x16x32_bf16 a[8:11], a[204:207], a[112:115], 0
    buffer_load_dwordx4 v[68:71], v46, s[40:43], s4 offen sc1
    v_mfma_f32_16x16x32_bf16 a[8:11], a[188:191], a[108:111], a[8:11]
    ds_read_b64_tr_b16 v[196:197], v34 offset:49152
    ds_read_b64_tr_b16 v[198:199], v34 offset:51200
    v_mfma_f32_16x16x32_bf16 a[8:11], a[172:175], a[104:107], a[8:11]
    ds_read_b64_tr_b16 v[200:201], v35 offset:49152
    ds_read_b64_tr_b16 v[202:203], v35 offset:51200
    buffer_load_dwordx4 v[72:75], v46, s[40:43], s5 offen sc1
    s_waitcnt vmcnt(9)
    v_mfma_f32_16x16x32_bf16 v[108:111], a[208:211], a[116:119], v[108:111]
    buffer_load_dwordx4 v[76:79], v46, s[40:43], s6 offen sc1
    v_mfma_f32_16x16x32_bf16 v[108:111], a[224:227], a[120:123], v[108:111]
    ds_read_b64_tr_b16 v[172:173], v36 offset:32768
    ds_read_b64_tr_b16 v[174:175], v36 offset:34816
    v_mfma_f32_16x16x32_bf16 v[108:111], a[240:243], a[124:127], v[108:111]
    ds_read_b64_tr_b16 v[176:177], v37 offset:32768
    ds_read_b64_tr_b16 v[178:179], v37 offset:34816
    v_mfma_f32_16x16x32_bf16 v[108:111], v[220:223], a[128:131], v[108:111]
    buffer_load_dwordx4 v[80:83], v46, s[40:43], s7 offen sc1
    v_mfma_f32_16x16x32_bf16 a[0:3], v[224:227], a[128:131], a[0:3]
    ds_read_b64_tr_b16 v[180:181], v38 offset:32768
    ds_read_b64_tr_b16 v[182:183], v38 offset:34816
    v_mfma_f32_16x16x32_bf16 a[0:3], a[244:247], a[124:127], a[0:3]
    ds_read_b64_tr_b16 v[184:185], v39 offset:32768
    ds_read_b64_tr_b16 v[186:187], v39 offset:34816
    v_mfma_f32_16x16x32_bf16 a[0:3], a[228:231], a[120:123], a[0:3]
    buffer_load_dwordx4 v[84:87], v46, s[40:43], s8 offen sc1
    v_mfma_f32_16x16x32_bf16 a[0:3], a[212:215], a[116:119], a[0:3]
    v_mfma_f32_16x16x32_bf16 a[4:7], a[216:219], a[116:119], a[4:7]
    v_mfma_f32_16x16x32_bf16 a[4:7], a[232:235], a[120:123], a[4:7]
    v_mfma_f32_16x16x32_bf16 a[4:7], a[248:251], a[124:127], a[4:7]
    v_mfma_f32_16x16x32_bf16 a[4:7], v[228:231], a[128:131], a[4:7]
    v_mfma_f32_16x16x32_bf16 a[8:11], v[232:235], a[128:131], a[8:11]
    v_mfma_f32_16x16x32_bf16 a[8:11], a[252:255], a[124:127], a[8:11]
    v_mfma_f32_16x16x32_bf16 a[8:11], a[236:239], a[120:123], a[8:11]
    v_mfma_f32_16x16x32_bf16 a[8:11], a[220:223], a[116:119], a[8:11]
    s_waitcnt vmcnt(9)
    v_mfma_f32_16x16x32_bf16 v[108:111], v[236:239], a[132:135], v[108:111]
    buffer_load_dwordx4 v[88:91], v46, s[40:43], s9 offen sc1
    v_mfma_f32_16x16x32_bf16 v[108:111], a[144:147], a[136:139], v[108:111]
    v_mfma_f32_16x16x32_bf16 v[108:111], v[156:159], a[140:143], v[108:111]
    v_mfma_f32_16x16x32_bf16 a[0:3], v[160:163], a[140:143], a[0:3]
    buffer_load_dwordx4 v[92:95], v46, s[40:43], s10 offen sc1
    v_mfma_f32_16x16x32_bf16 a[0:3], a[148:151], a[136:139], a[0:3]
    v_mfma_f32_16x16x32_bf16 a[0:3], v[240:243], a[132:135], a[0:3]
    v_mfma_f32_16x16x32_bf16 a[4:7], v[244:247], a[132:135], a[4:7]
    buffer_load_dwordx4 v[96:99], v46, s[40:43], s11 offen sc1
    v_mfma_f32_16x16x32_bf16 a[4:7], a[152:155], a[136:139], a[4:7]
    v_mfma_f32_16x16x32_bf16 a[4:7], v[164:167], a[140:143], a[4:7]
    v_mfma_f32_16x16x32_bf16 a[8:11], v[168:171], a[140:143], a[8:11]
    buffer_load_dwordx4 v[100:103], v46, s[40:43], s12 offen sc1
    v_mfma_f32_16x16x32_bf16 a[8:11], a[156:159], a[136:139], a[8:11]
    v_mfma_f32_16x16x32_bf16 a[8:11], v[248:251], a[132:135], a[8:11]
    s_waitcnt vmcnt(9) lgkmcnt(0)
    v_mfma_f32_16x16x32_bf16 v[108:111], v[140:143], v[52:55], v[108:111]
    buffer_load_dwordx4 v[104:107], v46, s[40:43], s13 offen sc1
    v_mfma_f32_16x16x32_bf16 v[108:111], v[204:207], v[56:59], v[108:111]
    v_mfma_f32_16x16x32_bf16 v[108:111], v[188:191], v[60:63], v[108:111]
    v_mfma_f32_16x16x32_bf16 v[108:111], v[172:175], v[64:67], v[108:111]
    buffer_load_dwordx4 a[72:75], v46, s[40:43], s14 offen sc1
    v_mfma_f32_16x16x32_bf16 a[0:3], v[176:179], v[64:67], a[0:3]
    v_mfma_f32_16x16x32_bf16 a[0:3], v[192:195], v[60:63], a[0:3]
    v_mfma_f32_16x16x32_bf16 a[0:3], v[208:211], v[56:59], a[0:3]
    buffer_load_dwordx4 a[76:79], v46, s[40:43], s15 offen sc1
    v_mfma_f32_16x16x32_bf16 a[0:3], v[144:147], v[52:55], a[0:3]
    v_mfma_f32_16x16x32_bf16 a[4:7], v[148:151], v[52:55], a[4:7]
    v_mfma_f32_16x16x32_bf16 a[4:7], v[212:215], v[56:59], a[4:7]
    v_mfma_f32_16x16x32_bf16 a[4:7], v[196:199], v[60:63], a[4:7]
    v_mfma_f32_16x16x32_bf16 a[4:7], v[180:183], v[64:67], a[4:7]
    v_mfma_f32_16x16x32_bf16 a[8:11], v[184:187], v[64:67], a[8:11]
    v_mfma_f32_16x16x32_bf16 a[8:11], v[200:203], v[60:63], a[8:11]
    v_mfma_f32_16x16x32_bf16 a[8:11], v[216:219], v[56:59], a[8:11]
    v_mfma_f32_16x16x32_bf16 a[8:11], v[152:155], v[52:55], a[8:11]
    s_barrier
    v_xor_b32 v32, 0, v50
    v_xor_b32 v33, 64, v50
    v_xor_b32 v34, 128, v50
    v_xor_b32 v35, 192, v50
    v_add_u32 v36, 65536, v32
    v_add_u32 v37, 65536, v33
    v_add_u32 v38, 65536, v34
    v_add_u32 v39, 65536, v35
    v_xor_b32 v40, 16, v253
    v_add_u32 v41, 65536, v253
    v_add_u32 v42, 65536, v40
    s_waitcnt vmcnt(9)
    v_mfma_f32_16x16x32_bf16 v[112:115], a[160:163], v[68:71], 0
    buffer_load_dwordx4 a[80:83], v46, s[40:43], s16 offen sc1
    v_mfma_f32_16x16x32_bf16 v[112:115], a[176:179], v[72:75], v[112:115]
    s_mov_b32 s80, s78
    s_mul_i32 s55, s73, 20480
    v_mfma_f32_16x16x32_bf16 v[112:115], a[192:195], v[76:79], v[112:115]
    s_cmp_lt_u32 s48, 2
    s_cselect_b32 s80, s80, s55
    s_mul_i32 s81, s74, 20480
    v_mfma_f32_16x16x32_bf16 a[12:15], a[196:199], v[76:79], 0
    ds_write_b128 v32, v[108:111] offset:0
    v_mfma_f32_16x16x32_bf16 a[12:15], a[180:183], v[72:75], a[12:15]
    s_mul_i32 s55, s75, 20480
    s_cmp_lt_u32 s48, 2
    s_cselect_b32 s81, s81, s55
    v_mfma_f32_16x16x32_bf16 a[12:15], a[164:167], v[68:71], a[12:15]
    ds_write_b128 v33, a[0:3] offset:0
    v_mfma_f32_16x16x32_bf16 a[16:19], a[168:171], v[68:71], 0
    buffer_load_dwordx4 a[84:87], v46, s[40:43], s17 offen sc1
    v_mfma_f32_16x16x32_bf16 a[16:19], a[184:187], v[72:75], a[16:19]
    ds_write_b128 v34, a[4:7] offset:0
    v_mfma_f32_16x16x32_bf16 a[16:19], a[200:203], v[76:79], a[16:19]
    s_mul_i32 s82, s76, 20480
    s_mov_b32 s55, 0x40000000
    v_mfma_f32_16x16x32_bf16 a[20:23], a[204:207], v[76:79], 0
    ds_write_b128 v35, a[8:11] offset:0
    v_mfma_f32_16x16x32_bf16 a[20:23], a[188:191], v[72:75], a[20:23]
    s_cmp_lt_u32 s48, 2
    s_cselect_b32 s82, s82, s55
    v_mfma_f32_16x16x32_bf16 a[20:23], a[172:175], v[68:71], a[20:23]
    s_mul_i32 s56, s74, 55296
    v_add_u32 v46, s56, v45
    buffer_load_dwordx4 a[88:91], v46, s[40:43], s4 offen sc1
    buffer_load_dwordx4 a[92:95], v46, s[40:43], s5 offen sc1
    s_waitcnt vmcnt(9)
    v_mfma_f32_16x16x32_bf16 v[112:115], a[208:211], v[80:83], v[112:115]
    buffer_load_dwordx4 a[96:99], v46, s[40:43], s6 offen sc1
    v_mfma_f32_16x16x32_bf16 v[112:115], a[224:227], v[84:87], v[112:115]
    v_mfma_f32_16x16x32_bf16 v[112:115], a[240:243], v[88:91], v[112:115]
    v_mfma_f32_16x16x32_bf16 v[112:115], v[220:223], v[92:95], v[112:115]
    buffer_load_dwordx4 a[100:103], v46, s[40:43], s7 offen sc1
    v_mfma_f32_16x16x32_bf16 a[12:15], v[224:227], v[92:95], a[12:15]
    v_mfma_f32_16x16x32_bf16 a[12:15], a[244:247], v[88:91], a[12:15]
    v_mfma_f32_16x16x32_bf16 a[12:15], a[228:231], v[84:87], a[12:15]
    buffer_load_dwordx4 a[104:107], v46, s[40:43], s8 offen sc1
    v_mfma_f32_16x16x32_bf16 a[12:15], a[212:215], v[80:83], a[12:15]
    v_mfma_f32_16x16x32_bf16 a[16:19], a[216:219], v[80:83], a[16:19]
    v_mfma_f32_16x16x32_bf16 a[16:19], a[232:235], v[84:87], a[16:19]
    v_mfma_f32_16x16x32_bf16 a[16:19], a[248:251], v[88:91], a[16:19]
    v_mfma_f32_16x16x32_bf16 a[16:19], v[228:231], v[92:95], a[16:19]
    v_mfma_f32_16x16x32_bf16 a[20:23], v[232:235], v[92:95], a[20:23]
    v_mfma_f32_16x16x32_bf16 a[20:23], a[252:255], v[88:91], a[20:23]
    v_mfma_f32_16x16x32_bf16 a[20:23], a[236:239], v[84:87], a[20:23]
    v_mfma_f32_16x16x32_bf16 a[20:23], a[220:223], v[80:83], a[20:23]
    s_waitcnt vmcnt(9)
    v_mfma_f32_16x16x32_bf16 v[112:115], v[236:239], v[96:99], v[112:115]
    buffer_load_dwordx4 a[108:111], v46, s[40:43], s9 offen sc1
    v_mfma_f32_16x16x32_bf16 v[112:115], a[144:147], v[100:103], v[112:115]
    v_mfma_f32_16x16x32_bf16 v[112:115], v[156:159], v[104:107], v[112:115]
    v_mfma_f32_16x16x32_bf16 a[12:15], v[160:163], v[104:107], a[12:15]
    buffer_load_dwordx4 a[112:115], v46, s[40:43], s10 offen sc1
    v_mfma_f32_16x16x32_bf16 a[12:15], a[148:151], v[100:103], a[12:15]
    v_mfma_f32_16x16x32_bf16 a[12:15], v[240:243], v[96:99], a[12:15]
    v_mfma_f32_16x16x32_bf16 a[16:19], v[244:247], v[96:99], a[16:19]
    buffer_load_dwordx4 a[116:119], v46, s[40:43], s11 offen sc1
    v_mfma_f32_16x16x32_bf16 a[16:19], a[152:155], v[100:103], a[16:19]
    v_mfma_f32_16x16x32_bf16 a[16:19], v[164:167], v[104:107], a[16:19]
    v_mfma_f32_16x16x32_bf16 a[20:23], v[168:171], v[104:107], a[20:23]
    buffer_load_dwordx4 a[120:123], v46, s[40:43], s12 offen sc1
    v_mfma_f32_16x16x32_bf16 a[20:23], a[156:159], v[100:103], a[20:23]
    v_mfma_f32_16x16x32_bf16 a[20:23], v[248:251], v[96:99], a[20:23]
    s_waitcnt vmcnt(9)
    v_mfma_f32_16x16x32_bf16 v[112:115], v[140:143], a[72:75], v[112:115]
    buffer_load_dwordx4 a[124:127], v46, s[40:43], s13 offen sc1
    v_mfma_f32_16x16x32_bf16 v[112:115], v[204:207], a[76:79], v[112:115]
    v_mfma_f32_16x16x32_bf16 v[112:115], v[188:191], a[80:83], v[112:115]
    v_mfma_f32_16x16x32_bf16 v[112:115], v[172:175], a[84:87], v[112:115]
    buffer_load_dwordx4 a[128:131], v46, s[40:43], s14 offen sc1
    v_mfma_f32_16x16x32_bf16 a[12:15], v[176:179], a[84:87], a[12:15]
    v_mfma_f32_16x16x32_bf16 a[12:15], v[192:195], a[80:83], a[12:15]
    v_mfma_f32_16x16x32_bf16 a[12:15], v[208:211], a[76:79], a[12:15]
    buffer_load_dwordx4 a[132:135], v46, s[40:43], s15 offen sc1
    v_mfma_f32_16x16x32_bf16 a[12:15], v[144:147], a[72:75], a[12:15]
    v_mfma_f32_16x16x32_bf16 a[16:19], v[148:151], a[72:75], a[16:19]
    v_mfma_f32_16x16x32_bf16 a[16:19], v[212:215], a[76:79], a[16:19]
    v_mfma_f32_16x16x32_bf16 a[16:19], v[196:199], a[80:83], a[16:19]
    v_mfma_f32_16x16x32_bf16 a[16:19], v[180:183], a[84:87], a[16:19]
    v_mfma_f32_16x16x32_bf16 a[20:23], v[184:187], a[84:87], a[20:23]
    v_mfma_f32_16x16x32_bf16 a[20:23], v[200:203], a[80:83], a[20:23]
    v_mfma_f32_16x16x32_bf16 a[20:23], v[216:219], a[76:79], a[20:23]
    v_mfma_f32_16x16x32_bf16 a[20:23], v[152:155], a[72:75], a[20:23]
    s_waitcnt vmcnt(9)
    v_mfma_f32_16x16x32_bf16 v[116:119], a[160:163], a[88:91], 0
    buffer_load_dwordx4 a[136:139], v46, s[40:43], s16 offen sc1
    v_mfma_f32_16x16x32_bf16 v[116:119], a[176:179], a[92:95], v[116:119]
    v_mfma_f32_16x16x32_bf16 v[116:119], a[192:195], a[96:99], v[116:119]
    v_mfma_f32_16x16x32_bf16 a[24:27], a[196:199], a[96:99], 0
    ds_write_b128 v32, v[112:115] offset:16384
    v_mfma_f32_16x16x32_bf16 a[24:27], a[180:183], a[92:95], a[24:27]
    v_mfma_f32_16x16x32_bf16 a[24:27], a[164:167], a[88:91], a[24:27]
    ds_write_b128 v33, a[12:15] offset:16384
    v_mfma_f32_16x16x32_bf16 a[28:31], a[168:171], a[88:91], 0
    buffer_load_dwordx4 a[140:143], v46, s[40:43], s17 offen sc1
    v_mfma_f32_16x16x32_bf16 a[28:31], a[184:187], a[92:95], a[28:31]
    ds_write_b128 v34, a[16:19] offset:16384
    v_mfma_f32_16x16x32_bf16 a[28:31], a[200:203], a[96:99], a[28:31]
    v_mfma_f32_16x16x32_bf16 a[32:35], a[204:207], a[96:99], 0
    ds_write_b128 v35, a[20:23] offset:16384
    v_mfma_f32_16x16x32_bf16 a[32:35], a[188:191], a[92:95], a[32:35]
    v_mfma_f32_16x16x32_bf16 a[32:35], a[172:175], a[88:91], a[32:35]
    s_mul_i32 s56, s75, 55296
    v_add_u32 v46, s56, v45
    buffer_load_dwordx4 v[52:55], v46, s[40:43], s4 offen sc1
    buffer_load_dwordx4 v[56:59], v46, s[40:43], s5 offen sc1
    s_waitcnt vmcnt(9)
    v_mfma_f32_16x16x32_bf16 v[116:119], a[208:211], a[100:103], v[116:119]
    buffer_load_dwordx4 v[60:63], v46, s[40:43], s6 offen sc1
    v_mfma_f32_16x16x32_bf16 v[116:119], a[224:227], a[104:107], v[116:119]
    v_mfma_f32_16x16x32_bf16 v[116:119], a[240:243], a[108:111], v[116:119]
    v_mfma_f32_16x16x32_bf16 v[116:119], v[220:223], a[112:115], v[116:119]
    buffer_load_dwordx4 v[64:67], v46, s[40:43], s7 offen sc1
    v_mfma_f32_16x16x32_bf16 a[24:27], v[224:227], a[112:115], a[24:27]
    v_mfma_f32_16x16x32_bf16 a[24:27], a[244:247], a[108:111], a[24:27]
    v_mfma_f32_16x16x32_bf16 a[24:27], a[228:231], a[104:107], a[24:27]
    buffer_load_dwordx4 v[68:71], v46, s[40:43], s8 offen sc1
    v_mfma_f32_16x16x32_bf16 a[24:27], a[212:215], a[100:103], a[24:27]
    v_mfma_f32_16x16x32_bf16 a[28:31], a[216:219], a[100:103], a[28:31]
    v_mfma_f32_16x16x32_bf16 a[28:31], a[232:235], a[104:107], a[28:31]
    v_mfma_f32_16x16x32_bf16 a[28:31], a[248:251], a[108:111], a[28:31]
    v_mfma_f32_16x16x32_bf16 a[28:31], v[228:231], a[112:115], a[28:31]
    v_mfma_f32_16x16x32_bf16 a[32:35], v[232:235], a[112:115], a[32:35]
    v_mfma_f32_16x16x32_bf16 a[32:35], a[252:255], a[108:111], a[32:35]
    v_mfma_f32_16x16x32_bf16 a[32:35], a[236:239], a[104:107], a[32:35]
    v_mfma_f32_16x16x32_bf16 a[32:35], a[220:223], a[100:103], a[32:35]
    s_waitcnt vmcnt(9)
    v_mfma_f32_16x16x32_bf16 v[116:119], v[236:239], a[116:119], v[116:119]
    buffer_load_dwordx4 v[72:75], v46, s[40:43], s9 offen sc1
    v_mfma_f32_16x16x32_bf16 v[116:119], a[144:147], a[120:123], v[116:119]
    v_mfma_f32_16x16x32_bf16 v[116:119], v[156:159], a[124:127], v[116:119]
    v_mfma_f32_16x16x32_bf16 a[24:27], v[160:163], a[124:127], a[24:27]
    buffer_load_dwordx4 v[76:79], v46, s[40:43], s10 offen sc1
    v_mfma_f32_16x16x32_bf16 a[24:27], a[148:151], a[120:123], a[24:27]
    v_mfma_f32_16x16x32_bf16 a[24:27], v[240:243], a[116:119], a[24:27]
    v_mfma_f32_16x16x32_bf16 a[28:31], v[244:247], a[116:119], a[28:31]
    buffer_load_dwordx4 v[80:83], v46, s[40:43], s11 offen sc1
    v_mfma_f32_16x16x32_bf16 a[28:31], a[152:155], a[120:123], a[28:31]
    v_mfma_f32_16x16x32_bf16 a[28:31], v[164:167], a[124:127], a[28:31]
    v_mfma_f32_16x16x32_bf16 a[32:35], v[168:171], a[124:127], a[32:35]
    buffer_load_dwordx4 v[84:87], v46, s[40:43], s12 offen sc1
    v_mfma_f32_16x16x32_bf16 a[32:35], a[156:159], a[120:123], a[32:35]
    v_mfma_f32_16x16x32_bf16 a[32:35], v[248:251], a[116:119], a[32:35]
    s_waitcnt vmcnt(9)
    v_mfma_f32_16x16x32_bf16 v[116:119], v[140:143], a[128:131], v[116:119]
    buffer_load_dwordx4 v[88:91], v46, s[40:43], s13 offen sc1
    v_mfma_f32_16x16x32_bf16 v[116:119], v[204:207], a[132:135], v[116:119]
    v_mfma_f32_16x16x32_bf16 v[116:119], v[188:191], a[136:139], v[116:119]
    v_mfma_f32_16x16x32_bf16 v[116:119], v[172:175], a[140:143], v[116:119]
    buffer_load_dwordx4 v[92:95], v46, s[40:43], s14 offen sc1
    v_mfma_f32_16x16x32_bf16 a[24:27], v[176:179], a[140:143], a[24:27]
    v_mfma_f32_16x16x32_bf16 a[24:27], v[192:195], a[136:139], a[24:27]
    v_mfma_f32_16x16x32_bf16 a[24:27], v[208:211], a[132:135], a[24:27]
    buffer_load_dwordx4 v[96:99], v46, s[40:43], s15 offen sc1
    v_mfma_f32_16x16x32_bf16 a[24:27], v[144:147], a[128:131], a[24:27]
    v_mfma_f32_16x16x32_bf16 a[28:31], v[148:151], a[128:131], a[28:31]
    v_mfma_f32_16x16x32_bf16 a[28:31], v[212:215], a[132:135], a[28:31]
    v_mfma_f32_16x16x32_bf16 a[28:31], v[196:199], a[136:139], a[28:31]
    v_mfma_f32_16x16x32_bf16 a[28:31], v[180:183], a[140:143], a[28:31]
    v_mfma_f32_16x16x32_bf16 a[32:35], v[184:187], a[140:143], a[32:35]
    v_mfma_f32_16x16x32_bf16 a[32:35], v[200:203], a[136:139], a[32:35]
    v_mfma_f32_16x16x32_bf16 a[32:35], v[216:219], a[132:135], a[32:35]
    v_mfma_f32_16x16x32_bf16 a[32:35], v[152:155], a[128:131], a[32:35]
    s_waitcnt vmcnt(9)
    v_mfma_f32_16x16x32_bf16 v[120:123], a[160:163], v[52:55], 0
    buffer_load_dwordx4 v[100:103], v46, s[40:43], s16 offen sc1
    v_mfma_f32_16x16x32_bf16 v[120:123], a[176:179], v[56:59], v[120:123]
    v_mfma_f32_16x16x32_bf16 v[120:123], a[192:195], v[60:63], v[120:123]
    v_mfma_f32_16x16x32_bf16 a[36:39], a[196:199], v[60:63], 0
    ds_write_b128 v32, v[116:119] offset:32768
    v_mfma_f32_16x16x32_bf16 a[36:39], a[180:183], v[56:59], a[36:39]
    v_mfma_f32_16x16x32_bf16 a[36:39], a[164:167], v[52:55], a[36:39]
    ds_write_b128 v33, a[24:27] offset:32768
    v_mfma_f32_16x16x32_bf16 a[40:43], a[168:171], v[52:55], 0
    buffer_load_dwordx4 v[104:107], v46, s[40:43], s17 offen sc1
    v_mfma_f32_16x16x32_bf16 a[40:43], a[184:187], v[56:59], a[40:43]
    ds_write_b128 v34, a[28:31] offset:32768
    v_mfma_f32_16x16x32_bf16 a[40:43], a[200:203], v[60:63], a[40:43]
    v_mfma_f32_16x16x32_bf16 a[44:47], a[204:207], v[60:63], 0
    ds_write_b128 v35, a[32:35] offset:32768
    v_mfma_f32_16x16x32_bf16 a[44:47], a[188:191], v[56:59], a[44:47]
    v_mfma_f32_16x16x32_bf16 a[44:47], a[172:175], v[52:55], a[44:47]
    s_mul_i32 s56, s76, 55296
    v_add_u32 v46, s56, v45
    buffer_load_dwordx4 a[72:75], v46, s[40:43], s4 offen sc1
    buffer_load_dwordx4 a[76:79], v46, s[40:43], s5 offen sc1
    s_waitcnt vmcnt(9)
    v_mfma_f32_16x16x32_bf16 v[120:123], a[208:211], v[64:67], v[120:123]
    buffer_load_dwordx4 a[80:83], v46, s[40:43], s6 offen sc1
    v_mfma_f32_16x16x32_bf16 v[120:123], a[224:227], v[68:71], v[120:123]
    v_mfma_f32_16x16x32_bf16 v[120:123], a[240:243], v[72:75], v[120:123]
    v_mfma_f32_16x16x32_bf16 v[120:123], v[220:223], v[76:79], v[120:123]
    buffer_load_dwordx4 a[84:87], v46, s[40:43], s7 offen sc1
    v_mfma_f32_16x16x32_bf16 a[36:39], v[224:227], v[76:79], a[36:39]
    v_mfma_f32_16x16x32_bf16 a[36:39], a[244:247], v[72:75], a[36:39]
    v_mfma_f32_16x16x32_bf16 a[36:39], a[228:231], v[68:71], a[36:39]
    buffer_load_dwordx4 a[88:91], v46, s[40:43], s8 offen sc1
    v_mfma_f32_16x16x32_bf16 a[36:39], a[212:215], v[64:67], a[36:39]
    v_mfma_f32_16x16x32_bf16 a[40:43], a[216:219], v[64:67], a[40:43]
    v_mfma_f32_16x16x32_bf16 a[40:43], a[232:235], v[68:71], a[40:43]
    v_mfma_f32_16x16x32_bf16 a[40:43], a[248:251], v[72:75], a[40:43]
    v_mfma_f32_16x16x32_bf16 a[40:43], v[228:231], v[76:79], a[40:43]
    v_mfma_f32_16x16x32_bf16 a[44:47], v[232:235], v[76:79], a[44:47]
    v_mfma_f32_16x16x32_bf16 a[44:47], a[252:255], v[72:75], a[44:47]
    v_mfma_f32_16x16x32_bf16 a[44:47], a[236:239], v[68:71], a[44:47]
    v_mfma_f32_16x16x32_bf16 a[44:47], a[220:223], v[64:67], a[44:47]
    s_waitcnt vmcnt(9)
    v_mfma_f32_16x16x32_bf16 v[120:123], v[236:239], v[80:83], v[120:123]
    buffer_load_dwordx4 a[92:95], v46, s[40:43], s9 offen sc1
    v_mfma_f32_16x16x32_bf16 v[120:123], a[144:147], v[84:87], v[120:123]
    v_mfma_f32_16x16x32_bf16 v[120:123], v[156:159], v[88:91], v[120:123]
    v_mfma_f32_16x16x32_bf16 a[36:39], v[160:163], v[88:91], a[36:39]
    buffer_load_dwordx4 a[96:99], v46, s[40:43], s10 offen sc1
    v_mfma_f32_16x16x32_bf16 a[36:39], a[148:151], v[84:87], a[36:39]
    v_mfma_f32_16x16x32_bf16 a[36:39], v[240:243], v[80:83], a[36:39]
    v_mfma_f32_16x16x32_bf16 a[40:43], v[244:247], v[80:83], a[40:43]
    buffer_load_dwordx4 a[100:103], v46, s[40:43], s11 offen sc1
    v_mfma_f32_16x16x32_bf16 a[40:43], a[152:155], v[84:87], a[40:43]
    v_mfma_f32_16x16x32_bf16 a[40:43], v[164:167], v[88:91], a[40:43]
    v_mfma_f32_16x16x32_bf16 a[44:47], v[168:171], v[88:91], a[44:47]
    buffer_load_dwordx4 a[104:107], v46, s[40:43], s12 offen sc1
    v_mfma_f32_16x16x32_bf16 a[44:47], a[156:159], v[84:87], a[44:47]
    v_mfma_f32_16x16x32_bf16 a[44:47], v[248:251], v[80:83], a[44:47]
    s_waitcnt vmcnt(9)
    v_mfma_f32_16x16x32_bf16 v[120:123], v[140:143], v[92:95], v[120:123]
    buffer_load_dwordx4 a[108:111], v46, s[40:43], s13 offen sc1
    v_mfma_f32_16x16x32_bf16 v[120:123], v[204:207], v[96:99], v[120:123]
    v_mfma_f32_16x16x32_bf16 v[120:123], v[188:191], v[100:103], v[120:123]
    v_mfma_f32_16x16x32_bf16 v[120:123], v[172:175], v[104:107], v[120:123]
    buffer_load_dwordx4 a[112:115], v46, s[40:43], s14 offen sc1
    v_mfma_f32_16x16x32_bf16 a[36:39], v[176:179], v[104:107], a[36:39]
    v_mfma_f32_16x16x32_bf16 a[36:39], v[192:195], v[100:103], a[36:39]
    v_mfma_f32_16x16x32_bf16 a[36:39], v[208:211], v[96:99], a[36:39]
    buffer_load_dwordx4 a[116:119], v46, s[40:43], s15 offen sc1
    v_mfma_f32_16x16x32_bf16 a[36:39], v[144:147], v[92:95], a[36:39]
    v_mfma_f32_16x16x32_bf16 a[40:43], v[148:151], v[92:95], a[40:43]
    v_mfma_f32_16x16x32_bf16 a[40:43], v[212:215], v[96:99], a[40:43]
    buffer_load_dwordx4 a[120:123], v46, s[40:43], s16 offen sc1
    v_mfma_f32_16x16x32_bf16 a[40:43], v[196:199], v[100:103], a[40:43]
    v_mfma_f32_16x16x32_bf16 a[40:43], v[180:183], v[104:107], a[40:43]
    v_mfma_f32_16x16x32_bf16 a[44:47], v[184:187], v[104:107], a[44:47]
    v_mfma_f32_16x16x32_bf16 a[44:47], v[200:203], v[100:103], a[44:47]
    v_mfma_f32_16x16x32_bf16 a[44:47], v[216:219], v[96:99], a[44:47]
    v_mfma_f32_16x16x32_bf16 a[44:47], v[152:155], v[92:95], a[44:47]
    s_waitcnt vmcnt(9)
    v_mfma_f32_16x16x32_bf16 v[124:127], a[160:163], a[72:75], 0
    buffer_load_dwordx4 a[124:127], v46, s[40:43], s17 offen sc1
    v_mfma_f32_16x16x32_bf16 v[124:127], a[176:179], a[76:79], v[124:127]
    v_mfma_f32_16x16x32_bf16 v[124:127], a[192:195], a[80:83], v[124:127]
    v_mfma_f32_16x16x32_bf16 v[124:127], a[208:211], a[84:87], v[124:127]
    ds_write_b128 v32, v[120:123] offset:49152
    v_mfma_f32_16x16x32_bf16 a[48:51], a[212:215], a[84:87], 0
    v_mfma_f32_16x16x32_bf16 a[48:51], a[196:199], a[80:83], a[48:51]
    ds_write_b128 v33, a[36:39] offset:49152
    v_mfma_f32_16x16x32_bf16 a[48:51], a[180:183], a[76:79], a[48:51]
    v_mfma_f32_16x16x32_bf16 a[48:51], a[164:167], a[72:75], a[48:51]
    ds_write_b128 v34, a[40:43] offset:49152
    v_mfma_f32_16x16x32_bf16 a[52:55], a[168:171], a[72:75], 0
    v_mfma_f32_16x16x32_bf16 a[52:55], a[184:187], a[76:79], a[52:55]
    ds_write_b128 v35, a[44:47] offset:49152
    v_mfma_f32_16x16x32_bf16 a[52:55], a[200:203], a[80:83], a[52:55]
    v_mfma_f32_16x16x32_bf16 a[52:55], a[216:219], a[84:87], a[52:55]
    v_mfma_f32_16x16x32_bf16 a[56:59], a[220:223], a[84:87], 0
    v_mfma_f32_16x16x32_bf16 a[56:59], a[204:207], a[80:83], a[56:59]
    v_mfma_f32_16x16x32_bf16 a[56:59], a[188:191], a[76:79], a[56:59]
    v_mfma_f32_16x16x32_bf16 a[56:59], a[172:175], a[72:75], a[56:59]
    s_waitcnt lgkmcnt(0)
    s_barrier
    s_waitcnt vmcnt(6)
    v_mfma_f32_16x16x32_bf16 v[124:127], a[224:227], a[88:91], v[124:127]
    ds_read_b128 v[52:55], v253 offset:0
    v_mfma_f32_16x16x32_bf16 v[124:127], a[240:243], a[92:95], v[124:127]
    ds_read_b128 v[56:59], v40 offset:0
    v_mfma_f32_16x16x32_bf16 v[124:127], v[220:223], a[96:99], v[124:127]
    ds_read_b128 v[60:63], v253 offset:4096
    v_mfma_f32_16x16x32_bf16 v[124:127], v[236:239], a[100:103], v[124:127]
    ds_read_b128 v[64:67], v40 offset:4096
    v_mfma_f32_16x16x32_bf16 a[48:51], v[240:243], a[100:103], a[48:51]
    ds_read_b128 v[68:71], v253 offset:8192
    v_mfma_f32_16x16x32_bf16 a[48:51], v[224:227], a[96:99], a[48:51]
    ds_read_b128 v[72:75], v40 offset:8192
    v_mfma_f32_16x16x32_bf16 a[48:51], a[244:247], a[92:95], a[48:51]
    ds_read_b128 v[76:79], v253 offset:12288
    v_mfma_f32_16x16x32_bf16 a[48:51], a[228:231], a[88:91], a[48:51]
    ds_read_b128 v[80:83], v40 offset:12288
    v_mfma_f32_16x16x32_bf16 a[52:55], a[232:235], a[88:91], a[52:55]
    ds_read_b128 v[84:87], v253 offset:32768
    s_waitcnt lgkmcnt(5)
    v_mfma_f32_16x16x32_bf16 a[52:55], a[248:251], a[92:95], a[52:55]
    ds_read_b128 v[88:91], v40 offset:32768
    v_add_f32 v52, v52, v60
    v_mfma_f32_16x16x32_bf16 a[52:55], v[228:231], a[96:99], a[52:55]
    ds_read_b128 v[92:95], v253 offset:36864
    v_add_f32 v53, v53, v61
    v_mfma_f32_16x16x32_bf16 a[52:55], v[244:247], a[100:103], a[52:55]
    ds_read_b128 v[96:99], v40 offset:36864
    v_add_f32 v54, v54, v62
    v_mfma_f32_16x16x32_bf16 a[56:59], v[248:251], a[100:103], a[56:59]
    ds_read_b128 v[100:103], v253 offset:40960
    v_add_f32 v55, v55, v63
    v_mfma_f32_16x16x32_bf16 a[56:59], v[232:235], a[96:99], a[56:59]
    ds_read_b128 v[104:107], v40 offset:40960
    v_add_f32 v56, v56, v64
    v_mfma_f32_16x16x32_bf16 a[56:59], a[252:255], a[92:95], a[56:59]
    ds_read_b128 v[8:11], v253 offset:45056
    v_add_f32 v57, v57, v65
    v_mfma_f32_16x16x32_bf16 a[56:59], a[236:239], a[88:91], a[56:59]
    ds_read_b128 v[12:15], v40 offset:45056
    v_add_f32 v58, v58, v66
    s_waitcnt vmcnt(3)
    v_mfma_f32_16x16x32_bf16 v[124:127], a[144:147], a[104:107], v[124:127]
    v_add_f32 v59, v59, v67
    s_waitcnt lgkmcnt(8)
    v_mfma_f32_16x16x32_bf16 v[124:127], v[156:159], a[108:111], v[124:127]
    v_add_f32 v68, v68, v76
    v_add_f32 v69, v69, v77
    v_mfma_f32_16x16x32_bf16 v[124:127], v[140:143], a[112:115], v[124:127]
    v_add_f32 v70, v70, v78
    v_add_f32 v71, v71, v79
    v_mfma_f32_16x16x32_bf16 a[48:51], v[144:147], a[112:115], a[48:51]
    v_add_f32 v72, v72, v80
    v_add_f32 v73, v73, v81
    v_mfma_f32_16x16x32_bf16 a[48:51], v[160:163], a[108:111], a[48:51]
    v_add_f32 v74, v74, v82
    v_add_f32 v75, v75, v83
    v_mfma_f32_16x16x32_bf16 a[48:51], a[148:151], a[104:107], a[48:51]
    v_add_f32 v52, v52, v68
    v_mfma_f32_16x16x32_bf16 a[52:55], a[152:155], a[104:107], a[52:55]
    v_add_f32 v53, v53, v69
    v_add_f32 v54, v54, v70
    v_mfma_f32_16x16x32_bf16 a[52:55], v[164:167], a[108:111], a[52:55]
    v_add_f32 v55, v55, v71
    v_add_f32 v56, v56, v72
    v_mfma_f32_16x16x32_bf16 a[52:55], v[148:151], a[112:115], a[52:55]
    v_add_f32 v57, v57, v73
    v_add_f32 v58, v58, v74
    v_mfma_f32_16x16x32_bf16 a[56:59], v[152:155], a[112:115], a[56:59]
    v_add_f32 v59, v59, v75
    v_cvt_pk_bf16_f32 v60, v52, v53
    v_mfma_f32_16x16x32_bf16 a[56:59], v[168:171], a[108:111], a[56:59]
    v_cvt_pk_bf16_f32 v61, v54, v55
    v_cvt_pk_bf16_f32 v62, v56, v57
    v_mfma_f32_16x16x32_bf16 a[56:59], a[156:159], a[104:107], a[56:59]
    v_cvt_pk_bf16_f32 v63, v58, v59
    s_waitcnt lgkmcnt(4)
    s_waitcnt vmcnt(1)
    v_mfma_f32_16x16x32_bf16 v[124:127], v[204:207], a[116:119], v[124:127]
    v_add_f32 v84, v84, v92
    v_add_f32 v85, v85, v93
    v_mfma_f32_16x16x32_bf16 v[124:127], v[188:191], a[120:123], v[124:127]
    v_add_f32 v86, v86, v94
    v_add_f32 v87, v87, v95
    v_mfma_f32_16x16x32_bf16 a[48:51], v[192:195], a[120:123], a[48:51]
    v_add_f32 v88, v88, v96
    v_add_f32 v89, v89, v97
    v_mfma_f32_16x16x32_bf16 a[48:51], v[208:211], a[116:119], a[48:51]
    v_add_f32 v90, v90, v98
    v_add_f32 v91, v91, v99
    v_mfma_f32_16x16x32_bf16 a[52:55], v[212:215], a[116:119], a[52:55]
    s_waitcnt lgkmcnt(0)
    v_add_f32 v100, v100, v8
    v_mfma_f32_16x16x32_bf16 a[52:55], v[196:199], a[120:123], a[52:55]
    v_add_f32 v101, v101, v9
    v_add_f32 v102, v102, v10
    v_mfma_f32_16x16x32_bf16 a[56:59], v[200:203], a[120:123], a[56:59]
    v_add_f32 v103, v103, v11
    v_add_f32 v104, v104, v12
    v_mfma_f32_16x16x32_bf16 a[56:59], v[216:219], a[116:119], a[56:59]
    v_add_f32 v105, v105, v13
    v_add_f32 v106, v106, v14
    s_waitcnt vmcnt(0)
    v_mfma_f32_16x16x32_bf16 a[48:51], v[176:179], a[124:127], a[48:51]
    v_add_f32 v107, v107, v15
    v_mfma_f32_16x16x32_bf16 a[52:55], v[180:183], a[124:127], a[52:55]
    v_add_f32 v84, v84, v100
    v_add_f32 v85, v85, v101
    v_mfma_f32_16x16x32_bf16 a[56:59], v[184:187], a[124:127], a[56:59]
    v_add_f32 v86, v86, v102
    v_add_f32 v87, v87, v103
    v_mfma_f32_16x16x32_bf16 v[124:127], v[172:175], a[124:127], v[124:127]
    v_add_f32 v88, v88, v104
    v_add_f32 v89, v89, v105
    v_add_f32 v90, v90, v106
    v_add_f32 v91, v91, v107
    v_cvt_pk_bf16_f32 v92, v84, v85
    v_cvt_pk_bf16_f32 v93, v86, v87
    v_cvt_pk_bf16_f32 v94, v88, v89
    ds_write_b128 v37, a[48:51] offset:0
    ds_write_b128 v38, a[52:55] offset:0
    ds_write_b128 v39, a[56:59] offset:0
    ds_write_b128 v36, v[124:127] offset:0
    v_cvt_pk_bf16_f32 v95, v90, v91
    buffer_store_dwordx4 v[60:63], v51, s[36:39], s80 offen sc1
    buffer_store_dwordx4 v[92:95], v51, s[36:39], s81 offen sc1
    s_waitcnt lgkmcnt(0)
    s_barrier
    ds_read_b128 v[204:207], v41 offset:0
    ds_read_b128 v[208:211], v42 offset:0
    ds_read_b128 v[212:215], v41 offset:4096
    ds_read_b128 v[216:219], v42 offset:4096
    ds_read_b128 v[220:223], v41 offset:8192
    ds_read_b128 v[224:227], v42 offset:8192
    ds_read_b128 v[228:231], v41 offset:12288
    ds_read_b128 v[232:235], v42 offset:12288
    s_waitcnt lgkmcnt(4)
    v_pk_add_f32 v[204:205], v[204:205], v[212:213]
    v_pk_add_f32 v[206:207], v[206:207], v[214:215]
    v_pk_add_f32 v[208:209], v[208:209], v[216:217]
    v_pk_add_f32 v[210:211], v[210:211], v[218:219]
    s_waitcnt lgkmcnt(0)
    v_pk_add_f32 v[220:221], v[220:221], v[228:229]
    v_pk_add_f32 v[222:223], v[222:223], v[230:231]
    v_pk_add_f32 v[224:225], v[224:225], v[232:233]
    v_pk_add_f32 v[226:227], v[226:227], v[234:235]
    v_pk_add_f32 v[204:205], v[204:205], v[220:221]
    v_pk_add_f32 v[206:207], v[206:207], v[222:223]
    v_pk_add_f32 v[208:209], v[208:209], v[224:225]
    v_pk_add_f32 v[210:211], v[210:211], v[226:227]
    v_cvt_pk_bf16_f32 v212, v204, v205
    v_cvt_pk_bf16_f32 v213, v206, v207
    v_cvt_pk_bf16_f32 v214, v208, v209
    v_cvt_pk_bf16_f32 v215, v210, v211
    buffer_store_dwordx4 v[212:215], v51, s[36:39], s82 offen sc1
    s_endpgm
L_go_c2s:
    s_waitcnt lgkmcnt(0)
    s_mov_b32 s90, 0
L_go_c2w:
    s_sleep 2
    buffer_load_dword v1, v9, s[44:47], 0 offen sc1
    s_waitcnt vmcnt(0)
    v_readfirstlane_b32 s52, v1
    s_add_u32 s90, s90, 1
    s_cmp_gt_u32 s90, 0x80000
    s_cbranch_scc1 L_go_c2
    s_cmp_eq_u32 s52, 0
    s_cbranch_scc1 L_go_c2w
    s_branch L_go_c2
L_nu_c2_0s:
    s_waitcnt lgkmcnt(0)
    s_mov_b32 s90, 0
L_nu_c2_0w:
    s_mov_b64 exec, 0xffff
    buffer_load_dwordx4 v[4:7], v47, s[40:43], 0 offen sc1
    s_mov_b64 exec, -1
    s_waitcnt vmcnt(0) lgkmcnt(0)
    v_min_u32 v4, v4, v5
    v_min3_u32 v4, v4, v6, v7
    v_cmp_gt_u32 vcc, v4, v48
    s_nop 0
    s_or_b64 s[58:59], s[58:59], vcc
    s_and_b32 s52, s58, 0xffff
    s_cmp_eq_u32 s52, 0xffff
    s_cbranch_scc1 L_nu_c2_0
    s_sleep 4
    s_add_u32 s90, s90, 1
    s_cmp_gt_u32 s90, 0x80000
    s_cbranch_scc0 L_nu_c2_0w
    s_branch L_nu_c2_0
L_codeend_c2:
L_end:
    s_endpgm
.p2align 6
.type jobtab,@object
jobtab:
.long 2, 2580480, 0, 2252681504, 6967296, 31104, 0, 67372032, 0, 1, 2, 3, 4, 4, 0, 8126615
.long 0, 1146880, 384, 1969496848, 3102720, 14208, 1152, 488446730, 25, 26, 27, 28, 29, 29, 512000, 1417
.long 1, 2580480, 896, 1969496848, 6981632, 32000, 384, 2105360394, 60, 61, 62, 63, 64, 125, 1228800, 8127113
.long 0, 1146880, 1280, 1733509633, 3117056, 15104, 1152, 993736456, 55, 56, 57, 58, 59, 59, 1126400, 1432
.long 0, 0, 1792, 1733509633, 28672, 1792, 512, 1583242760, 90, 91, 92, 93, 94, 94, 1843200, 152
.long 1, 2580480, 1920, 2252681504, 6998016, 33024, 1024, 2105368072, 90, 91, 92, 93, 94, 125, 1843200, 8127639
.long 1, 2580480, 1152, 2252681504, 6985728, 32256, 512, 2105372418, 110, 111, 112, 113, 114, 125, 2252800, 7078039
.long 1, 2580480, 1664, 1969496848, 6993920, 32768, 1152, 2105372418, 110, 111, 112, 113, 114, 125, 2252800, 7079049
.long 0, 0, 0, 2252681504, 0, 0, 512, 488446730, 25, 26, 27, 28, 29, 29, 512000, 151
.long 0, 1146880, 512, 1733509633, 3104768, 14336, 1152, 404232200, 20, 21, 22, 23, 24, 24, 409600, 263576
.long 0, 0, 896, 1969496848, 14336, 896, 512, 993736456, 55, 56, 57, 58, 59, 59, 1126400, 137
.long 0, 1146880, 1408, 2252681504, 3119104, 15232, 1152, 909522438, 50, 51, 52, 53, 54, 54, 1024000, 263575
.long 0, 0, 1920, 2252681504, 30720, 1920, 512, 1499027718, 85, 86, 87, 88, 89, 89, 1740800, 262551
.long 0, 1146880, 2304, 1969496848, 3133440, 16128, 1152, 1583242760, 90, 91, 92, 93, 94, 94, 1843200, 1161
.long 1, 2580480, 640, 1733509633, 6977536, 31744, 384, 2122217220, 115, 116, 117, 118, 119, 126, 2355200, 8126616
.long 1, 2580480, 1408, 1733509633, 6989824, 32512, 1024, 2122217220, 115, 116, 117, 118, 119, 126, 2355200, 8127640
.long 0, 0, 128, 1969496848, 2048, 128, 512, 404232200, 20, 21, 22, 23, 24, 24, 409600, 262281
.long 0, 1146880, 640, 2252681504, 3106816, 14464, 1152, 320017158, 15, 16, 17, 18, 19, 19, 307200, 525719
.long 0, 0, 1024, 1733509633, 16384, 1024, 512, 909522438, 50, 51, 52, 53, 54, 54, 1024000, 262296
.long 0, 1146880, 1536, 1969496848, 3121152, 15360, 1152, 825307396, 45, 46, 47, 48, 49, 49, 921600, 525449
.long 0, 0, 2048, 1969496848, 32768, 2048, 512, 1414812420, 80, 81, 82, 83, 84, 84, 1638400, 524681
.long 0, 1146880, 2432, 1733509633, 3135488, 16256, 1152, 1499027718, 85, 86, 87, 88, 89, 89, 1740800, 263320
.long 1, 2580480, 384, 2252681504, 6973440, 31488, 512, 2122217220, 115, 116, 117, 118, 119, 126, 2355200, 9175191
.long 1, 2580480, 2176, 1733509633, 7002112, 33280, 1152, 2122217220, 115, 116, 117, 118, 119, 126, 2355200, 9176216
.long 0, 0, 256, 1733509633, 4096, 256, 512, 320017158, 15, 16, 17, 18, 19, 19, 307200, 524440
.long 0, 1146880, 768, 1969496848, 3108864, 14592, 1152, 235801860, 10, 11, 12, 13, 14, 14, 204800, 787593
.long 0, 0, 1152, 2252681504, 18432, 1152, 512, 825307396, 45, 46, 47, 48, 49, 49, 921600, 524695
.long 0, 1146880, 1664, 1733509633, 3123200, 15488, 1152, 741091586, 40, 41, 42, 43, 44, 44, 819200, 787608
.long 0, 0, 2176, 1733509633, 34816, 2176, 512, 1330597634, 75, 76, 77, 78, 79, 79, 1536000, 786840
.long 0, 1146880, 2560, 2252681504, 3137536, 16384, 1152, 1414812420, 80, 81, 82, 83, 84, 84, 1638400, 525463
.long 1, 2580480, 2944, 1733509633, 7014400, 34048, 384, 2139061254, 120, 121, 122, 123, 124, 127, 2457600, 10223768
.long 1, 2580480, 2432, 1969496848, 7006208, 33536, 1024, 2139061254, 120, 121, 122, 123, 124, 127, 2457600, 10224777
.long 0, 0, 384, 2252681504, 6144, 384, 512, 235801860, 10, 11, 12, 13, 14, 14, 204800, 786839
.long 0, 1433600, 0, 1733509633, 3870720, 17280, 1152, 151587074, 5, 6, 7, 8, 9, 9, 102400, 1049752
.long 0, 0, 1280, 1969496848, 20480, 1280, 512, 741091586, 40, 41, 42, 43, 44, 44, 819200, 786825
.long 0, 1433600, 896, 2252681504, 3885056, 18176, 1152, 656877312, 35, 36, 37, 38, 39, 39, 716800, 1049751
.long 0, 0, 2304, 2252681504, 36864, 2304, 512, 1246382592, 70, 71, 72, 73, 74, 74, 1433600, 1048727
.long 0, 1433600, 1792, 1969496848, 3899392, 19072, 1152, 1330597634, 75, 76, 77, 78, 79, 79, 1536000, 787593
.long 1, 2580480, 2688, 2252681504, 7010304, 33792, 512, 2139061254, 120, 121, 122, 123, 124, 127, 2457600, 11272343
.long 1, 2580480, 3200, 1969496848, 7018496, 34304, 1152, 2139061254, 120, 121, 122, 123, 124, 127, 2457600, 11273353
.long 0, 0, 512, 1969496848, 8192, 512, 512, 151587074, 5, 6, 7, 8, 9, 9, 102400, 1048969
.long 0, 1433600, 128, 2252681504, 3872768, 17408, 1152, 67372032, 0, 1, 2, 3, 4, 4, 0, 1311895
.long 0, 0, 1408, 1733509633, 22528, 1408, 512, 656877312, 35, 36, 37, 38, 39, 39, 716800, 1048984
.long 0, 1433600, 1024, 1969496848, 3887104, 18304, 1152, 572662284, 30, 31, 32, 33, 34, 34, 614400, 1311881
.long 0, 0, 2432, 1969496848, 38912, 2432, 512, 1162167564, 65, 66, 67, 68, 69, 69, 1331200, 1310857
.long 0, 1433600, 1920, 1733509633, 3901440, 19200, 1152, 1246382592, 70, 71, 72, 73, 74, 74, 1433600, 1050008
.long 0, 0, 2688, 2252681504, 43008, 2688, 512, 1835887872, 105, 106, 107, 108, 109, 109, 2150400, 407
.long 0, 1146880, 3072, 1969496848, 3145728, 16896, 1152, 1835887872, 105, 106, 107, 108, 109, 109, 2150400, 1161
.long 0, 0, 640, 1733509633, 10240, 640, 512, 67372032, 0, 1, 2, 3, 4, 4, 0, 1311128
.long 0, 1433600, 256, 1969496848, 3874816, 17536, 1024, 488446730, 25, 26, 27, 28, 29, 29, 512000, 1574025
.long 0, 0, 1536, 2252681504, 24576, 1536, 512, 572662284, 30, 31, 32, 33, 34, 34, 614400, 1310871
.long 0, 1433600, 1152, 1733509633, 3889152, 18432, 1024, 1077952522, 60, 61, 62, 63, 64, 64, 1228800, 1574296
.long 0, 0, 2560, 1733509633, 40960, 2560, 512, 1077952522, 60, 61, 62, 63, 64, 64, 1228800, 1573016
.long 0, 1433600, 2048, 2252681504, 3903488, 19328, 1152, 1162167564, 65, 66, 67, 68, 69, 69, 1331200, 1312151
.long 0, 0, 2816, 1969496848, 45056, 2816, 512, 1751672844, 100, 101, 102, 103, 104, 104, 2048000, 262537
.long 0, 1146880, 3200, 1733509633, 3147776, 17024, 1152, 1751672844, 100, 101, 102, 103, 104, 104, 2048000, 263320
.long 0, 0, 768, 2252681504, 12288, 768, 384, 488446730, 25, 26, 27, 28, 29, 29, 512000, 1573015
.long 0, 1433600, 384, 1733509633, 3876864, 17664, 1024, 404232200, 20, 21, 22, 23, 24, 24, 409600, 1836440
.long 0, 0, 1664, 1969496848, 26624, 1664, 384, 993736456, 55, 56, 57, 58, 59, 59, 1126400, 1573001
.long 0, 1433600, 1280, 2252681504, 3891200, 18560, 1024, 993736456, 55, 56, 57, 58, 59, 59, 1126400, 1836439
.long 0, 286720, 1792, 2252681504, 802816, 5248, 384, 1583242760, 90, 91, 92, 93, 94, 94, 1843200, 1835159
.long 0, 1433600, 2176, 1969496848, 3905536, 19456, 1152, 1077952522, 60, 61, 62, 63, 64, 64, 1228800, 1574281
.long 0, 0, 2944, 1733509633, 47104, 2944, 512, 1667457290, 95, 96, 97, 98, 99, 99, 1945600, 524696
.long 0, 1146880, 3328, 2252681504, 3149824, 17152, 1152, 1667457290, 95, 96, 97, 98, 99, 99, 1945600, 525463
.long 0, 286720, 0, 1969496848, 774144, 3456, 384, 404232200, 20, 21, 22, 23, 24, 24, 409600, 1835145
.long 0, 1433600, 512, 2252681504, 3878912, 17792, 1024, 320017158, 15, 16, 17, 18, 19, 19, 307200, 2098583
.long 0, 286720, 896, 1733509633, 788480, 4352, 384, 909522438, 50, 51, 52, 53, 54, 54, 1024000, 1835160
.long 0, 1433600, 1408, 1969496848, 3893248, 18688, 1024, 909522438, 50, 51, 52, 53, 54, 54, 1024000, 2098569
.long 0, 286720, 1920, 1969496848, 804864, 5376, 384, 1499027718, 85, 86, 87, 88, 89, 89, 1740800, 2097545
.long 0, 1433600, 2304, 1733509633, 3907584, 19584, 1024, 1499027718, 85, 86, 87, 88, 89, 89, 1740800, 1836184
.long 0, 0, 3072, 2252681504, 49152, 3072, 384, 1920102146, 110, 111, 112, 113, 114, 114, 2252800, 786583
.long 0, 1433600, 2688, 1733509633, 3913728, 19968, 1024, 1920102146, 110, 111, 112, 113, 114, 114, 2252800, 787864
.long 0, 286720, 128, 1733509633, 776192, 3584, 384, 320017158, 15, 16, 17, 18, 19, 19, 307200, 2097304
.long 0, 1433600, 640, 1969496848, 3880960, 17920, 1024, 235801860, 10, 11, 12, 13, 14, 14, 204800, 2360713
.long 0, 286720, 1024, 2252681504, 790528, 4480, 384, 825307396, 45, 46, 47, 48, 49, 49, 921600, 2097303
.long 0, 1433600, 1536, 1733509633, 3895296, 18816, 1024, 825307396, 45, 46, 47, 48, 49, 49, 921600, 2360472
.long 0, 286720, 2048, 1733509633, 806912, 5504, 384, 1414812420, 80, 81, 82, 83, 84, 84, 1638400, 2359704
.long 0, 1433600, 2432, 2252681504, 3909632, 19712, 1024, 1414812420, 80, 81, 82, 83, 84, 84, 1638400, 2098327
.long 0, 0, 3200, 1969496848, 51200, 3200, 384, 1835887872, 105, 106, 107, 108, 109, 109, 2150400, 1048713
.long 0, 1433600, 2816, 2252681504, 3915776, 20096, 1024, 1835887872, 105, 106, 107, 108, 109, 109, 2150400, 1050007
.long 0, 286720, 256, 2252681504, 778240, 3712, 384, 235801860, 10, 11, 12, 13, 14, 14, 204800, 2359447
.long 0, 1433600, 768, 1733509633, 3883008, 18048, 1024, 151587074, 5, 6, 7, 8, 9, 9, 102400, 2622616
.long 0, 286720, 1152, 1969496848, 792576, 4608, 384, 741091586, 40, 41, 42, 43, 44, 44, 819200, 2359689
.long 0, 1433600, 1664, 2252681504, 3897344, 18944, 1024, 741091586, 40, 41, 42, 43, 44, 44, 819200, 2622615
.long 0, 286720, 2176, 2252681504, 808960, 5632, 384, 1330597634, 75, 76, 77, 78, 79, 79, 1536000, 2621847
.long 0, 1433600, 2560, 1969496848, 3911680, 19840, 1024, 1330597634, 75, 76, 77, 78, 79, 79, 1536000, 2360457
.long 0, 0, 3328, 1733509633, 53248, 3328, 384, 1751672844, 100, 101, 102, 103, 104, 104, 2048000, 1310872
.long 0, 1433600, 2944, 1969496848, 3917824, 20224, 1024, 1751672844, 100, 101, 102, 103, 104, 104, 2048000, 1312137
.long 0, 286720, 384, 1969496848, 780288, 3840, 384, 151587074, 5, 6, 7, 8, 9, 9, 102400, 2621833
.long 0, 1720320, 0, 2252681504, 4644864, 20736, 1024, 67372032, 0, 1, 2, 3, 4, 4, 0, 2884759
.long 0, 286720, 1280, 1733509633, 794624, 4736, 384, 656877312, 35, 36, 37, 38, 39, 39, 716800, 2621848
.long 0, 1720320, 896, 1969496848, 4659200, 21632, 1024, 656877312, 35, 36, 37, 38, 39, 39, 716800, 2884745
.long 0, 286720, 2304, 1969496848, 811008, 5760, 384, 1246382592, 70, 71, 72, 73, 74, 74, 1433600, 2883721
.long 0, 1720320, 1792, 1733509633, 4673536, 22528, 1024, 1246382592, 70, 71, 72, 73, 74, 74, 1433600, 2622616
.long 0, 286720, 2688, 1969496848, 817152, 6144, 384, 1667457290, 95, 96, 97, 98, 99, 99, 1945600, 1573257
.long 0, 1433600, 3072, 1733509633, 3919872, 20352, 1024, 1667457290, 95, 96, 97, 98, 99, 99, 1945600, 1574040
.long 0, 286720, 512, 1733509633, 782336, 3968, 384, 67372032, 0, 1, 2, 3, 4, 4, 0, 2883992
.long 0, 1720320, 128, 1969496848, 4646912, 20864, 896, 572662284, 30, 31, 32, 33, 34, 34, 614400, 3146889
.long 0, 286720, 1408, 2252681504, 796672, 4864, 384, 572662284, 30, 31, 32, 33, 34, 34, 614400, 2883991
.long 0, 1720320, 1024, 1733509633, 4661248, 21760, 1024, 572662284, 30, 31, 32, 33, 34, 34, 614400, 3146904
.long 0, 286720, 2432, 1733509633, 813056, 5888, 384, 1162167564, 65, 66, 67, 68, 69, 69, 1331200, 3145880
.long 0, 1720320, 1920, 2252681504, 4675584, 22656, 1024, 1162167564, 65, 66, 67, 68, 69, 69, 1331200, 2885015
.long 0, 286720, 2816, 1733509633, 819200, 6272, 256, 2139061512, 200, 124, 125, 126, 127, 127, 1073741824, 1835416
.long 0, 1433600, 3200, 2252681504, 3921920, 20480, 896, 2139061512, 200, 124, 125, 126, 127, 127, 1073741824, 1836183
.long 0, 286720, 640, 2252681504, 784384, 4096, 256, 572662284, 30, 31, 32, 33, 34, 34, 614400, 3146135
.long 0, 1720320, 256, 1733509633, 4648960, 20992, 896, 488446730, 25, 26, 27, 28, 29, 29, 512000, 3409048
.long 0, 286720, 1536, 1969496848, 798720, 4992, 256, 1077952522, 60, 61, 62, 63, 64, 64, 1228800, 3145865
.long 0, 1720320, 1152, 2252681504, 4663296, 21888, 896, 1077952522, 60, 61, 62, 63, 64, 64, 1228800, 3409303
.long 0, 286720, 2560, 2252681504, 815104, 6016, 256, 1583242760, 90, 91, 92, 93, 94, 94, 1843200, 3408023
.long 0, 1720320, 2048, 1969496848, 4677632, 22784, 896, 1583242760, 90, 91, 92, 93, 94, 94, 1843200, 3147145
.long 0, 286720, 2944, 2252681504, 821248, 6400, 256, 2071689990, 200, 120, 121, 122, 123, 123, 1073741824, 2097559
.long 0, 1433600, 3328, 1969496848, 3923968, 20608, 896, 2071689990, 200, 120, 121, 122, 123, 123, 1073741824, 2098313
.long 0, 286720, 768, 1969496848, 786432, 4224, 256, 488446730, 25, 26, 27, 28, 29, 29, 512000, 3408009
.long 0, 1720320, 384, 2252681504, 4651008, 21120, 896, 404232200, 20, 21, 22, 23, 24, 24, 409600, 3671447
.long 0, 286720, 1664, 1733509633, 800768, 5120, 256, 993736456, 55, 56, 57, 58, 59, 59, 1126400, 3408024
.long 0, 1720320, 1280, 1969496848, 4665344, 22016, 896, 993736456, 55, 56, 57, 58, 59, 59, 1126400, 3671433
.long 0, 573440, 1792, 1969496848, 1576960, 8704, 256, 1499027718, 85, 86, 87, 88, 89, 89, 1740800, 3670153
.long 0, 1720320, 2176, 1733509633, 4679680, 22912, 896, 1499027718, 85, 86, 87, 88, 89, 89, 1740800, 3409304
.long 0, 286720, 3072, 1969496848, 823296, 6528, 256, 2004317956, 115, 116, 117, 118, 119, 119, 2355200, 2359433
.long 0, 1720320, 2688, 2252681504, 4687872, 23424, 896, 2004317956, 115, 116, 117, 118, 119, 119, 2355200, 2360727
.long 0, 573440, 0, 1733509633, 1548288, 6912, 256, 404232200, 20, 21, 22, 23, 24, 24, 409600, 3670168
.long 0, 1720320, 512, 1969496848, 4653056, 21248, 896, 320017158, 15, 16, 17, 18, 19, 19, 307200, 3933577
.long 0, 573440, 896, 2252681504, 1562624, 7808, 256, 909522438, 50, 51, 52, 53, 54, 54, 1024000, 3670167
.long 0, 1720320, 1408, 1733509633, 4667392, 22144, 896, 909522438, 50, 51, 52, 53, 54, 54, 1024000, 3933592
.long 0, 573440, 1920, 1733509633, 1579008, 8832, 256, 1414812420, 80, 81, 82, 83, 84, 84, 1638400, 3932568
.long 0, 1720320, 2304, 2252681504, 4681728, 23040, 896, 1414812420, 80, 81, 82, 83, 84, 84, 1638400, 3671191
.long 0, 286720, 3200, 1733509633, 825344, 6656, 256, 1920102146, 110, 111, 112, 113, 114, 114, 2252800, 2621592
.long 0, 1720320, 2816, 1969496848, 4689920, 23552, 896, 1920102146, 110, 111, 112, 113, 114, 114, 2252800, 2622857
.long 0, 573440, 128, 2252681504, 1550336, 7040, 256, 320017158, 15, 16, 17, 18, 19, 19, 307200, 3932311
.long 0, 1720320, 640, 1733509633, 4655104, 21376, 896, 235801860, 10, 11, 12, 13, 14, 14, 204800, 4195736
.long 0, 573440, 1024, 1969496848, 1564672, 7936, 256, 825307396, 45, 46, 47, 48, 49, 49, 921600, 3932297
.long 0, 1720320, 1536, 2252681504, 4669440, 22272, 896, 825307396, 45, 46, 47, 48, 49, 49, 921600, 4195479
.long 0, 573440, 2048, 2252681504, 1581056, 8960, 256, 1330597634, 75, 76, 77, 78, 79, 79, 1536000, 4194711
.long 0, 1720320, 2432, 1969496848, 4683776, 23168, 896, 1330597634, 75, 76, 77, 78, 79, 79, 1536000, 3933321
.long 0, 286720, 3328, 2252681504, 827392, 6784, 256, 1835887872, 105, 106, 107, 108, 109, 109, 2150400, 2883735
.long 0, 1720320, 2944, 1733509633, 4691968, 23680, 896, 1835887872, 105, 106, 107, 108, 109, 109, 2150400, 2885016
.long 0, 573440, 256, 1969496848, 1552384, 7168, 256, 235801860, 10, 11, 12, 13, 14, 14, 204800, 4194441
.long 0, 1720320, 768, 2252681504, 4657152, 21504, 896, 151587074, 5, 6, 7, 8, 9, 9, 102400, 4457623
.long 0, 573440, 1152, 1733509633, 1566720, 8064, 256, 741091586, 40, 41, 42, 43, 44, 44, 819200, 4194712
.long 0, 1720320, 1664, 1969496848, 4671488, 22400, 896, 741091586, 40, 41, 42, 43, 44, 44, 819200, 4457609
.long 0, 573440, 2176, 1969496848, 1583104, 9088, 256, 1246382592, 70, 71, 72, 73, 74, 74, 1433600, 4456841
.long 0, 1720320, 2560, 1733509633, 4685824, 23296, 896, 1246382592, 70, 71, 72, 73, 74, 74, 1433600, 4195480
.long 0, 573440, 2688, 1733509633, 1591296, 9600, 256, 1751672844, 100, 101, 102, 103, 104, 104, 2048000, 3146136
.long 0, 1720320, 3072, 2252681504, 4694016, 23808, 896, 1751672844, 100, 101, 102, 103, 104, 104, 2048000, 3146903
.long 0, 573440, 384, 1733509633, 1554432, 7296, 256, 151587074, 5, 6, 7, 8, 9, 9, 102400, 4456856
.long 0, 2007040, 0, 1969496848, 5419008, 24192, 896, 67372032, 0, 1, 2, 3, 4, 4, 0, 4719753
.long 0, 573440, 1280, 2252681504, 1568768, 8192, 256, 656877312, 35, 36, 37, 38, 39, 39, 716800, 4456855
.long 0, 2007040, 896, 1733509633, 5433344, 25088, 896, 656877312, 35, 36, 37, 38, 39, 39, 716800, 4719768
.long 0, 573440, 2304, 1733509633, 1585152, 9216, 256, 1162167564, 65, 66, 67, 68, 69, 69, 1331200, 4718744
.long 0, 2007040, 1792, 2252681504, 5447680, 25984, 896, 1162167564, 65, 66, 67, 68, 69, 69, 1331200, 4457623
.long 0, 573440, 2816, 2252681504, 1593344, 9728, 256, 1667457290, 95, 96, 97, 98, 99, 99, 1945600, 3408279
.long 0, 1720320, 3200, 1969496848, 4696064, 23936, 896, 1667457290, 95, 96, 97, 98, 99, 99, 1945600, 3409033
.long 0, 573440, 512, 2252681504, 1556480, 7424, 256, 67372032, 0, 1, 2, 3, 4, 4, 0, 4718999
.long 0, 2007040, 128, 1733509633, 5421056, 24320, 768, 488446730, 25, 26, 27, 28, 29, 29, 512000, 4981912
.long 0, 573440, 1408, 1969496848, 1570816, 8320, 128, 1077952522, 60, 61, 62, 63, 64, 64, 1228800, 4718985
.long 0, 2007040, 1024, 2252681504, 5435392, 25216, 768, 1077952522, 60, 61, 62, 63, 64, 64, 1228800, 4981911
.long 0, 573440, 2432, 2252681504, 1587200, 9344, 128, 1583242760, 90, 91, 92, 93, 94, 94, 1843200, 4980887
.long 0, 2007040, 1920, 1969496848, 5449728, 26112, 768, 1583242760, 90, 91, 92, 93, 94, 94, 1843200, 4720009
.long 0, 573440, 2944, 1969496848, 1595392, 9856, 128, 2139061512, 200, 124, 125, 126, 127, 127, 1073741824, 3670409
.long 0, 1720320, 3328, 1733509633, 4698112, 24064, 768, 2139061512, 200, 124, 125, 126, 127, 127, 1073741824, 3671192
.long 0, 573440, 640, 1969496848, 1558528, 7552, 128, 488446730, 25, 26, 27, 28, 29, 29, 512000, 4981129
.long 0, 2007040, 256, 2252681504, 5423104, 24448, 768, 404232200, 20, 21, 22, 23, 24, 24, 409600, 5244055
.long 0, 573440, 1536, 1733509633, 1572864, 8448, 128, 993736456, 55, 56, 57, 58, 59, 59, 1126400, 4980888
.long 0, 2007040, 1152, 1969496848, 5437440, 25344, 768, 993736456, 55, 56, 57, 58, 59, 59, 1126400, 5244297
.long 0, 573440, 2560, 1969496848, 1589248, 9472, 128, 1499027718, 85, 86, 87, 88, 89, 89, 1740800, 5243017
.long 0, 2007040, 2048, 1733509633, 5451776, 26240, 768, 1499027718, 85, 86, 87, 88, 89, 89, 1740800, 4982168
.long 0, 573440, 3072, 1733509633, 1597440, 9984, 128, 2071689990, 200, 120, 121, 122, 123, 123, 1073741824, 3932312
.long 0, 2007040, 2688, 1969496848, 5462016, 26880, 768, 2071689990, 200, 120, 121, 122, 123, 123, 1073741824, 3933577
.long 0, 573440, 768, 1733509633, 1560576, 7680, 128, 404232200, 20, 21, 22, 23, 24, 24, 409600, 5243032
.long 0, 2007040, 384, 1969496848, 5425152, 24576, 768, 320017158, 15, 16, 17, 18, 19, 19, 307200, 5506441
.long 0, 573440, 1664, 2252681504, 1574912, 8576, 128, 909522438, 50, 51, 52, 53, 54, 54, 1024000, 5243031
.long 0, 2007040, 1280, 1733509633, 5439488, 25472, 768, 909522438, 50, 51, 52, 53, 54, 54, 1024000, 5506456
.long 0, 860160, 1792, 1733509633, 2351104, 12160, 128, 1414812420, 80, 81, 82, 83, 84, 84, 1638400, 5505176
.long 0, 2007040, 2176, 2252681504, 5453824, 26368, 768, 1414812420, 80, 81, 82, 83, 84, 84, 1638400, 5244311
.long 0, 573440, 3200, 2252681504, 1599488, 10112, 128, 2004317956, 115, 116, 117, 118, 119, 119, 2355200, 4194455
.long 0, 2007040, 2816, 1733509633, 5464064, 27008, 768, 2004317956, 115, 116, 117, 118, 119, 119, 2355200, 4195736
.long 0, 860160, 0, 2252681504, 2322432, 10368, 128, 320017158, 15, 16, 17, 18, 19, 19, 307200, 5505175
.long 0, 2007040, 512, 1733509633, 5427200, 24704, 768, 235801860, 10, 11, 12, 13, 14, 14, 204800, 5768600
.long 0, 860160, 896, 1969496848, 2336768, 11264, 128, 825307396, 45, 46, 47, 48, 49, 49, 921600, 5505161
.long 0, 2007040, 1408, 2252681504, 5441536, 25600, 768, 825307396, 45, 46, 47, 48, 49, 49, 921600, 5768599
.long 0, 860160, 1920, 2252681504, 2353152, 12288, 128, 1330597634, 75, 76, 77, 78, 79, 79, 1536000, 5767575
.long 0, 2007040, 2304, 1969496848, 5455872, 26496, 768, 1330597634, 75, 76, 77, 78, 79, 79, 1536000, 5506185
.long 0, 573440, 3328, 1969496848, 1601536, 10240, 128, 1920102146, 110, 111, 112, 113, 114, 114, 2252800, 4456585
.long 0, 2007040, 2944, 2252681504, 5466112, 27136, 768, 1920102146, 110, 111, 112, 113, 114, 114, 2252800, 4457879
.long 0, 860160, 128, 1969496848, 2324480, 10496, 128, 235801860, 10, 11, 12, 13, 14, 14, 204800, 5767305
.long 0, 2007040, 640, 2252681504, 5429248, 24832, 768, 151587074, 5, 6, 7, 8, 9, 9, 102400, 6030743
.long 0, 860160, 1024, 1733509633, 2338816, 11392, 128, 741091586, 40, 41, 42, 43, 44, 44, 819200, 5767320
.long 0, 2007040, 1536, 1969496848, 5443584, 25728, 768, 741091586, 40, 41, 42, 43, 44, 44, 819200, 6030473
.long 0, 860160, 2048, 1969496848, 2355200, 12416, 128, 1246382592, 70, 71, 72, 73, 74, 74, 1433600, 6029705
.long 0, 2007040, 2432, 1733509633, 5457920, 26624, 768, 1246382592, 70, 71, 72, 73, 74, 74, 1433600, 5768344
.long 0, 860160, 2688, 2252681504, 2365440, 13056, 128, 1835887872, 105, 106, 107, 108, 109, 109, 2150400, 4718999
.long 0, 2007040, 3072, 1969496848, 5468160, 27264, 768, 1835887872, 105, 106, 107, 108, 109, 109, 2150400, 4719753
.long 0, 860160, 256, 1733509633, 2326528, 10624, 128, 151587074, 5, 6, 7, 8, 9, 9, 102400, 6029464
.long 0, 2007040, 768, 1969496848, 5431296, 24960, 768, 67372032, 0, 1, 2, 3, 4, 4, 0, 6292617
.long 0, 860160, 1152, 2252681504, 2340864, 11520, 128, 656877312, 35, 36, 37, 38, 39, 39, 716800, 6029719
.long 0, 2007040, 1664, 1733509633, 5445632, 25856, 768, 656877312, 35, 36, 37, 38, 39, 39, 716800, 6292632
.long 0, 860160, 2176, 1733509633, 2357248, 12544, 128, 1162167564, 65, 66, 67, 68, 69, 69, 1331200, 6291864
.long 0, 2007040, 2560, 2252681504, 5459968, 26752, 768, 1162167564, 65, 66, 67, 68, 69, 69, 1331200, 6030487
.long 0, 860160, 2816, 1969496848, 2367488, 13184, 128, 1751672844, 100, 101, 102, 103, 104, 104, 2048000, 4981129
.long 0, 2007040, 3200, 1733509633, 5470208, 27392, 768, 1751672844, 100, 101, 102, 103, 104, 104, 2048000, 4981912
.long 0, 860160, 384, 2252681504, 2328576, 10752, 128, 67372032, 0, 1, 2, 3, 4, 4, 0, 6291863
.long 0, 2293760, 0, 1733509633, 6193152, 27648, 640, 572662284, 30, 31, 32, 33, 34, 34, 614400, 6554776
.long 0, 860160, 1280, 1969496848, 2342912, 11648, 128, 572662284, 30, 31, 32, 33, 34, 34, 614400, 6291849
.long 0, 2293760, 896, 2252681504, 6207488, 28544, 768, 572662284, 30, 31, 32, 33, 34, 34, 614400, 6554775
.long 0, 860160, 2304, 2252681504, 2359296, 12672, 0, 1667457290, 95, 96, 97, 98, 99, 99, 1945600, 6553751
.long 0, 2293760, 1792, 1969496848, 6221824, 29440, 640, 1667457290, 95, 96, 97, 98, 99, 99, 1945600, 6292617
.long 0, 860160, 2944, 1733509633, 2369536, 13312, 128, 1667457290, 95, 96, 97, 98, 99, 99, 1945600, 5243288
.long 0, 2007040, 3328, 2252681504, 5472256, 27520, 768, 1667457290, 95, 96, 97, 98, 99, 99, 1945600, 5244055
.long 0, 860160, 512, 1969496848, 2330624, 10880, 0, 572662284, 30, 31, 32, 33, 34, 34, 614400, 6553993
.long 0, 2293760, 128, 2252681504, 6195200, 27776, 640, 488446730, 25, 26, 27, 28, 29, 29, 512000, 6816919
.long 0, 860160, 1408, 1733509633, 2344960, 11776, 0, 1077952522, 60, 61, 62, 63, 64, 64, 1228800, 6554008
.long 0, 2293760, 1024, 1969496848, 6209536, 28672, 640, 1077952522, 60, 61, 62, 63, 64, 64, 1228800, 6816905
.long 0, 860160, 2432, 1969496848, 2361344, 12800, 0, 1583242760, 90, 91, 92, 93, 94, 94, 1843200, 6815881
.long 0, 2293760, 1920, 1733509633, 6223872, 29568, 640, 1583242760, 90, 91, 92, 93, 94, 94, 1843200, 6555032
.long 0, 860160, 3072, 2252681504, 2371584, 13440, 0, 2139061512, 200, 124, 125, 126, 127, 127, 1073741824, 5505175
.long 0, 2293760, 2688, 1733509633, 6236160, 30336, 640, 2139061512, 200, 124, 125, 126, 127, 127, 1073741824, 5506456
.long 0, 860160, 640, 1733509633, 2332672, 11008, 0, 488446730, 25, 26, 27, 28, 29, 29, 512000, 6816152
.long 0, 2293760, 256, 1969496848, 6197248, 27904, 640, 404232200, 20, 21, 22, 23, 24, 24, 409600, 7079049
.long 0, 860160, 1536, 2252681504, 2347008, 11904, 0, 993736456, 55, 56, 57, 58, 59, 59, 1126400, 6815895
.long 0, 2293760, 1152, 1733509633, 6211584, 28800, 640, 993736456, 55, 56, 57, 58, 59, 59, 1126400, 7079320
.long 0, 860160, 2560, 1733509633, 2363392, 12928, 0, 1499027718, 85, 86, 87, 88, 89, 89, 1740800, 7078040
.long 0, 2293760, 2048, 2252681504, 6225920, 29696, 640, 1499027718, 85, 86, 87, 88, 89, 89, 1740800, 6817175
.long 0, 860160, 3200, 1969496848, 2373632, 13568, 0, 2071689990, 200, 120, 121, 122, 123, 123, 1073741824, 5767305
.long 0, 2293760, 2816, 2252681504, 6238208, 30464, 640, 2071689990, 200, 120, 121, 122, 123, 123, 1073741824, 5768599
.long 0, 860160, 768, 2252681504, 2334720, 11136, 0, 404232200, 20, 21, 22, 23, 24, 24, 409600, 7078039
.long 0, 2293760, 384, 1733509633, 6199296, 28032, 640, 320017158, 15, 16, 17, 18, 19, 19, 307200, 7341464
.long 0, 860160, 1664, 1969496848, 2349056, 12032, 0, 909522438, 50, 51, 52, 53, 54, 54, 1024000, 7078025
.long 0, 2293760, 1280, 2252681504, 6213632, 28928, 640, 909522438, 50, 51, 52, 53, 54, 54, 1024000, 7341463
.long 0, 1146880, 1792, 2252681504, 3125248, 15616, 0, 1414812420, 80, 81, 82, 83, 84, 84, 1638400, 7340183
.long 0, 2293760, 2176, 1969496848, 6227968, 29824, 640, 1414812420, 80, 81, 82, 83, 84, 84, 1638400, 7079305
.long 0, 860160, 3328, 1733509633, 2375680, 13696, 0, 2004317956, 115, 116, 117, 118, 119, 119, 2355200, 6029464
.long 0, 2293760, 2944, 1969496848, 6240256, 30592, 640, 2004317956, 115, 116, 117, 118, 119, 119, 2355200, 6030729
.long 0, 1146880, 0, 1969496848, 3096576, 13824, 0, 320017158, 15, 16, 17, 18, 19, 19, 307200, 7340169
.long 0, 2293760, 512, 2252681504, 6201344, 28160, 640, 235801860, 10, 11, 12, 13, 14, 14, 204800, 7603607
.long 0, 1146880, 896, 1733509633, 3110912, 14720, 0, 825307396, 45, 46, 47, 48, 49, 49, 921600, 7340184
.long 0, 2293760, 1408, 1969496848, 6215680, 29056, 640, 825307396, 45, 46, 47, 48, 49, 49, 921600, 7603593
.long 0, 1146880, 1920, 1969496848, 3127296, 15744, 0, 1330597634, 75, 76, 77, 78, 79, 79, 1536000, 7602569
.long 0, 2293760, 2304, 1733509633, 6230016, 29952, 640, 1330597634, 75, 76, 77, 78, 79, 79, 1536000, 7341208
.long 0, 1146880, 2688, 1969496848, 3139584, 16512, 0, 1920102146, 110, 111, 112, 113, 114, 114, 2252800, 6291849
.long 0, 2293760, 3072, 1733509633, 6242304, 30720, 640, 1920102146, 110, 111, 112, 113, 114, 114, 2252800, 6292632
.long 0, 1146880, 128, 1733509633, 3098624, 13952, 0, 235801860, 10, 11, 12, 13, 14, 14, 204800, 7602328
.long 0, 2293760, 640, 1969496848, 6203392, 28288, 640, 151587074, 5, 6, 7, 8, 9, 9, 102400, 7865737
.long 0, 1146880, 1024, 2252681504, 3112960, 14848, 0, 741091586, 40, 41, 42, 43, 44, 44, 819200, 7602327
.long 0, 2293760, 1536, 1733509633, 6217728, 29184, 640, 741091586, 40, 41, 42, 43, 44, 44, 819200, 7865496
.long 0, 1146880, 2048, 1733509633, 3129344, 15872, 0, 1246382592, 70, 71, 72, 73, 74, 74, 1433600, 7864728
.long 0, 2293760, 2432, 2252681504, 6232064, 30080, 640, 1246382592, 70, 71, 72, 73, 74, 74, 1433600, 7603351
.long 0, 1146880, 2816, 1733509633, 3141632, 16640, 0, 1835887872, 105, 106, 107, 108, 109, 109, 2150400, 6554008
.long 0, 2293760, 3200, 2252681504, 6244352, 30848, 640, 1835887872, 105, 106, 107, 108, 109, 109, 2150400, 6554775
.long 0, 1146880, 256, 2252681504, 3100672, 14080, 0, 151587074, 5, 6, 7, 8, 9, 9, 102400, 7864471
.long 0, 2293760, 768, 1733509633, 6205440, 28416, 640, 67372032, 0, 1, 2, 3, 4, 4, 0, 8127640
.long 0, 1146880, 1152, 1969496848, 3115008, 14976, 0, 656877312, 35, 36, 37, 38, 39, 39, 716800, 7864713
.long 0, 2293760, 1664, 2252681504, 6219776, 29312, 640, 656877312, 35, 36, 37, 38, 39, 39, 716800, 8127639
.long 0, 1146880, 2176, 2252681504, 3131392, 16000, 0, 1162167564, 65, 66, 67, 68, 69, 69, 1331200, 8126871
.long 0, 2293760, 2560, 1969496848, 6234112, 30208, 640, 1162167564, 65, 66, 67, 68, 69, 69, 1331200, 7865481
.long 0, 1146880, 2944, 2252681504, 3143680, 16768, 0, 1751672844, 100, 101, 102, 103, 104, 104, 2048000, 6816151
.long 0, 2293760, 3328, 1969496848, 6246400, 30976, 640, 1751672844, 100, 101, 102, 103, 104, 104, 2048000, 6816905
.size jobtab, 16384
.section .rodata,"a"
.p2align 6
.amdhsa_kernel standalone__glu_gated_geglu__prompt_kernel
  .amdhsa_next_free_vgpr 512
  .amdhsa_next_free_sgpr 102
  .amdhsa_accum_offset 256
  .amdhsa_group_segment_fixed_size 0
  .amdhsa_kernarg_size 56
  .amdhsa_user_sgpr_count 2
  .amdhsa_user_sgpr_kernarg_segment_ptr 1
  .amdhsa_system_sgpr_workgroup_id_x 1
  .amdhsa_float_denorm_mode_32 3
.end_amdhsa_kernel
```
